```python
import torch

def _softmax(x, axis=-1):
    return torch.softmax(x, dim=axis)
def _gelu(x):
    return torch.nn.functional.gelu(x, approximate="tanh")
def _silu(x):
    return torch.nn.functional.silu(x)
def _sigmoid(x):
    return torch.sigmoid(x)
def _layernorm(x, axis=-1, eps=1e-5):
    m = x.mean(dim=axis, keepdim=True)
    v = x.var(dim=axis, keepdim=True, unbiased=False)
    return (x - m) / torch.sqrt(v + eps)
def _scatter_add(tgt, idx, src, axis=0):
    return tgt.clone().index_add_(axis, idx, src)
def _segment_sum(src, seg, n):
    out = torch.zeros((n,) + src.shape[1:], dtype=src.dtype)
    return out.index_add_(0, seg, src)
def _pad(x, pw):
    flat = tuple(v for pair in reversed(pw) for v in pair)
    return torch.nn.functional.pad(x, flat)

kernel_name = 'concat_heads__mha_block_cached__mha_block_cached__near_ridge'

def setup_inputs():

    _w = (lambda a: (lambda t: t.to(torch.bfloat16) if t.is_floating_point() else t)(torch.as_tensor(a)))
    def _A_setup():
        B, Sq, D = 8, 192, 576
        H, Sk, Dh = 32, 512, 128
        return {
            "x": _w((lambda *s: torch.randn(*s, dtype=torch.bfloat16) * 0.8)(B, Sq, D)),
            "k_cache": _w((lambda *s: torch.randn(*s, dtype=torch.bfloat16) * 0.8)(B, H, Sk, Dh)),
            "v_cache": _w((lambda *s: torch.randn(*s, dtype=torch.bfloat16) * 0.05)(B, H, Sk, Dh)),
            "wq": _w((lambda *s: torch.randn(*s, dtype=torch.bfloat16) * 0.8)(D, H * Dh) * (D ** -0.5)),
            "wo": _w((lambda *s: torch.randn(*s, dtype=torch.bfloat16) * 0.05)(H * Dh, D) * ((H * Dh) ** -0.5)),
        }
    _A_in = _A_setup()

    def _B_setup():
        B, Sq, D = 8, 192, 576
        H, Sk, Dh = 32, 512, 128
        return {
            "x": _w((lambda *s: torch.randn(*s, dtype=torch.bfloat16) * 0.8)(B, Sq, D)),
            "k_cache": _w((lambda *s: torch.randn(*s, dtype=torch.bfloat16) * 0.8)(B, H, Sk, Dh)),
            "v_cache": _w((lambda *s: torch.randn(*s, dtype=torch.bfloat16) * 0.05)(B, H, Sk, Dh)),
            "wq": _w((lambda *s: torch.randn(*s, dtype=torch.bfloat16) * 0.8)(D, H * Dh) * (D ** -0.5)),
            "wo": _w((lambda *s: torch.randn(*s, dtype=torch.bfloat16) * 0.05)(H * Dh, D) * ((H * Dh) ** -0.5)),
        }
    _B_in = _B_setup()

    return {
        "A_x": _A_in["x"],
        "A_k_cache": _A_in["k_cache"],
        "A_v_cache": _A_in["v_cache"],
        "A_wq": _A_in["wq"],
        "A_wo": _A_in["wo"],
        "B_x": _B_in["x"],
        "B_k_cache": _B_in["k_cache"],
        "B_v_cache": _B_in["v_cache"],
        "B_wq": _B_in["wq"],
        "B_wo": _B_in["wo"],
    }

def reference(A_x, A_k_cache, A_v_cache, A_wq, A_wo, B_x, B_k_cache, B_v_cache, B_wq, B_wo):
    def _A_ref(x, k_cache, v_cache, wq, wo):
        B, Sq, D = x.shape
        H, Dh = 32, 128
        q = (lambda x, *d: x.permute(*d))((x @ wq).reshape(B, Sq, H, Dh), 0, 2, 1, 3)
        scores = torch.einsum("bhqd,bhkd->bhqk", q, k_cache) * (Dh ** -0.5)
        p = _softmax(scores, axis=-1)
        o = torch.einsum("bhqk,bhkd->bhqd", p, v_cache)
        return (lambda x, *d: x.permute(*d))(o, 0, 2, 1, 3).reshape(B, Sq, H * Dh) @ wo

    def _B_ref(x, k_cache, v_cache, wq, wo):
        B, Sq, D = x.shape
        H, Dh = 32, 128
        q = (lambda x, *d: x.permute(*d))((x @ wq).reshape(B, Sq, H, Dh), 0, 2, 1, 3)
        scores = torch.einsum("bhqd,bhkd->bhqk", q, k_cache) * (Dh ** -0.5)
        p = _softmax(scores, axis=-1)
        o = torch.einsum("bhqk,bhkd->bhqd", p, v_cache)
        return (lambda x, *d: x.permute(*d))(o, 0, 2, 1, 3).reshape(B, Sq, H * Dh) @ wo

    a = _A_ref(A_x, A_k_cache, A_v_cache, A_wq, A_wo)
    b = _B_ref(B_x, B_k_cache, B_v_cache, B_wq, B_wo)
    return torch.concatenate([a, b], axis=-1)
```

```asm
; @launch kernel=attn_kernel grid=(256,1,1) block=(512,1,1) lds=163840
; @launch kernel=oproj_kernel grid=(256,1,1) block=(256,1,1) lds=98304
.amdgcn_target "amdgcn-amd-amdhsa--gfx950"
.text
.globl attn_kernel
.p2align 8
.type attn_kernel,@function
attn_kernel:
    s_cmp_ge_u32 s2, 256
    s_cbranch_scc1 L_k1_done
    s_load_dwordx4 s[8:11], s[0:1], 0
    s_load_dwordx4 s[12:15], s[0:1], 16
    s_load_dwordx2 s[16:17], s[0:1], 32
    s_load_dwordx4 s[20:23], s[0:1], 40
    s_load_dwordx4 s[24:27], s[0:1], 56
    s_load_dwordx2 s[28:29], s[0:1], 72
    s_load_dwordx2 s[30:31], s[0:1], 96
    v_lshrrev_b32 v1, 6, v0
    v_and_b32 v207, 63, v0
    v_readfirstlane_b32 s32, v1
    s_nop 3
    s_lshr_b32 s70, s32, 2
    s_and_b32 s3, s32, 3
    s_and_b32 s7, s2, 7
    s_lshr_b32 s4, s7, 2
    s_lshr_b32 s32, s2, 3
    s_and_b32 s5, s32, 7
    s_and_b32 s6, s7, 3
    s_lshl_b32 s6, s6, 2
    s_lshr_b32 s33, s32, 3
    s_add_u32 s6, s6, s33
    s_lshl_b32 s6, s6, 1
    s_add_u32 s6, s6, s70
    s_mul_i32 s75, s70, 81920
    s_lshl_b32 s64, s3, 11
    s_add_u32 s64, s64, s75
    s_mul_i32 s65, s3, 6144
    s_mul_i32 s33, s70, 3072
    s_add_u32 s65, s65, s33
    v_lshrrev_b32 v2, 4, v207
    v_and_b32 v3, 15, v207
    s_and_b32 s33, s3, 1
    s_lshl_b32 s33, s33, 2
    v_or_b32 v4, s33, v2
    v_lshlrev_b32 v4, 1, v4
    v_xor_b32 v4, v3, v4
    v_lshlrev_b32 v4, 4, v4
    s_lshl_b32 s33, s3, 3
    v_add_u32 v5, s33, v2
    v_lshlrev_b32 v6, 13, v5
    v_add_u32 v204, v6, v4
    v_lshlrev_b32 v6, 8, v5
    v_lshlrev_b32 v7, 1, v2
    v_xor_b32 v8, v3, v7
    v_lshlrev_b32 v8, 4, v8
    v_add_u32 v205, v6, v8
    v_or_b32 v7, 8, v7
    v_xor_b32 v8, v3, v7
    v_lshlrev_b32 v8, 4, v8
    v_add_u32 v206, v6, v8
    v_lshrrev_b32 v6, 3, v207
    s_mul_i32 s33, s3, 48
    s_mul_i32 s34, s70, 24
    s_add_u32 s33, s33, s34
    v_add_u32 v6, s33, v6
    v_mul_u32_u24 v6, 1152, v6
    v_and_b32 v7, 7, v207
    s_lshl_b32 s34, s70, 2
    v_or_b32 v9, s34, v2
    v_xor_b32 v8, v7, v9
    v_lshl_add_u32 v180, v8, 4, v6
    v_xor_b32 v9, 4, v9
    v_xor_b32 v8, v7, v9
    v_lshl_add_u32 v8, v8, 4, v6
    v_add_u32 v181, 8192, v8
    v_and_b32 v6, 3, v207
    v_lshrrev_b32 v7, 2, v207
    v_and_b32 v7, 3, v7
    v_lshlrev_b32 v8, 3, v2
    v_add_u32 v8, v8, v7
    v_lshlrev_b32 v8, 8, v8
    v_and_b32 v9, 1, v2
    v_lshlrev_b32 v9, 2, v9
    v_or_b32 v9, v9, v7
    v_lshlrev_b32 v9, 5, v9
    v_lshlrev_b32 v10, 3, v6
    v_add3_u32 v8, v8, v9, v10
    v_add_u32 v8, s75, v8
    v_mov_b32 v192, v8
    v_xor_b32 v193, 32, v8
    v_xor_b32 v194, 64, v8
    v_xor_b32 v195, 96, v8
    v_xor_b32 v196, 128, v8
    v_xor_b32 v197, 160, v8
    v_xor_b32 v198, 192, v8
    v_xor_b32 v199, 224, v8
    v_lshrrev_b32 v6, 1, v3
    v_xor_b32 v6, v6, v2
    v_lshlrev_b32 v6, 4, v6
    v_lshlrev_b32 v7, 7, v3
    s_mul_i32 s33, s3, 6144
    v_add3_u32 v6, v6, v7, s33
    v_add_u32 v168, 32768, v6
    v_xor_b32 v169, 64, v168
    v_add_u32 v170, 114688, v6
    v_xor_b32 v171, 64, v170
    v_add_u32 v172, 57344, v6
    v_xor_b32 v173, 64, v172
    v_lshlrev_b32 v6, 4, v207
    v_add_u32 v174, s64, v6
    s_waitcnt lgkmcnt(0)
    s_cmp_eq_u32 s4, 0
    s_cselect_b32 s8, s8, s20
    s_cselect_b32 s9, s9, s21
    s_cselect_b32 s10, s10, s22
    s_cselect_b32 s11, s11, s23
    s_cselect_b32 s12, s12, s24
    s_cselect_b32 s13, s13, s25
    s_cselect_b32 s14, s14, s26
    s_cselect_b32 s15, s15, s27
    s_cselect_b32 s16, s16, s28
    s_cselect_b32 s17, s17, s29
    s_mul_i32 s7, s5, 221184
    s_add_u32 s36, s8, s7
    s_addc_u32 s37, s9, 0
    s_mov_b32 s38, 0x36000
    s_mov_b32 s39, 0x20000
    s_lshl_b32 s7, s6, 8
    s_sub_u32 s33, 4718592, s7
    s_add_u32 s40, s14, s7
    s_addc_u32 s41, s15, 0
    s_mov_b32 s42, s33
    s_mov_b32 s43, 0x20000
    s_lshl_b32 s7, s5, 5
    s_add_u32 s7, s7, s6
    s_lshl_b32 s7, s7, 17
    s_add_u32 s44, s10, s7
    s_addc_u32 s45, s11, 0
    s_mov_b32 s46, 0x20000
    s_mov_b32 s47, 0x20000
    s_add_u32 s48, s12, s7
    s_addc_u32 s49, s13, 0
    s_mov_b32 s50, 0x20000
    s_mov_b32 s51, 0x20000
    s_add_u32 m0, s64, 0
    s_mov_b32 s66, 0
    s_mov_b32 s67, 31744
    buffer_load_dwordx4 v204, s[40:43], s66 offen lds
    buffer_load_dwordx4 v204, s[40:43], s67 offen offset:1024 lds
    s_add_u32 m0, s65, 32768
    s_mov_b32 s74, 0
    s_mov_b32 s18, 16384
    buffer_load_dwordx4 v180, s[36:39], s74 offen lds
    buffer_load_dwordx4 v181, s[36:39], s74 offen offset:1024 lds
    buffer_load_dwordx4 v180, s[36:39], s18 offen offset:2048 lds
    s_add_u32 m0, s64, 8192
    s_mov_b32 s66, 262144
    s_mov_b32 s67, 293888
    buffer_load_dwordx4 v204, s[40:43], s66 offen lds
    buffer_load_dwordx4 v204, s[40:43], s67 offen offset:1024 lds
    s_add_u32 m0, s64, 16384
    s_mov_b32 s66, 524288
    s_mov_b32 s67, 556032
    buffer_load_dwordx4 v204, s[40:43], s66 offen lds
    buffer_load_dwordx4 v204, s[40:43], s67 offen offset:1024 lds
    s_add_u32 m0, s65, 114688
    s_mov_b32 s74, 128
    s_mov_b32 s18, 16512
    buffer_load_dwordx4 v180, s[36:39], s74 offen lds
    buffer_load_dwordx4 v181, s[36:39], s74 offen offset:1024 lds
    buffer_load_dwordx4 v180, s[36:39], s18 offen offset:2048 lds
    s_add_u32 m0, s64, 24576
    s_mov_b32 s66, 786432
    s_mov_b32 s67, 818176
    buffer_load_dwordx4 v204, s[40:43], s66 offen lds
    buffer_load_dwordx4 v204, s[40:43], s67 offen offset:1024 lds
    s_lshl_b32 s34, s4, 7
    s_lshl_b32 s35, s6, 2
    s_add_u32 s34, s34, s35
    s_mul_i32 s34, s34, 96
    s_mul_i32 s35, s5, 12
    s_add_u32 s34, s34, s35
    s_mul_i32 s35, s3, 3
    s_add_u32 s34, s34, s35
    s_lshl_b32 s34, s34, 10
    s_add_u32 s52, s30, s34
    s_addc_u32 s53, s31, 0
    s_sub_u32 s54, 25165824, s34
    s_mov_b32 s55, 0x20000
    s_lshl_b32 s20, s3, 6
    s_lshl_b32 s21, s3, 11
    s_mov_b32 s56, s16
    s_mov_b32 s57, s17
    s_mov_b32 s58, 4718592
    s_mov_b32 s59, 0x20000
    s_and_b32 s33, s2, 3
    s_lshl_b32 s33, s33, 5
    s_lshr_b32 s34, s2, 3
    s_add_u32 s33, s33, s34
    s_lshl_b32 s33, s33, 3
    s_lshl_b32 s34, s70, 2
    s_add_u32 s33, s33, s34
    s_add_u32 s33, s33, s3
    s_mul_i32 s23, s33, 4608
    s_lshr_b32 s22, s2, 3
    s_mul_i32 s22, s22, 1
    s_lshl_b32 s33, s70, 3
    s_add_u32 s22, s22, s33
    s_and_b32 s22, s22, 15
    s_lshl_b32 s22, s22, 13
    v_lshrrev_b32 v6, 2, v207
    v_mul_u32_u24 v7, 1152, v6
    v_and_b32 v8, 3, v207
    v_lshl_add_u32 v184, v8, 4, v7
    v_lshlrev_b32 v6, 6, v6
    v_lshl_add_u32 v6, v8, 3, v6
    v_add_u32 v6, s64, v6
    v_add_u32 v182, 57344, v6
    v_lshlrev_b32 v183, 4, v207
    v_mov_b32 v185, 0
    buffer_load_dword v186, v185, s[44:47], 0 offen nt
    buffer_load_dword v187, v185, s[48:51], 0 offen nt
    v_mov_b32 v1, 0x3f803f80
    v_accvgpr_write_b32 a12, v1
    v_accvgpr_write_b32 a13, v1
    v_accvgpr_write_b32 a14, v1
    v_accvgpr_write_b32 a15, v1
    s_waitcnt vmcnt(11)
    s_barrier
    ds_read_b128 v[96:99], v168
    ds_read_b128 v[100:103], v168 offset:2048
    ds_read_b128 v[104:107], v168 offset:4096
    ds_read_b64_tr_b16 v[120:121], v192
    ds_read_b64_tr_b16 v[122:123], v192 offset:1024
    ds_read_b64_tr_b16 v[124:125], v193
    ds_read_b64_tr_b16 v[126:127], v193 offset:1024
    ds_read_b64_tr_b16 v[128:129], v194
    ds_read_b64_tr_b16 v[130:131], v194 offset:1024
    s_waitcnt lgkmcnt(4)
    v_mfma_f32_16x16x32_bf16 v[0:3], v[120:123], v[96:99], 0
    ds_read_b64_tr_b16 v[132:133], v195
    v_mfma_f32_16x16x32_bf16 v[32:35], v[120:123], v[100:103], 0
    ds_read_b64_tr_b16 v[134:135], v195 offset:1024
    v_mfma_f32_16x16x32_bf16 v[64:67], v[120:123], v[104:107], 0
    ds_read_b64_tr_b16 v[136:137], v196
    s_waitcnt lgkmcnt(5)
    v_mfma_f32_16x16x32_bf16 v[4:7], v[124:127], v[96:99], 0
    ds_read_b64_tr_b16 v[140:141], v197
    v_mfma_f32_16x16x32_bf16 v[36:39], v[124:127], v[100:103], 0
    ds_read_b64_tr_b16 v[120:121], v198
    v_mfma_f32_16x16x32_bf16 v[68:71], v[124:127], v[104:107], 0
    ds_read_b64_tr_b16 v[124:125], v199
    s_waitcnt lgkmcnt(6)
    v_mfma_f32_16x16x32_bf16 v[8:11], v[128:131], v[96:99], 0
    ds_read_b64_tr_b16 v[138:139], v196 offset:1024
    v_mfma_f32_16x16x32_bf16 v[40:43], v[128:131], v[100:103], 0
    ds_read_b64_tr_b16 v[142:143], v197 offset:1024
    s_waitcnt lgkmcnt(6)
    ds_read_b64_tr_b16 v[122:123], v198 offset:1024
    ds_read_b64_tr_b16 v[126:127], v199 offset:1024
    v_mfma_f32_16x16x32_bf16 v[72:75], v[128:131], v[104:107], 0
    ds_read_b128 v[108:111], v169
    v_mfma_f32_16x16x32_bf16 v[12:15], v[132:135], v[96:99], 0
    ds_read_b128 v[112:115], v169 offset:2048
    v_mfma_f32_16x16x32_bf16 v[44:47], v[132:135], v[100:103], 0
    ds_read_b128 v[116:119], v169 offset:4096
    s_waitcnt lgkmcnt(6)
    v_mfma_f32_16x16x32_bf16 v[76:79], v[132:135], v[104:107], 0
    s_add_u32 m0, s64, 0
    s_mov_b32 s66, 1048576
    s_mov_b32 s67, 1080320
    v_mfma_f32_16x16x32_bf16 v[16:19], v[136:139], v[96:99], 0
    s_waitcnt lgkmcnt(3)
    s_waitcnt vmcnt(9)
    s_barrier
    v_mfma_f32_16x16x32_bf16 v[48:51], v[136:139], v[100:103], 0
    ds_read_b64_tr_b16 v[128:129], v192 offset:8192
    v_mfma_f32_16x16x32_bf16 v[80:83], v[136:139], v[104:107], 0
    ds_read_b64_tr_b16 v[130:131], v192 offset:9216
    v_mfma_f32_16x16x32_bf16 v[20:23], v[140:143], v[96:99], 0
    buffer_load_dwordx4 v204, s[40:43], s66 offen lds
    v_mfma_f32_16x16x32_bf16 v[52:55], v[140:143], v[100:103], 0
    ds_read_b64_tr_b16 v[132:133], v193 offset:8192
    v_mfma_f32_16x16x32_bf16 v[84:87], v[140:143], v[104:107], 0
    ds_read_b64_tr_b16 v[134:135], v193 offset:9216
    v_mfma_f32_16x16x32_bf16 v[24:27], v[120:123], v[96:99], 0
    buffer_load_dwordx4 v204, s[40:43], s67 offen offset:1024 lds
    v_mfma_f32_16x16x32_bf16 v[56:59], v[120:123], v[100:103], 0
    ds_read_b64_tr_b16 v[136:137], v194 offset:8192
    v_mfma_f32_16x16x32_bf16 v[88:91], v[120:123], v[104:107], 0
    ds_read_b64_tr_b16 v[138:139], v194 offset:9216
    v_mfma_f32_16x16x32_bf16 v[28:31], v[124:127], v[96:99], 0
    ds_read_b64_tr_b16 v[140:141], v195 offset:8192
    v_mfma_f32_16x16x32_bf16 v[60:63], v[124:127], v[100:103], 0
    ds_read_b64_tr_b16 v[142:143], v195 offset:9216
    s_waitcnt lgkmcnt(8)
    v_mfma_f32_16x16x32_bf16 v[92:95], v[124:127], v[104:107], 0
    ds_read_b64_tr_b16 v[120:121], v196 offset:8192
    s_waitcnt lgkmcnt(7)
    v_mfma_f32_16x16x32_bf16 v[0:3], v[128:131], v[108:111], v[0:3]
    ds_read_b64_tr_b16 v[124:125], v197 offset:8192
    v_mfma_f32_16x16x32_bf16 v[32:35], v[128:131], v[112:115], v[32:35]
    ds_read_b64_tr_b16 v[122:123], v196 offset:9216
    s_waitcnt lgkmcnt(7)
    v_mfma_f32_16x16x32_bf16 v[64:67], v[128:131], v[116:119], v[64:67]
    ds_read_b64_tr_b16 v[128:129], v198 offset:8192
    v_mfma_f32_16x16x32_bf16 v[4:7], v[132:135], v[108:111], v[4:7]
    ds_read_b64_tr_b16 v[126:127], v197 offset:9216
    v_mfma_f32_16x16x32_bf16 v[36:39], v[132:135], v[112:115], v[36:39]
    ds_read_b64_tr_b16 v[130:131], v198 offset:9216
    s_waitcnt lgkmcnt(8)
    v_mfma_f32_16x16x32_bf16 v[68:71], v[132:135], v[116:119], v[68:71]
    ds_read_b64_tr_b16 v[132:133], v199 offset:8192
    v_mfma_f32_16x16x32_bf16 v[8:11], v[136:139], v[108:111], v[8:11]
    ds_read_b64_tr_b16 v[134:135], v199 offset:9216
    v_mfma_f32_16x16x32_bf16 v[40:43], v[136:139], v[112:115], v[40:43]
    s_waitcnt lgkmcnt(8)
    v_mfma_f32_16x16x32_bf16 v[72:75], v[136:139], v[116:119], v[72:75]
    v_mfma_f32_16x16x32_bf16 v[12:15], v[140:143], v[108:111], v[12:15]
    v_mfma_f32_16x16x32_bf16 v[44:47], v[140:143], v[112:115], v[44:47]
    s_waitcnt lgkmcnt(5)
    s_add_u32 m0, s65, 32768
    s_mov_b32 s74, 256
    v_mfma_f32_16x16x32_bf16 v[76:79], v[140:143], v[116:119], v[76:79]
    s_mov_b32 s18, 16640
    v_mfma_f32_16x16x32_bf16 v[16:19], v[120:123], v[108:111], v[16:19]
    s_waitcnt lgkmcnt(0)
    s_waitcnt vmcnt(6)
    s_barrier
    v_mfma_f32_16x16x32_bf16 v[48:51], v[120:123], v[112:115], v[48:51]
    ds_read_b64_tr_b16 v[136:137], v192 offset:16384
    v_mfma_f32_16x16x32_bf16 v[80:83], v[120:123], v[116:119], v[80:83]
    buffer_load_dwordx4 v180, s[36:39], s74 offen lds
    v_mfma_f32_16x16x32_bf16 v[20:23], v[124:127], v[108:111], v[20:23]
    ds_read_b128 v[96:99], v170
    v_mfma_f32_16x16x32_bf16 v[52:55], v[124:127], v[112:115], v[52:55]
    ds_read_b64_tr_b16 v[138:139], v192 offset:17408
    v_mfma_f32_16x16x32_bf16 v[84:87], v[124:127], v[116:119], v[84:87]
    ds_read_b128 v[100:103], v170 offset:2048
    v_mfma_f32_16x16x32_bf16 v[24:27], v[128:131], v[108:111], v[24:27]
    buffer_load_dwordx4 v181, s[36:39], s74 offen offset:1024 lds
    v_mfma_f32_16x16x32_bf16 v[56:59], v[128:131], v[112:115], v[56:59]
    ds_read_b128 v[104:107], v170 offset:4096
    v_mfma_f32_16x16x32_bf16 v[88:91], v[128:131], v[116:119], v[88:91]
    ds_read_b64_tr_b16 v[140:141], v193 offset:16384
    v_mfma_f32_16x16x32_bf16 v[28:31], v[132:135], v[108:111], v[28:31]
    ds_read_b64_tr_b16 v[142:143], v193 offset:17408
    v_mfma_f32_16x16x32_bf16 v[60:63], v[132:135], v[112:115], v[60:63]
    s_waitcnt lgkmcnt(2)
    buffer_load_dwordx4 v180, s[36:39], s18 offen offset:2048 lds
    s_add_u32 m0, s64, 8192
    s_mov_b32 s66, 1310720
    s_mov_b32 s67, 1342464
    v_mfma_f32_16x16x32_bf16 v[92:95], v[132:135], v[116:119], v[92:95]
    buffer_load_dwordx4 v204, s[40:43], s66 offen lds
    buffer_load_dwordx4 v204, s[40:43], s67 offen offset:1024 lds
    v_mfma_f32_16x16x32_bf16 v[0:3], v[136:139], v[96:99], v[0:3]
    ds_read_b64_tr_b16 v[120:121], v194 offset:16384
    v_mfma_f32_16x16x32_bf16 v[32:35], v[136:139], v[100:103], v[32:35]
    ds_read_b64_tr_b16 v[122:123], v194 offset:17408
    s_waitcnt lgkmcnt(2)
    v_mfma_f32_16x16x32_bf16 v[64:67], v[136:139], v[104:107], v[64:67]
    ds_read_b64_tr_b16 v[124:125], v195 offset:16384
    v_mfma_f32_16x16x32_bf16 v[4:7], v[140:143], v[96:99], v[4:7]
    ds_read_b64_tr_b16 v[126:127], v195 offset:17408
    v_mfma_f32_16x16x32_bf16 v[36:39], v[140:143], v[100:103], v[36:39]
    ds_read_b64_tr_b16 v[128:129], v196 offset:16384
    s_waitcnt lgkmcnt(3)
    v_mfma_f32_16x16x32_bf16 v[68:71], v[140:143], v[104:107], v[68:71]
    ds_read_b64_tr_b16 v[132:133], v197 offset:16384
    v_mfma_f32_16x16x32_bf16 v[8:11], v[120:123], v[96:99], v[8:11]
    ds_read_b64_tr_b16 v[136:137], v198 offset:16384
    ds_read_b64_tr_b16 v[140:141], v199 offset:16384
    v_mfma_f32_16x16x32_bf16 v[40:43], v[120:123], v[100:103], v[40:43]
    ds_read_b64_tr_b16 v[130:131], v196 offset:17408
    s_waitcnt lgkmcnt(5)
    ds_read_b64_tr_b16 v[134:135], v197 offset:17408
    ds_read_b64_tr_b16 v[138:139], v198 offset:17408
    ds_read_b64_tr_b16 v[142:143], v199 offset:17408
    v_mfma_f32_16x16x32_bf16 v[72:75], v[120:123], v[104:107], v[72:75]
    ds_read_b128 v[108:111], v171
    v_mfma_f32_16x16x32_bf16 v[12:15], v[124:127], v[96:99], v[12:15]
    ds_read_b128 v[112:115], v171 offset:2048
    v_mfma_f32_16x16x32_bf16 v[44:47], v[124:127], v[100:103], v[44:47]
    ds_read_b128 v[116:119], v171 offset:4096
    s_waitcnt lgkmcnt(6)
    v_mfma_f32_16x16x32_bf16 v[76:79], v[124:127], v[104:107], v[76:79]
    s_add_u32 m0, s64, 16384
    s_mov_b32 s66, 1572864
    s_mov_b32 s67, 1604608
    v_mfma_f32_16x16x32_bf16 v[16:19], v[128:131], v[96:99], v[16:19]
    s_waitcnt lgkmcnt(3)
    s_waitcnt vmcnt(9)
    s_barrier
    v_mfma_f32_16x16x32_bf16 v[48:51], v[128:131], v[100:103], v[48:51]
    ds_read_b64_tr_b16 v[120:121], v192 offset:24576
    v_mfma_f32_16x16x32_bf16 v[80:83], v[128:131], v[104:107], v[80:83]
    ds_read_b64_tr_b16 v[122:123], v192 offset:25600
    v_mfma_f32_16x16x32_bf16 v[20:23], v[132:135], v[96:99], v[20:23]
    buffer_load_dwordx4 v204, s[40:43], s66 offen lds
    v_mfma_f32_16x16x32_bf16 v[52:55], v[132:135], v[100:103], v[52:55]
    ds_read_b64_tr_b16 v[124:125], v193 offset:24576
    v_mfma_f32_16x16x32_bf16 v[84:87], v[132:135], v[104:107], v[84:87]
    ds_read_b64_tr_b16 v[126:127], v193 offset:25600
    v_mfma_f32_16x16x32_bf16 v[24:27], v[136:139], v[96:99], v[24:27]
    buffer_load_dwordx4 v204, s[40:43], s67 offen offset:1024 lds
    v_mfma_f32_16x16x32_bf16 v[56:59], v[136:139], v[100:103], v[56:59]
    ds_read_b64_tr_b16 v[128:129], v194 offset:24576
    v_mfma_f32_16x16x32_bf16 v[88:91], v[136:139], v[104:107], v[88:91]
    ds_read_b64_tr_b16 v[130:131], v194 offset:25600
    v_mfma_f32_16x16x32_bf16 v[28:31], v[140:143], v[96:99], v[28:31]
    ds_read_b64_tr_b16 v[132:133], v195 offset:24576
    v_mfma_f32_16x16x32_bf16 v[60:63], v[140:143], v[100:103], v[60:63]
    ds_read_b64_tr_b16 v[134:135], v195 offset:25600
    s_waitcnt lgkmcnt(8)
    v_mfma_f32_16x16x32_bf16 v[92:95], v[140:143], v[104:107], v[92:95]
    ds_read_b64_tr_b16 v[136:137], v196 offset:24576
    s_waitcnt lgkmcnt(7)
    v_mfma_f32_16x16x32_bf16 v[0:3], v[120:123], v[108:111], v[0:3]
    ds_read_b64_tr_b16 v[140:141], v197 offset:24576
    v_mfma_f32_16x16x32_bf16 v[32:35], v[120:123], v[112:115], v[32:35]
    ds_read_b64_tr_b16 v[138:139], v196 offset:25600
    s_waitcnt lgkmcnt(7)
    v_mfma_f32_16x16x32_bf16 v[64:67], v[120:123], v[116:119], v[64:67]
    ds_read_b64_tr_b16 v[120:121], v198 offset:24576
    v_mfma_f32_16x16x32_bf16 v[4:7], v[124:127], v[108:111], v[4:7]
    ds_read_b64_tr_b16 v[142:143], v197 offset:25600
    v_mfma_f32_16x16x32_bf16 v[36:39], v[124:127], v[112:115], v[36:39]
    ds_read_b64_tr_b16 v[122:123], v198 offset:25600
    s_waitcnt lgkmcnt(8)
    v_mfma_f32_16x16x32_bf16 v[68:71], v[124:127], v[116:119], v[68:71]
    ds_read_b64_tr_b16 v[124:125], v199 offset:24576
    v_mfma_f32_16x16x32_bf16 v[8:11], v[128:131], v[108:111], v[8:11]
    ds_read_b64_tr_b16 v[126:127], v199 offset:25600
    v_mfma_f32_16x16x32_bf16 v[40:43], v[128:131], v[112:115], v[40:43]
    s_waitcnt lgkmcnt(8)
    v_mfma_f32_16x16x32_bf16 v[72:75], v[128:131], v[116:119], v[72:75]
    v_mfma_f32_16x16x32_bf16 v[12:15], v[132:135], v[108:111], v[12:15]
    v_mfma_f32_16x16x32_bf16 v[44:47], v[132:135], v[112:115], v[44:47]
    s_waitcnt lgkmcnt(5)
    s_add_u32 m0, s65, 114688
    s_mov_b32 s74, 384
    v_mfma_f32_16x16x32_bf16 v[76:79], v[132:135], v[116:119], v[76:79]
    s_mov_b32 s18, 16768
    v_mfma_f32_16x16x32_bf16 v[16:19], v[136:139], v[108:111], v[16:19]
    s_waitcnt lgkmcnt(0)
    s_waitcnt vmcnt(4)
    s_barrier
    v_mfma_f32_16x16x32_bf16 v[48:51], v[136:139], v[112:115], v[48:51]
    ds_read_b64_tr_b16 v[128:129], v192
    v_mfma_f32_16x16x32_bf16 v[80:83], v[136:139], v[116:119], v[80:83]
    buffer_load_dwordx4 v180, s[36:39], s74 offen lds
    v_mfma_f32_16x16x32_bf16 v[20:23], v[140:143], v[108:111], v[20:23]
    ds_read_b128 v[96:99], v168
    v_mfma_f32_16x16x32_bf16 v[52:55], v[140:143], v[112:115], v[52:55]
    ds_read_b64_tr_b16 v[130:131], v192 offset:1024
    v_mfma_f32_16x16x32_bf16 v[84:87], v[140:143], v[116:119], v[84:87]
    ds_read_b128 v[100:103], v168 offset:2048
    v_mfma_f32_16x16x32_bf16 v[24:27], v[120:123], v[108:111], v[24:27]
    buffer_load_dwordx4 v181, s[36:39], s74 offen offset:1024 lds
    v_mfma_f32_16x16x32_bf16 v[56:59], v[120:123], v[112:115], v[56:59]
    ds_read_b128 v[104:107], v168 offset:4096
    v_mfma_f32_16x16x32_bf16 v[88:91], v[120:123], v[116:119], v[88:91]
    ds_read_b64_tr_b16 v[132:133], v193
    v_mfma_f32_16x16x32_bf16 v[28:31], v[124:127], v[108:111], v[28:31]
    ds_read_b64_tr_b16 v[134:135], v193 offset:1024
    v_mfma_f32_16x16x32_bf16 v[60:63], v[124:127], v[112:115], v[60:63]
    s_waitcnt lgkmcnt(2)
    buffer_load_dwordx4 v180, s[36:39], s18 offen offset:2048 lds
    s_add_u32 m0, s64, 24576
    s_mov_b32 s66, 1835008
    s_mov_b32 s67, 1866752
    v_mfma_f32_16x16x32_bf16 v[92:95], v[124:127], v[116:119], v[92:95]
    buffer_load_dwordx4 v204, s[40:43], s66 offen lds
    buffer_load_dwordx4 v204, s[40:43], s67 offen offset:1024 lds
    s_add_u32 m0, s64, 65536
    s_mov_b32 s66, 0
    v_mfma_f32_16x16x32_bf16 v[0:3], v[128:131], v[96:99], v[0:3]
    buffer_load_dwordx4 v205, s[44:47], s66 offen nt lds
    buffer_load_dwordx4 v206, s[44:47], s66 offen offset:1024 nt lds
    ds_read_b64_tr_b16 v[136:137], v194
    v_mfma_f32_16x16x32_bf16 v[32:35], v[128:131], v[100:103], v[32:35]
    ds_read_b64_tr_b16 v[138:139], v194 offset:1024
    s_waitcnt lgkmcnt(2)
    v_mfma_f32_16x16x32_bf16 v[64:67], v[128:131], v[104:107], v[64:67]
    ds_read_b64_tr_b16 v[140:141], v195
    v_mfma_f32_16x16x32_bf16 v[4:7], v[132:135], v[96:99], v[4:7]
    ds_read_b64_tr_b16 v[142:143], v195 offset:1024
    v_mfma_f32_16x16x32_bf16 v[36:39], v[132:135], v[100:103], v[36:39]
    ds_read_b64_tr_b16 v[120:121], v196
    s_waitcnt lgkmcnt(3)
    v_mfma_f32_16x16x32_bf16 v[68:71], v[132:135], v[104:107], v[68:71]
    ds_read_b64_tr_b16 v[124:125], v197
    v_mfma_f32_16x16x32_bf16 v[8:11], v[136:139], v[96:99], v[8:11]
    ds_read_b64_tr_b16 v[128:129], v198
    ds_read_b64_tr_b16 v[132:133], v199
    v_mfma_f32_16x16x32_bf16 v[40:43], v[136:139], v[100:103], v[40:43]
    ds_read_b64_tr_b16 v[122:123], v196 offset:1024
    s_waitcnt lgkmcnt(5)
    ds_read_b64_tr_b16 v[126:127], v197 offset:1024
    ds_read_b64_tr_b16 v[130:131], v198 offset:1024
    ds_read_b64_tr_b16 v[134:135], v199 offset:1024
    v_mfma_f32_16x16x32_bf16 v[72:75], v[136:139], v[104:107], v[72:75]
    ds_read_b128 v[108:111], v169
    v_mfma_f32_16x16x32_bf16 v[12:15], v[140:143], v[96:99], v[12:15]
    ds_read_b128 v[112:115], v169 offset:2048
    v_mfma_f32_16x16x32_bf16 v[44:47], v[140:143], v[100:103], v[44:47]
    ds_read_b128 v[116:119], v169 offset:4096
    s_waitcnt lgkmcnt(6)
    v_mfma_f32_16x16x32_bf16 v[76:79], v[140:143], v[104:107], v[76:79]
    s_add_u32 m0, s64, 0
    s_mov_b32 s66, 2097152
    s_mov_b32 s67, 2128896
    v_mfma_f32_16x16x32_bf16 v[16:19], v[120:123], v[96:99], v[16:19]
    s_waitcnt lgkmcnt(3)
    s_waitcnt vmcnt(9)
    s_barrier
    v_mfma_f32_16x16x32_bf16 v[48:51], v[120:123], v[100:103], v[48:51]
    ds_read_b64_tr_b16 v[136:137], v192 offset:8192
    v_mfma_f32_16x16x32_bf16 v[80:83], v[120:123], v[104:107], v[80:83]
    ds_read_b64_tr_b16 v[138:139], v192 offset:9216
    v_mfma_f32_16x16x32_bf16 v[20:23], v[124:127], v[96:99], v[20:23]
    buffer_load_dwordx4 v204, s[40:43], s66 offen lds
    v_mfma_f32_16x16x32_bf16 v[52:55], v[124:127], v[100:103], v[52:55]
    ds_read_b64_tr_b16 v[140:141], v193 offset:8192
    v_mfma_f32_16x16x32_bf16 v[84:87], v[124:127], v[104:107], v[84:87]
    ds_read_b64_tr_b16 v[142:143], v193 offset:9216
    v_mfma_f32_16x16x32_bf16 v[24:27], v[128:131], v[96:99], v[24:27]
    buffer_load_dwordx4 v204, s[40:43], s67 offen offset:1024 lds
    v_mfma_f32_16x16x32_bf16 v[56:59], v[128:131], v[100:103], v[56:59]
    ds_read_b64_tr_b16 v[120:121], v194 offset:8192
    v_mfma_f32_16x16x32_bf16 v[88:91], v[128:131], v[104:107], v[88:91]
    ds_read_b64_tr_b16 v[122:123], v194 offset:9216
    v_mfma_f32_16x16x32_bf16 v[28:31], v[132:135], v[96:99], v[28:31]
    ds_read_b64_tr_b16 v[124:125], v195 offset:8192
    v_mfma_f32_16x16x32_bf16 v[60:63], v[132:135], v[100:103], v[60:63]
    ds_read_b64_tr_b16 v[126:127], v195 offset:9216
    s_waitcnt lgkmcnt(8)
    v_mfma_f32_16x16x32_bf16 v[92:95], v[132:135], v[104:107], v[92:95]
    ds_read_b64_tr_b16 v[128:129], v196 offset:8192
    s_waitcnt lgkmcnt(7)
    v_mfma_f32_16x16x32_bf16 v[0:3], v[136:139], v[108:111], v[0:3]
    ds_read_b64_tr_b16 v[132:133], v197 offset:8192
    v_mfma_f32_16x16x32_bf16 v[32:35], v[136:139], v[112:115], v[32:35]
    ds_read_b64_tr_b16 v[130:131], v196 offset:9216
    s_waitcnt lgkmcnt(7)
    v_mfma_f32_16x16x32_bf16 v[64:67], v[136:139], v[116:119], v[64:67]
    ds_read_b64_tr_b16 v[136:137], v198 offset:8192
    v_mfma_f32_16x16x32_bf16 v[4:7], v[140:143], v[108:111], v[4:7]
    ds_read_b64_tr_b16 v[134:135], v197 offset:9216
    v_mfma_f32_16x16x32_bf16 v[36:39], v[140:143], v[112:115], v[36:39]
    ds_read_b64_tr_b16 v[138:139], v198 offset:9216
    s_waitcnt lgkmcnt(8)
    v_mfma_f32_16x16x32_bf16 v[68:71], v[140:143], v[116:119], v[68:71]
    ds_read_b64_tr_b16 v[140:141], v199 offset:8192
    v_mfma_f32_16x16x32_bf16 v[8:11], v[120:123], v[108:111], v[8:11]
    ds_read_b64_tr_b16 v[142:143], v199 offset:9216
    v_mfma_f32_16x16x32_bf16 v[40:43], v[120:123], v[112:115], v[40:43]
    s_waitcnt lgkmcnt(8)
    v_mfma_f32_16x16x32_bf16 v[72:75], v[120:123], v[116:119], v[72:75]
    v_mfma_f32_16x16x32_bf16 v[12:15], v[124:127], v[108:111], v[12:15]
    v_mfma_f32_16x16x32_bf16 v[44:47], v[124:127], v[112:115], v[44:47]
    s_waitcnt lgkmcnt(5)
    s_add_u32 m0, s65, 32768
    s_mov_b32 s74, 512
    v_mfma_f32_16x16x32_bf16 v[76:79], v[124:127], v[116:119], v[76:79]
    s_mov_b32 s18, 16896
    v_mfma_f32_16x16x32_bf16 v[16:19], v[128:131], v[108:111], v[16:19]
    s_waitcnt lgkmcnt(0)
    s_waitcnt vmcnt(6)
    s_barrier
    v_mfma_f32_16x16x32_bf16 v[48:51], v[128:131], v[112:115], v[48:51]
    ds_read_b64_tr_b16 v[120:121], v192 offset:16384
    v_mfma_f32_16x16x32_bf16 v[80:83], v[128:131], v[116:119], v[80:83]
    buffer_load_dwordx4 v180, s[36:39], s74 offen lds
    v_mfma_f32_16x16x32_bf16 v[20:23], v[132:135], v[108:111], v[20:23]
    ds_read_b128 v[96:99], v170
    v_mfma_f32_16x16x32_bf16 v[52:55], v[132:135], v[112:115], v[52:55]
    ds_read_b64_tr_b16 v[122:123], v192 offset:17408
    v_mfma_f32_16x16x32_bf16 v[84:87], v[132:135], v[116:119], v[84:87]
    ds_read_b128 v[100:103], v170 offset:2048
    v_mfma_f32_16x16x32_bf16 v[24:27], v[136:139], v[108:111], v[24:27]
    buffer_load_dwordx4 v181, s[36:39], s74 offen offset:1024 lds
    v_mfma_f32_16x16x32_bf16 v[56:59], v[136:139], v[112:115], v[56:59]
    ds_read_b128 v[104:107], v170 offset:4096
    v_mfma_f32_16x16x32_bf16 v[88:91], v[136:139], v[116:119], v[88:91]
    ds_read_b64_tr_b16 v[124:125], v193 offset:16384
    v_mfma_f32_16x16x32_bf16 v[28:31], v[140:143], v[108:111], v[28:31]
    ds_read_b64_tr_b16 v[126:127], v193 offset:17408
    v_mfma_f32_16x16x32_bf16 v[60:63], v[140:143], v[112:115], v[60:63]
    s_waitcnt lgkmcnt(2)
    buffer_load_dwordx4 v180, s[36:39], s18 offen offset:2048 lds
    s_add_u32 m0, s64, 8192
    s_mov_b32 s66, 2359296
    s_mov_b32 s67, 2391040
    v_mfma_f32_16x16x32_bf16 v[92:95], v[140:143], v[116:119], v[92:95]
    buffer_load_dwordx4 v204, s[40:43], s66 offen lds
    buffer_load_dwordx4 v204, s[40:43], s67 offen offset:1024 lds
    s_add_u32 m0, s64, 73728
    s_mov_b32 s66, 8192
    v_mfma_f32_16x16x32_bf16 v[0:3], v[120:123], v[96:99], v[0:3]
    buffer_load_dwordx4 v205, s[44:47], s66 offen nt lds
    buffer_load_dwordx4 v206, s[44:47], s66 offen offset:1024 nt lds
    ds_read_b64_tr_b16 v[128:129], v194 offset:16384
    v_mfma_f32_16x16x32_bf16 v[32:35], v[120:123], v[100:103], v[32:35]
    ds_read_b64_tr_b16 v[130:131], v194 offset:17408
    s_waitcnt lgkmcnt(2)
    v_mfma_f32_16x16x32_bf16 v[64:67], v[120:123], v[104:107], v[64:67]
    ds_read_b64_tr_b16 v[132:133], v195 offset:16384
    v_mfma_f32_16x16x32_bf16 v[4:7], v[124:127], v[96:99], v[4:7]
    ds_read_b64_tr_b16 v[134:135], v195 offset:17408
    v_mfma_f32_16x16x32_bf16 v[36:39], v[124:127], v[100:103], v[36:39]
    ds_read_b64_tr_b16 v[136:137], v196 offset:16384
    s_waitcnt lgkmcnt(3)
    v_mfma_f32_16x16x32_bf16 v[68:71], v[124:127], v[104:107], v[68:71]
    ds_read_b64_tr_b16 v[140:141], v197 offset:16384
    v_mfma_f32_16x16x32_bf16 v[8:11], v[128:131], v[96:99], v[8:11]
    ds_read_b64_tr_b16 v[120:121], v198 offset:16384
    ds_read_b64_tr_b16 v[124:125], v199 offset:16384
    v_mfma_f32_16x16x32_bf16 v[40:43], v[128:131], v[100:103], v[40:43]
    ds_read_b64_tr_b16 v[138:139], v196 offset:17408
    s_waitcnt lgkmcnt(5)
    ds_read_b64_tr_b16 v[142:143], v197 offset:17408
    ds_read_b64_tr_b16 v[122:123], v198 offset:17408
    ds_read_b64_tr_b16 v[126:127], v199 offset:17408
    v_mfma_f32_16x16x32_bf16 v[72:75], v[128:131], v[104:107], v[72:75]
    ds_read_b128 v[108:111], v171
    v_mfma_f32_16x16x32_bf16 v[12:15], v[132:135], v[96:99], v[12:15]
    ds_read_b128 v[112:115], v171 offset:2048
    v_mfma_f32_16x16x32_bf16 v[44:47], v[132:135], v[100:103], v[44:47]
    ds_read_b128 v[116:119], v171 offset:4096
    s_waitcnt lgkmcnt(6)
    v_mfma_f32_16x16x32_bf16 v[76:79], v[132:135], v[104:107], v[76:79]
    s_add_u32 m0, s64, 16384
    s_mov_b32 s66, 2621440
    s_mov_b32 s67, 2653184
    v_mfma_f32_16x16x32_bf16 v[16:19], v[136:139], v[96:99], v[16:19]
    s_waitcnt lgkmcnt(3)
    s_waitcnt vmcnt(11)
    s_barrier
    v_mfma_f32_16x16x32_bf16 v[48:51], v[136:139], v[100:103], v[48:51]
    ds_read_b64_tr_b16 v[128:129], v192 offset:24576
    v_mfma_f32_16x16x32_bf16 v[80:83], v[136:139], v[104:107], v[80:83]
    ds_read_b64_tr_b16 v[130:131], v192 offset:25600
    v_mfma_f32_16x16x32_bf16 v[20:23], v[140:143], v[96:99], v[20:23]
    buffer_load_dwordx4 v204, s[40:43], s66 offen lds
    v_mfma_f32_16x16x32_bf16 v[52:55], v[140:143], v[100:103], v[52:55]
    ds_read_b64_tr_b16 v[132:133], v193 offset:24576
    v_mfma_f32_16x16x32_bf16 v[84:87], v[140:143], v[104:107], v[84:87]
    ds_read_b64_tr_b16 v[134:135], v193 offset:25600
    v_mfma_f32_16x16x32_bf16 v[24:27], v[120:123], v[96:99], v[24:27]
    buffer_load_dwordx4 v204, s[40:43], s67 offen offset:1024 lds
    v_mfma_f32_16x16x32_bf16 v[56:59], v[120:123], v[100:103], v[56:59]
    ds_read_b64_tr_b16 v[136:137], v194 offset:24576
    v_mfma_f32_16x16x32_bf16 v[88:91], v[120:123], v[104:107], v[88:91]
    ds_read_b64_tr_b16 v[138:139], v194 offset:25600
    v_mfma_f32_16x16x32_bf16 v[28:31], v[124:127], v[96:99], v[28:31]
    ds_read_b64_tr_b16 v[140:141], v195 offset:24576
    v_mfma_f32_16x16x32_bf16 v[60:63], v[124:127], v[100:103], v[60:63]
    ds_read_b64_tr_b16 v[142:143], v195 offset:25600
    s_waitcnt lgkmcnt(8)
    v_mfma_f32_16x16x32_bf16 v[92:95], v[124:127], v[104:107], v[92:95]
    ds_read_b64_tr_b16 v[120:121], v196 offset:24576
    s_waitcnt lgkmcnt(7)
    v_mfma_f32_16x16x32_bf16 v[0:3], v[128:131], v[108:111], v[0:3]
    ds_read_b64_tr_b16 v[124:125], v197 offset:24576
    v_mfma_f32_16x16x32_bf16 v[32:35], v[128:131], v[112:115], v[32:35]
    ds_read_b64_tr_b16 v[122:123], v196 offset:25600
    s_waitcnt lgkmcnt(7)
    v_mfma_f32_16x16x32_bf16 v[64:67], v[128:131], v[116:119], v[64:67]
    ds_read_b64_tr_b16 v[128:129], v198 offset:24576
    v_mfma_f32_16x16x32_bf16 v[4:7], v[132:135], v[108:111], v[4:7]
    ds_read_b64_tr_b16 v[126:127], v197 offset:25600
    v_mfma_f32_16x16x32_bf16 v[36:39], v[132:135], v[112:115], v[36:39]
    ds_read_b64_tr_b16 v[130:131], v198 offset:25600
    s_waitcnt lgkmcnt(8)
    v_mfma_f32_16x16x32_bf16 v[68:71], v[132:135], v[116:119], v[68:71]
    ds_read_b64_tr_b16 v[132:133], v199 offset:24576
    v_mfma_f32_16x16x32_bf16 v[8:11], v[136:139], v[108:111], v[8:11]
    ds_read_b64_tr_b16 v[134:135], v199 offset:25600
    v_mfma_f32_16x16x32_bf16 v[40:43], v[136:139], v[112:115], v[40:43]
    s_waitcnt lgkmcnt(8)
    v_mfma_f32_16x16x32_bf16 v[72:75], v[136:139], v[116:119], v[72:75]
    v_mfma_f32_16x16x32_bf16 v[12:15], v[140:143], v[108:111], v[12:15]
    v_mfma_f32_16x16x32_bf16 v[44:47], v[140:143], v[112:115], v[44:47]
    s_waitcnt lgkmcnt(5)
    s_add_u32 m0, s65, 114688
    s_mov_b32 s74, 640
    v_mfma_f32_16x16x32_bf16 v[76:79], v[140:143], v[116:119], v[76:79]
    s_mov_b32 s18, 17024
    v_mfma_f32_16x16x32_bf16 v[16:19], v[120:123], v[108:111], v[16:19]
    s_waitcnt lgkmcnt(0)
    s_waitcnt vmcnt(6)
    s_barrier
    v_mfma_f32_16x16x32_bf16 v[48:51], v[120:123], v[112:115], v[48:51]
    ds_read_b64_tr_b16 v[136:137], v192
    v_mfma_f32_16x16x32_bf16 v[80:83], v[120:123], v[116:119], v[80:83]
    buffer_load_dwordx4 v180, s[36:39], s74 offen lds
    v_mfma_f32_16x16x32_bf16 v[20:23], v[124:127], v[108:111], v[20:23]
    ds_read_b128 v[96:99], v168
    v_mfma_f32_16x16x32_bf16 v[52:55], v[124:127], v[112:115], v[52:55]
    ds_read_b64_tr_b16 v[138:139], v192 offset:1024
    v_mfma_f32_16x16x32_bf16 v[84:87], v[124:127], v[116:119], v[84:87]
    ds_read_b128 v[100:103], v168 offset:2048
    v_mfma_f32_16x16x32_bf16 v[24:27], v[128:131], v[108:111], v[24:27]
    buffer_load_dwordx4 v181, s[36:39], s74 offen offset:1024 lds
    v_mfma_f32_16x16x32_bf16 v[56:59], v[128:131], v[112:115], v[56:59]
    ds_read_b128 v[104:107], v168 offset:4096
    v_mfma_f32_16x16x32_bf16 v[88:91], v[128:131], v[116:119], v[88:91]
    ds_read_b64_tr_b16 v[140:141], v193
    v_mfma_f32_16x16x32_bf16 v[28:31], v[132:135], v[108:111], v[28:31]
    ds_read_b64_tr_b16 v[142:143], v193 offset:1024
    v_mfma_f32_16x16x32_bf16 v[60:63], v[132:135], v[112:115], v[60:63]
    s_waitcnt lgkmcnt(2)
    buffer_load_dwordx4 v180, s[36:39], s18 offen offset:2048 lds
    s_add_u32 m0, s64, 24576
    s_mov_b32 s66, 2883584
    s_mov_b32 s67, 2915328
    v_mfma_f32_16x16x32_bf16 v[92:95], v[132:135], v[116:119], v[92:95]
    buffer_load_dwordx4 v204, s[40:43], s66 offen lds
    buffer_load_dwordx4 v204, s[40:43], s67 offen offset:1024 lds
    s_add_u32 m0, s64, 57344
    s_mov_b32 s67, 0
    v_mfma_f32_16x16x32_bf16 v[0:3], v[136:139], v[96:99], v[0:3]
    buffer_load_dwordx4 v205, s[48:51], s67 offen nt lds
    buffer_load_dwordx4 v206, s[48:51], s67 offen offset:1024 nt lds
    ds_read_b64_tr_b16 v[120:121], v194
    v_mfma_f32_16x16x32_bf16 v[32:35], v[136:139], v[100:103], v[32:35]
    ds_read_b64_tr_b16 v[122:123], v194 offset:1024
    s_waitcnt lgkmcnt(2)
    v_mfma_f32_16x16x32_bf16 v[64:67], v[136:139], v[104:107], v[64:67]
    ds_read_b64_tr_b16 v[124:125], v195
    v_mfma_f32_16x16x32_bf16 v[4:7], v[140:143], v[96:99], v[4:7]
    ds_read_b64_tr_b16 v[126:127], v195 offset:1024
    v_mfma_f32_16x16x32_bf16 v[36:39], v[140:143], v[100:103], v[36:39]
    ds_read_b64_tr_b16 v[128:129], v196
    s_waitcnt lgkmcnt(3)
    v_mfma_f32_16x16x32_bf16 v[68:71], v[140:143], v[104:107], v[68:71]
    ds_read_b64_tr_b16 v[132:133], v197
    v_mfma_f32_16x16x32_bf16 v[8:11], v[120:123], v[96:99], v[8:11]
    ds_read_b64_tr_b16 v[136:137], v198
    ds_read_b64_tr_b16 v[140:141], v199
    v_mfma_f32_16x16x32_bf16 v[40:43], v[120:123], v[100:103], v[40:43]
    ds_read_b64_tr_b16 v[130:131], v196 offset:1024
    s_waitcnt lgkmcnt(5)
    ds_read_b64_tr_b16 v[134:135], v197 offset:1024
    ds_read_b64_tr_b16 v[138:139], v198 offset:1024
    ds_read_b64_tr_b16 v[142:143], v199 offset:1024
    v_mfma_f32_16x16x32_bf16 v[72:75], v[120:123], v[104:107], v[72:75]
    ds_read_b128 v[108:111], v169
    v_mfma_f32_16x16x32_bf16 v[12:15], v[124:127], v[96:99], v[12:15]
    ds_read_b128 v[112:115], v169 offset:2048
    v_mfma_f32_16x16x32_bf16 v[44:47], v[124:127], v[100:103], v[44:47]
    ds_read_b128 v[116:119], v169 offset:4096
    s_waitcnt lgkmcnt(6)
    v_mfma_f32_16x16x32_bf16 v[76:79], v[124:127], v[104:107], v[76:79]
    s_add_u32 m0, s64, 0
    s_mov_b32 s66, 3145728
    s_mov_b32 s67, 3177472
    v_mfma_f32_16x16x32_bf16 v[16:19], v[128:131], v[96:99], v[16:19]
    s_waitcnt lgkmcnt(3)
    s_waitcnt vmcnt(11)
    s_barrier
    v_mfma_f32_16x16x32_bf16 v[48:51], v[128:131], v[100:103], v[48:51]
    ds_read_b64_tr_b16 v[120:121], v192 offset:8192
    v_mfma_f32_16x16x32_bf16 v[80:83], v[128:131], v[104:107], v[80:83]
    ds_read_b64_tr_b16 v[122:123], v192 offset:9216
    v_mfma_f32_16x16x32_bf16 v[20:23], v[132:135], v[96:99], v[20:23]
    buffer_load_dwordx4 v204, s[40:43], s66 offen lds
    v_mfma_f32_16x16x32_bf16 v[52:55], v[132:135], v[100:103], v[52:55]
    ds_read_b64_tr_b16 v[124:125], v193 offset:8192
    v_mfma_f32_16x16x32_bf16 v[84:87], v[132:135], v[104:107], v[84:87]
    ds_read_b64_tr_b16 v[126:127], v193 offset:9216
    v_mfma_f32_16x16x32_bf16 v[24:27], v[136:139], v[96:99], v[24:27]
    buffer_load_dwordx4 v204, s[40:43], s67 offen offset:1024 lds
    v_mfma_f32_16x16x32_bf16 v[56:59], v[136:139], v[100:103], v[56:59]
    ds_read_b64_tr_b16 v[128:129], v194 offset:8192
    v_mfma_f32_16x16x32_bf16 v[88:91], v[136:139], v[104:107], v[88:91]
    ds_read_b64_tr_b16 v[130:131], v194 offset:9216
    v_mfma_f32_16x16x32_bf16 v[28:31], v[140:143], v[96:99], v[28:31]
    ds_read_b64_tr_b16 v[132:133], v195 offset:8192
    v_mfma_f32_16x16x32_bf16 v[60:63], v[140:143], v[100:103], v[60:63]
    ds_read_b64_tr_b16 v[134:135], v195 offset:9216
    s_waitcnt lgkmcnt(8)
    v_mfma_f32_16x16x32_bf16 v[92:95], v[140:143], v[104:107], v[92:95]
    ds_read_b64_tr_b16 v[136:137], v196 offset:8192
    s_waitcnt lgkmcnt(7)
    v_mfma_f32_16x16x32_bf16 v[0:3], v[120:123], v[108:111], v[0:3]
    ds_read_b64_tr_b16 v[140:141], v197 offset:8192
    v_mfma_f32_16x16x32_bf16 v[32:35], v[120:123], v[112:115], v[32:35]
    ds_read_b64_tr_b16 v[138:139], v196 offset:9216
    s_waitcnt lgkmcnt(7)
    v_mfma_f32_16x16x32_bf16 v[64:67], v[120:123], v[116:119], v[64:67]
    ds_read_b64_tr_b16 v[120:121], v198 offset:8192
    v_mfma_f32_16x16x32_bf16 v[4:7], v[124:127], v[108:111], v[4:7]
    ds_read_b64_tr_b16 v[142:143], v197 offset:9216
    v_mfma_f32_16x16x32_bf16 v[36:39], v[124:127], v[112:115], v[36:39]
    ds_read_b64_tr_b16 v[122:123], v198 offset:9216
    s_waitcnt lgkmcnt(8)
    v_mfma_f32_16x16x32_bf16 v[68:71], v[124:127], v[116:119], v[68:71]
    ds_read_b64_tr_b16 v[124:125], v199 offset:8192
    v_mfma_f32_16x16x32_bf16 v[8:11], v[128:131], v[108:111], v[8:11]
    ds_read_b64_tr_b16 v[126:127], v199 offset:9216
    v_mfma_f32_16x16x32_bf16 v[40:43], v[128:131], v[112:115], v[40:43]
    s_waitcnt lgkmcnt(8)
    v_mfma_f32_16x16x32_bf16 v[72:75], v[128:131], v[116:119], v[72:75]
    v_mfma_f32_16x16x32_bf16 v[12:15], v[132:135], v[108:111], v[12:15]
    v_mfma_f32_16x16x32_bf16 v[44:47], v[132:135], v[112:115], v[44:47]
    s_waitcnt lgkmcnt(5)
    s_add_u32 m0, s65, 32768
    s_mov_b32 s74, 768
    v_mfma_f32_16x16x32_bf16 v[76:79], v[132:135], v[116:119], v[76:79]
    s_mov_b32 s18, 17152
    v_mfma_f32_16x16x32_bf16 v[16:19], v[136:139], v[108:111], v[16:19]
    s_waitcnt lgkmcnt(0)
    s_waitcnt vmcnt(6)
    s_barrier
    v_mfma_f32_16x16x32_bf16 v[48:51], v[136:139], v[112:115], v[48:51]
    ds_read_b64_tr_b16 v[128:129], v192 offset:16384
    v_mfma_f32_16x16x32_bf16 v[80:83], v[136:139], v[116:119], v[80:83]
    buffer_load_dwordx4 v180, s[36:39], s74 offen lds
    v_mfma_f32_16x16x32_bf16 v[20:23], v[140:143], v[108:111], v[20:23]
    ds_read_b128 v[96:99], v170
    v_mfma_f32_16x16x32_bf16 v[52:55], v[140:143], v[112:115], v[52:55]
    ds_read_b64_tr_b16 v[130:131], v192 offset:17408
    v_mfma_f32_16x16x32_bf16 v[84:87], v[140:143], v[116:119], v[84:87]
    ds_read_b128 v[100:103], v170 offset:2048
    v_mfma_f32_16x16x32_bf16 v[24:27], v[120:123], v[108:111], v[24:27]
    buffer_load_dwordx4 v181, s[36:39], s74 offen offset:1024 lds
    v_mfma_f32_16x16x32_bf16 v[56:59], v[120:123], v[112:115], v[56:59]
    ds_read_b128 v[104:107], v170 offset:4096
    v_mfma_f32_16x16x32_bf16 v[88:91], v[120:123], v[116:119], v[88:91]
    ds_read_b64_tr_b16 v[132:133], v193 offset:16384
    v_mfma_f32_16x16x32_bf16 v[28:31], v[124:127], v[108:111], v[28:31]
    ds_read_b64_tr_b16 v[134:135], v193 offset:17408
    v_mfma_f32_16x16x32_bf16 v[60:63], v[124:127], v[112:115], v[60:63]
    s_waitcnt lgkmcnt(2)
    buffer_load_dwordx4 v180, s[36:39], s18 offen offset:2048 lds
    s_add_u32 m0, s64, 8192
    s_mov_b32 s66, 3407872
    s_mov_b32 s67, 3439616
    v_mfma_f32_16x16x32_bf16 v[92:95], v[124:127], v[116:119], v[92:95]
    buffer_load_dwordx4 v204, s[40:43], s66 offen lds
    buffer_load_dwordx4 v204, s[40:43], s67 offen offset:1024 lds
    v_mfma_f32_16x16x32_bf16 v[0:3], v[128:131], v[96:99], v[0:3]
    ds_read_b64_tr_b16 v[136:137], v194 offset:16384
    v_mfma_f32_16x16x32_bf16 v[32:35], v[128:131], v[100:103], v[32:35]
    ds_read_b64_tr_b16 v[138:139], v194 offset:17408
    s_waitcnt lgkmcnt(2)
    v_mfma_f32_16x16x32_bf16 v[64:67], v[128:131], v[104:107], v[64:67]
    ds_read_b64_tr_b16 v[140:141], v195 offset:16384
    v_mfma_f32_16x16x32_bf16 v[4:7], v[132:135], v[96:99], v[4:7]
    ds_read_b64_tr_b16 v[142:143], v195 offset:17408
    v_mfma_f32_16x16x32_bf16 v[36:39], v[132:135], v[100:103], v[36:39]
    ds_read_b64_tr_b16 v[120:121], v196 offset:16384
    s_waitcnt lgkmcnt(3)
    v_mfma_f32_16x16x32_bf16 v[68:71], v[132:135], v[104:107], v[68:71]
    ds_read_b64_tr_b16 v[124:125], v197 offset:16384
    v_mfma_f32_16x16x32_bf16 v[8:11], v[136:139], v[96:99], v[8:11]
    ds_read_b64_tr_b16 v[128:129], v198 offset:16384
    ds_read_b64_tr_b16 v[132:133], v199 offset:16384
    v_mfma_f32_16x16x32_bf16 v[40:43], v[136:139], v[100:103], v[40:43]
    ds_read_b64_tr_b16 v[122:123], v196 offset:17408
    s_waitcnt lgkmcnt(5)
    ds_read_b64_tr_b16 v[126:127], v197 offset:17408
    ds_read_b64_tr_b16 v[130:131], v198 offset:17408
    ds_read_b64_tr_b16 v[134:135], v199 offset:17408
    v_mfma_f32_16x16x32_bf16 v[72:75], v[136:139], v[104:107], v[72:75]
    ds_read_b128 v[108:111], v171
    v_mfma_f32_16x16x32_bf16 v[12:15], v[140:143], v[96:99], v[12:15]
    ds_read_b128 v[112:115], v171 offset:2048
    v_mfma_f32_16x16x32_bf16 v[44:47], v[140:143], v[100:103], v[44:47]
    ds_read_b128 v[116:119], v171 offset:4096
    s_waitcnt lgkmcnt(6)
    v_mfma_f32_16x16x32_bf16 v[76:79], v[140:143], v[104:107], v[76:79]
    s_add_u32 m0, s64, 16384
    s_mov_b32 s66, 3670016
    s_mov_b32 s67, 3701760
    v_mfma_f32_16x16x32_bf16 v[16:19], v[120:123], v[96:99], v[16:19]
    s_waitcnt lgkmcnt(3)
    s_waitcnt vmcnt(9)
    s_barrier
    v_mfma_f32_16x16x32_bf16 v[48:51], v[120:123], v[100:103], v[48:51]
    ds_read_b64_tr_b16 v[136:137], v192 offset:24576
    v_mfma_f32_16x16x32_bf16 v[80:83], v[120:123], v[104:107], v[80:83]
    ds_read_b64_tr_b16 v[138:139], v192 offset:25600
    v_mfma_f32_16x16x32_bf16 v[20:23], v[124:127], v[96:99], v[20:23]
    buffer_load_dwordx4 v204, s[40:43], s66 offen lds
    v_mfma_f32_16x16x32_bf16 v[52:55], v[124:127], v[100:103], v[52:55]
    ds_read_b64_tr_b16 v[140:141], v193 offset:24576
    v_mfma_f32_16x16x32_bf16 v[84:87], v[124:127], v[104:107], v[84:87]
    ds_read_b64_tr_b16 v[142:143], v193 offset:25600
    v_mfma_f32_16x16x32_bf16 v[24:27], v[128:131], v[96:99], v[24:27]
    buffer_load_dwordx4 v204, s[40:43], s67 offen offset:1024 lds
    v_mfma_f32_16x16x32_bf16 v[56:59], v[128:131], v[100:103], v[56:59]
    ds_read_b64_tr_b16 v[120:121], v194 offset:24576
    v_mfma_f32_16x16x32_bf16 v[88:91], v[128:131], v[104:107], v[88:91]
    ds_read_b64_tr_b16 v[122:123], v194 offset:25600
    v_mfma_f32_16x16x32_bf16 v[28:31], v[132:135], v[96:99], v[28:31]
    ds_read_b64_tr_b16 v[124:125], v195 offset:24576
    v_mfma_f32_16x16x32_bf16 v[60:63], v[132:135], v[100:103], v[60:63]
    ds_read_b64_tr_b16 v[126:127], v195 offset:25600
    s_waitcnt lgkmcnt(8)
    v_mfma_f32_16x16x32_bf16 v[92:95], v[132:135], v[104:107], v[92:95]
    ds_read_b64_tr_b16 v[128:129], v196 offset:24576
    s_waitcnt lgkmcnt(7)
    v_mfma_f32_16x16x32_bf16 v[0:3], v[136:139], v[108:111], v[0:3]
    ds_read_b64_tr_b16 v[132:133], v197 offset:24576
    v_mfma_f32_16x16x32_bf16 v[32:35], v[136:139], v[112:115], v[32:35]
    ds_read_b64_tr_b16 v[130:131], v196 offset:25600
    s_waitcnt lgkmcnt(7)
    v_mfma_f32_16x16x32_bf16 v[64:67], v[136:139], v[116:119], v[64:67]
    ds_read_b64_tr_b16 v[136:137], v198 offset:24576
    v_mfma_f32_16x16x32_bf16 v[4:7], v[140:143], v[108:111], v[4:7]
    ds_read_b64_tr_b16 v[134:135], v197 offset:25600
    v_mfma_f32_16x16x32_bf16 v[36:39], v[140:143], v[112:115], v[36:39]
    ds_read_b64_tr_b16 v[138:139], v198 offset:25600
    s_waitcnt lgkmcnt(8)
    v_mfma_f32_16x16x32_bf16 v[68:71], v[140:143], v[116:119], v[68:71]
    ds_read_b64_tr_b16 v[140:141], v199 offset:24576
    v_mfma_f32_16x16x32_bf16 v[8:11], v[120:123], v[108:111], v[8:11]
    ds_read_b64_tr_b16 v[142:143], v199 offset:25600
    v_mfma_f32_16x16x32_bf16 v[40:43], v[120:123], v[112:115], v[40:43]
    s_waitcnt lgkmcnt(8)
    v_mfma_f32_16x16x32_bf16 v[72:75], v[120:123], v[116:119], v[72:75]
    v_mfma_f32_16x16x32_bf16 v[12:15], v[124:127], v[108:111], v[12:15]
    v_mfma_f32_16x16x32_bf16 v[44:47], v[124:127], v[112:115], v[44:47]
    s_waitcnt lgkmcnt(5)
    s_add_u32 m0, s65, 114688
    s_mov_b32 s74, 896
    v_mfma_f32_16x16x32_bf16 v[76:79], v[124:127], v[116:119], v[76:79]
    s_mov_b32 s18, 17280
    v_mfma_f32_16x16x32_bf16 v[16:19], v[128:131], v[108:111], v[16:19]
    s_waitcnt lgkmcnt(0)
    s_waitcnt vmcnt(4)
    s_barrier
    v_mfma_f32_16x16x32_bf16 v[48:51], v[128:131], v[112:115], v[48:51]
    ds_read_b64_tr_b16 v[120:121], v192
    v_mfma_f32_16x16x32_bf16 v[80:83], v[128:131], v[116:119], v[80:83]
    buffer_load_dwordx4 v180, s[36:39], s74 offen lds
    v_mfma_f32_16x16x32_bf16 v[20:23], v[132:135], v[108:111], v[20:23]
    ds_read_b128 v[96:99], v168
    v_mfma_f32_16x16x32_bf16 v[52:55], v[132:135], v[112:115], v[52:55]
    ds_read_b64_tr_b16 v[122:123], v192 offset:1024
    v_mfma_f32_16x16x32_bf16 v[84:87], v[132:135], v[116:119], v[84:87]
    ds_read_b128 v[100:103], v168 offset:2048
    v_mfma_f32_16x16x32_bf16 v[24:27], v[136:139], v[108:111], v[24:27]
    buffer_load_dwordx4 v181, s[36:39], s74 offen offset:1024 lds
    v_mfma_f32_16x16x32_bf16 v[56:59], v[136:139], v[112:115], v[56:59]
    ds_read_b128 v[104:107], v168 offset:4096
    v_mfma_f32_16x16x32_bf16 v[88:91], v[136:139], v[116:119], v[88:91]
    ds_read_b64_tr_b16 v[124:125], v193
    v_mfma_f32_16x16x32_bf16 v[28:31], v[140:143], v[108:111], v[28:31]
    ds_read_b64_tr_b16 v[126:127], v193 offset:1024
    v_mfma_f32_16x16x32_bf16 v[60:63], v[140:143], v[112:115], v[60:63]
    s_waitcnt lgkmcnt(2)
    buffer_load_dwordx4 v180, s[36:39], s18 offen offset:2048 lds
    s_add_u32 m0, s64, 24576
    s_mov_b32 s66, 3932160
    s_mov_b32 s67, 3963904
    v_mfma_f32_16x16x32_bf16 v[92:95], v[140:143], v[116:119], v[92:95]
    buffer_load_dwordx4 v204, s[40:43], s66 offen lds
    buffer_load_dwordx4 v204, s[40:43], s67 offen offset:1024 lds
    v_mfma_f32_16x16x32_bf16 v[0:3], v[120:123], v[96:99], v[0:3]
    ds_read_b64_tr_b16 v[128:129], v194
    v_mfma_f32_16x16x32_bf16 v[32:35], v[120:123], v[100:103], v[32:35]
    ds_read_b64_tr_b16 v[130:131], v194 offset:1024
    s_waitcnt lgkmcnt(2)
    v_mfma_f32_16x16x32_bf16 v[64:67], v[120:123], v[104:107], v[64:67]
    ds_read_b64_tr_b16 v[132:133], v195
    v_mfma_f32_16x16x32_bf16 v[4:7], v[124:127], v[96:99], v[4:7]
    ds_read_b64_tr_b16 v[134:135], v195 offset:1024
    v_mfma_f32_16x16x32_bf16 v[36:39], v[124:127], v[100:103], v[36:39]
    ds_read_b64_tr_b16 v[136:137], v196
    s_waitcnt lgkmcnt(3)
    v_mfma_f32_16x16x32_bf16 v[68:71], v[124:127], v[104:107], v[68:71]
    ds_read_b64_tr_b16 v[140:141], v197
    v_mfma_f32_16x16x32_bf16 v[8:11], v[128:131], v[96:99], v[8:11]
    ds_read_b64_tr_b16 v[120:121], v198
    ds_read_b64_tr_b16 v[124:125], v199
    v_mfma_f32_16x16x32_bf16 v[40:43], v[128:131], v[100:103], v[40:43]
    ds_read_b64_tr_b16 v[138:139], v196 offset:1024
    s_waitcnt lgkmcnt(5)
    ds_read_b64_tr_b16 v[142:143], v197 offset:1024
    ds_read_b64_tr_b16 v[122:123], v198 offset:1024
    ds_read_b64_tr_b16 v[126:127], v199 offset:1024
    v_mfma_f32_16x16x32_bf16 v[72:75], v[128:131], v[104:107], v[72:75]
    ds_read_b128 v[108:111], v169
    v_mfma_f32_16x16x32_bf16 v[12:15], v[132:135], v[96:99], v[12:15]
    ds_read_b128 v[112:115], v169 offset:2048
    v_mfma_f32_16x16x32_bf16 v[44:47], v[132:135], v[100:103], v[44:47]
    ds_read_b128 v[116:119], v169 offset:4096
    s_waitcnt lgkmcnt(6)
    v_mfma_f32_16x16x32_bf16 v[76:79], v[132:135], v[104:107], v[76:79]
    s_add_u32 m0, s64, 0
    s_mov_b32 s66, 4194304
    s_mov_b32 s67, 4226048
    v_mfma_f32_16x16x32_bf16 v[16:19], v[136:139], v[96:99], v[16:19]
    s_waitcnt lgkmcnt(3)
    s_waitcnt vmcnt(7)
    s_barrier
    v_mfma_f32_16x16x32_bf16 v[48:51], v[136:139], v[100:103], v[48:51]
    ds_read_b64_tr_b16 v[128:129], v192 offset:8192
    v_mfma_f32_16x16x32_bf16 v[80:83], v[136:139], v[104:107], v[80:83]
    ds_read_b64_tr_b16 v[130:131], v192 offset:9216
    v_mfma_f32_16x16x32_bf16 v[20:23], v[140:143], v[96:99], v[20:23]
    buffer_load_dwordx4 v204, s[40:43], s66 offen lds
    v_mfma_f32_16x16x32_bf16 v[52:55], v[140:143], v[100:103], v[52:55]
    ds_read_b64_tr_b16 v[132:133], v193 offset:8192
    v_mfma_f32_16x16x32_bf16 v[84:87], v[140:143], v[104:107], v[84:87]
    ds_read_b64_tr_b16 v[134:135], v193 offset:9216
    v_mfma_f32_16x16x32_bf16 v[24:27], v[120:123], v[96:99], v[24:27]
    buffer_load_dwordx4 v204, s[40:43], s67 offen offset:1024 lds
    v_mfma_f32_16x16x32_bf16 v[56:59], v[120:123], v[100:103], v[56:59]
    ds_read_b64_tr_b16 v[136:137], v194 offset:8192
    v_mfma_f32_16x16x32_bf16 v[88:91], v[120:123], v[104:107], v[88:91]
    ds_read_b64_tr_b16 v[138:139], v194 offset:9216
    v_mfma_f32_16x16x32_bf16 v[28:31], v[124:127], v[96:99], v[28:31]
    ds_read_b64_tr_b16 v[140:141], v195 offset:8192
    v_mfma_f32_16x16x32_bf16 v[60:63], v[124:127], v[100:103], v[60:63]
    ds_read_b64_tr_b16 v[142:143], v195 offset:9216
    s_waitcnt lgkmcnt(8)
    v_mfma_f32_16x16x32_bf16 v[92:95], v[124:127], v[104:107], v[92:95]
    ds_read_b64_tr_b16 v[120:121], v196 offset:8192
    s_waitcnt lgkmcnt(7)
    v_mfma_f32_16x16x32_bf16 v[0:3], v[128:131], v[108:111], v[0:3]
    ds_read_b64_tr_b16 v[124:125], v197 offset:8192
    v_mfma_f32_16x16x32_bf16 v[32:35], v[128:131], v[112:115], v[32:35]
    ds_read_b64_tr_b16 v[122:123], v196 offset:9216
    s_waitcnt lgkmcnt(7)
    v_mfma_f32_16x16x32_bf16 v[64:67], v[128:131], v[116:119], v[64:67]
    ds_read_b64_tr_b16 v[128:129], v198 offset:8192
    v_mfma_f32_16x16x32_bf16 v[4:7], v[132:135], v[108:111], v[4:7]
    ds_read_b64_tr_b16 v[126:127], v197 offset:9216
    v_mfma_f32_16x16x32_bf16 v[36:39], v[132:135], v[112:115], v[36:39]
    ds_read_b64_tr_b16 v[130:131], v198 offset:9216
    s_waitcnt lgkmcnt(8)
    v_mfma_f32_16x16x32_bf16 v[68:71], v[132:135], v[116:119], v[68:71]
    ds_read_b64_tr_b16 v[132:133], v199 offset:8192
    v_mfma_f32_16x16x32_bf16 v[8:11], v[136:139], v[108:111], v[8:11]
    ds_read_b64_tr_b16 v[134:135], v199 offset:9216
    v_mfma_f32_16x16x32_bf16 v[40:43], v[136:139], v[112:115], v[40:43]
    s_waitcnt lgkmcnt(8)
    v_mfma_f32_16x16x32_bf16 v[72:75], v[136:139], v[116:119], v[72:75]
    v_mfma_f32_16x16x32_bf16 v[12:15], v[140:143], v[108:111], v[12:15]
    v_mfma_f32_16x16x32_bf16 v[44:47], v[140:143], v[112:115], v[44:47]
    s_waitcnt lgkmcnt(5)
    s_add_u32 m0, s65, 32768
    s_mov_b32 s74, 1024
    v_mfma_f32_16x16x32_bf16 v[76:79], v[140:143], v[116:119], v[76:79]
    s_mov_b32 s18, 17408
    v_mfma_f32_16x16x32_bf16 v[16:19], v[120:123], v[108:111], v[16:19]
    s_waitcnt lgkmcnt(0)
    s_waitcnt vmcnt(4)
    s_barrier
    v_mfma_f32_16x16x32_bf16 v[48:51], v[120:123], v[112:115], v[48:51]
    ds_read_b64_tr_b16 v[136:137], v192 offset:16384
    v_mfma_f32_16x16x32_bf16 v[80:83], v[120:123], v[116:119], v[80:83]
    buffer_load_dwordx4 v180, s[36:39], s74 offen lds
    v_mfma_f32_16x16x32_bf16 v[20:23], v[124:127], v[108:111], v[20:23]
    ds_read_b128 v[96:99], v170
    v_mfma_f32_16x16x32_bf16 v[52:55], v[124:127], v[112:115], v[52:55]
    ds_read_b64_tr_b16 v[138:139], v192 offset:17408
    v_mfma_f32_16x16x32_bf16 v[84:87], v[124:127], v[116:119], v[84:87]
    ds_read_b128 v[100:103], v170 offset:2048
    v_mfma_f32_16x16x32_bf16 v[24:27], v[128:131], v[108:111], v[24:27]
    buffer_load_dwordx4 v181, s[36:39], s74 offen offset:1024 lds
    v_mfma_f32_16x16x32_bf16 v[56:59], v[128:131], v[112:115], v[56:59]
    ds_read_b128 v[104:107], v170 offset:4096
    v_mfma_f32_16x16x32_bf16 v[88:91], v[128:131], v[116:119], v[88:91]
    ds_read_b64_tr_b16 v[140:141], v193 offset:16384
    v_mfma_f32_16x16x32_bf16 v[28:31], v[132:135], v[108:111], v[28:31]
    ds_read_b64_tr_b16 v[142:143], v193 offset:17408
    v_mfma_f32_16x16x32_bf16 v[60:63], v[132:135], v[112:115], v[60:63]
    s_waitcnt lgkmcnt(2)
    buffer_load_dwordx4 v180, s[36:39], s18 offen offset:2048 lds
    s_add_u32 m0, s64, 8192
    s_mov_b32 s66, 4456448
    s_mov_b32 s67, 4488192
    v_mfma_f32_16x16x32_bf16 v[92:95], v[132:135], v[116:119], v[92:95]
    buffer_load_dwordx4 v204, s[40:43], s66 offen lds
    buffer_load_dwordx4 v204, s[40:43], s67 offen offset:1024 lds
    v_mfma_f32_16x16x32_bf16 v[0:3], v[136:139], v[96:99], v[0:3]
    ds_read_b64_tr_b16 v[120:121], v194 offset:16384
    v_mfma_f32_16x16x32_bf16 v[32:35], v[136:139], v[100:103], v[32:35]
    ds_read_b64_tr_b16 v[122:123], v194 offset:17408
    s_waitcnt lgkmcnt(2)
    v_mfma_f32_16x16x32_bf16 v[64:67], v[136:139], v[104:107], v[64:67]
    ds_read_b64_tr_b16 v[124:125], v195 offset:16384
    v_mfma_f32_16x16x32_bf16 v[4:7], v[140:143], v[96:99], v[4:7]
    ds_read_b64_tr_b16 v[126:127], v195 offset:17408
    v_mfma_f32_16x16x32_bf16 v[36:39], v[140:143], v[100:103], v[36:39]
    ds_read_b64_tr_b16 v[128:129], v196 offset:16384
    s_waitcnt lgkmcnt(3)
    v_mfma_f32_16x16x32_bf16 v[68:71], v[140:143], v[104:107], v[68:71]
    ds_read_b64_tr_b16 v[132:133], v197 offset:16384
    v_mfma_f32_16x16x32_bf16 v[8:11], v[120:123], v[96:99], v[8:11]
    ds_read_b64_tr_b16 v[136:137], v198 offset:16384
    ds_read_b64_tr_b16 v[140:141], v199 offset:16384
    v_mfma_f32_16x16x32_bf16 v[40:43], v[120:123], v[100:103], v[40:43]
    ds_read_b64_tr_b16 v[130:131], v196 offset:17408
    s_waitcnt lgkmcnt(5)
    ds_read_b64_tr_b16 v[134:135], v197 offset:17408
    ds_read_b64_tr_b16 v[138:139], v198 offset:17408
    ds_read_b64_tr_b16 v[142:143], v199 offset:17408
    v_mfma_f32_16x16x32_bf16 v[72:75], v[120:123], v[104:107], v[72:75]
    ds_read_b128 v[108:111], v171
    v_mfma_f32_16x16x32_bf16 v[12:15], v[124:127], v[96:99], v[12:15]
    ds_read_b128 v[112:115], v171 offset:2048
    v_mfma_f32_16x16x32_bf16 v[44:47], v[124:127], v[100:103], v[44:47]
    ds_read_b128 v[116:119], v171 offset:4096
    s_waitcnt lgkmcnt(6)
    v_mfma_f32_16x16x32_bf16 v[76:79], v[124:127], v[104:107], v[76:79]
    s_add_u32 m0, s64, 16384
    s_mov_b32 s66, 16384
    v_mfma_f32_16x16x32_bf16 v[16:19], v[128:131], v[96:99], v[16:19]
    s_waitcnt lgkmcnt(3)
    s_waitcnt vmcnt(7)
    s_barrier
    v_mfma_f32_16x16x32_bf16 v[48:51], v[128:131], v[100:103], v[48:51]
    ds_read_b64_tr_b16 v[120:121], v192 offset:24576
    v_mfma_f32_16x16x32_bf16 v[80:83], v[128:131], v[104:107], v[80:83]
    buffer_load_dwordx4 v205, s[44:47], s66 offen nt lds
    v_mfma_f32_16x16x32_bf16 v[20:23], v[132:135], v[96:99], v[20:23]
    ds_read_b64_tr_b16 v[122:123], v192 offset:25600
    v_mfma_f32_16x16x32_bf16 v[52:55], v[132:135], v[100:103], v[52:55]
    buffer_load_dwordx4 v206, s[44:47], s66 offen offset:1024 nt lds
    v_mfma_f32_16x16x32_bf16 v[84:87], v[132:135], v[104:107], v[84:87]
    ds_read_b64_tr_b16 v[124:125], v193 offset:24576
    v_mfma_f32_16x16x32_bf16 v[24:27], v[136:139], v[96:99], v[24:27]
    ds_read_b64_tr_b16 v[126:127], v193 offset:25600
    v_mfma_f32_16x16x32_bf16 v[56:59], v[136:139], v[100:103], v[56:59]
    ds_read_b64_tr_b16 v[128:129], v194 offset:24576
    v_mfma_f32_16x16x32_bf16 v[88:91], v[136:139], v[104:107], v[88:91]
    ds_read_b64_tr_b16 v[130:131], v194 offset:25600
    v_mfma_f32_16x16x32_bf16 v[28:31], v[140:143], v[96:99], v[28:31]
    ds_read_b64_tr_b16 v[132:133], v195 offset:24576
    v_mfma_f32_16x16x32_bf16 v[60:63], v[140:143], v[100:103], v[60:63]
    ds_read_b64_tr_b16 v[134:135], v195 offset:25600
    s_waitcnt lgkmcnt(8)
    v_mfma_f32_16x16x32_bf16 v[92:95], v[140:143], v[104:107], v[92:95]
    ds_read_b64_tr_b16 v[136:137], v196 offset:24576
    s_waitcnt lgkmcnt(7)
    v_mfma_f32_16x16x32_bf16 v[0:3], v[120:123], v[108:111], v[0:3]
    ds_read_b64_tr_b16 v[140:141], v197 offset:24576
    v_mfma_f32_16x16x32_bf16 v[32:35], v[120:123], v[112:115], v[32:35]
    ds_read_b64_tr_b16 v[138:139], v196 offset:25600
    s_waitcnt lgkmcnt(7)
    v_mfma_f32_16x16x32_bf16 v[64:67], v[120:123], v[116:119], v[64:67]
    ds_read_b64_tr_b16 v[120:121], v198 offset:24576
    v_mfma_f32_16x16x32_bf16 v[4:7], v[124:127], v[108:111], v[4:7]
    ds_read_b64_tr_b16 v[142:143], v197 offset:25600
    v_mfma_f32_16x16x32_bf16 v[36:39], v[124:127], v[112:115], v[36:39]
    ds_read_b64_tr_b16 v[122:123], v198 offset:25600
    s_waitcnt lgkmcnt(8)
    v_mfma_f32_16x16x32_bf16 v[68:71], v[124:127], v[116:119], v[68:71]
    ds_read_b64_tr_b16 v[124:125], v199 offset:24576
    v_and_b32 v144, 15, v207
    v_mfma_f32_16x16x32_bf16 v[8:11], v[128:131], v[108:111], v[8:11]
    ds_read_b64_tr_b16 v[126:127], v199 offset:25600
    v_lshrrev_b32 v145, 4, v207
    v_mfma_f32_16x16x32_bf16 v[40:43], v[128:131], v[112:115], v[40:43]
    s_waitcnt lgkmcnt(8)
    v_and_b32 v146, 7, v207
    v_lshlrev_b32 v146, 1, v146
    v_mfma_f32_16x16x32_bf16 v[72:75], v[128:131], v[116:119], v[72:75]
    v_xor_b32 v146, v146, v145
    v_lshlrev_b32 v146, 4, v146
    v_mfma_f32_16x16x32_bf16 v[12:15], v[132:135], v[108:111], v[12:15]
    v_lshl_add_u32 v144, v144, 8, v146
    v_add_u32 v144, s75, v144
    v_mfma_f32_16x16x32_bf16 v[44:47], v[132:135], v[112:115], v[44:47]
    s_waitcnt lgkmcnt(5)
    v_add_u32 v200, 16384, v144
    v_xor_b32 v201, 64, v200
    v_mfma_f32_16x16x32_bf16 v[76:79], v[132:135], v[116:119], v[76:79]
    s_add_u32 m0, s64, 24576
    v_xor_b32 v202, 128, v200
    v_xor_b32 v203, 192, v200
    v_mfma_f32_16x16x32_bf16 v[16:19], v[136:139], v[108:111], v[16:19]
    s_mov_b32 s66, 24576
    s_waitcnt lgkmcnt(0)
    s_waitcnt vmcnt(4)
    s_barrier
    v_mfma_f32_16x16x32_bf16 v[48:51], v[136:139], v[112:115], v[48:51]
    ds_read_b64_tr_b16 v[128:129], v192
    v_mfma_f32_16x16x32_bf16 v[80:83], v[136:139], v[116:119], v[80:83]
    buffer_load_dwordx4 v205, s[44:47], s66 offen nt lds
    v_mfma_f32_16x16x32_bf16 v[20:23], v[140:143], v[108:111], v[20:23]
    ds_read_b128 v[96:99], v168
    v_mfma_f32_16x16x32_bf16 v[52:55], v[140:143], v[112:115], v[52:55]
    ds_read_b64_tr_b16 v[130:131], v192 offset:1024
    v_mfma_f32_16x16x32_bf16 v[84:87], v[140:143], v[116:119], v[84:87]
    ds_read_b128 v[100:103], v168 offset:2048
    v_mfma_f32_16x16x32_bf16 v[24:27], v[120:123], v[108:111], v[24:27]
    buffer_load_dwordx4 v206, s[44:47], s66 offen offset:1024 nt lds
    v_mfma_f32_16x16x32_bf16 v[56:59], v[120:123], v[112:115], v[56:59]
    ds_read_b128 v[104:107], v168 offset:4096
    v_mfma_f32_16x16x32_bf16 v[88:91], v[120:123], v[116:119], v[88:91]
    ds_read_b64_tr_b16 v[132:133], v193
    v_mfma_f32_16x16x32_bf16 v[28:31], v[124:127], v[108:111], v[28:31]
    ds_read_b64_tr_b16 v[134:135], v193 offset:1024
    v_mfma_f32_16x16x32_bf16 v[60:63], v[124:127], v[112:115], v[60:63]
    ds_read_b64_tr_b16 v[136:137], v194
    s_waitcnt lgkmcnt(3)
    v_mfma_f32_16x16x32_bf16 v[92:95], v[124:127], v[116:119], v[92:95]
    ds_read_b64_tr_b16 v[138:139], v194 offset:1024
    v_mfma_f32_16x16x32_bf16 v[0:3], v[128:131], v[96:99], v[0:3]
    ds_read_b64_tr_b16 v[140:141], v195
    v_mfma_f32_16x16x32_bf16 v[32:35], v[128:131], v[100:103], v[32:35]
    ds_read_b64_tr_b16 v[142:143], v195 offset:1024
    s_waitcnt lgkmcnt(4)
    v_mfma_f32_16x16x32_bf16 v[64:67], v[128:131], v[104:107], v[64:67]
    ds_read_b64_tr_b16 v[120:121], v196
    v_mfma_f32_16x16x32_bf16 v[4:7], v[132:135], v[96:99], v[4:7]
    ds_read_b64_tr_b16 v[124:125], v197
    v_mfma_f32_16x16x32_bf16 v[36:39], v[132:135], v[100:103], v[36:39]
    ds_read_b64_tr_b16 v[128:129], v198
    s_waitcnt lgkmcnt(5)
    v_mfma_f32_16x16x32_bf16 v[68:71], v[132:135], v[104:107], v[68:71]
    ds_read_b64_tr_b16 v[132:133], v199
    v_lshrrev_b32 v148, 2, v207
    v_mfma_f32_16x16x32_bf16 v[8:11], v[136:139], v[96:99], v[8:11]
    ds_read_b64_tr_b16 v[122:123], v196 offset:1024
    v_and_b32 v149, 7, v148
    v_mfma_f32_16x16x32_bf16 v[40:43], v[136:139], v[100:103], v[40:43]
    ds_read_b64_tr_b16 v[126:127], v197 offset:1024
    s_waitcnt lgkmcnt(6)
    ds_read_b64_tr_b16 v[130:131], v198 offset:1024
    ds_read_b64_tr_b16 v[134:135], v199 offset:1024
    v_mfma_f32_16x16x32_bf16 v[72:75], v[136:139], v[104:107], v[72:75]
    ds_read_b128 v[108:111], v169
    v_lshlrev_b32 v149, 5, v149
    v_mfma_f32_16x16x32_bf16 v[12:15], v[140:143], v[96:99], v[12:15]
    ds_read_b128 v[112:115], v169 offset:2048
    v_and_b32 v150, 3, v207
    v_mfma_f32_16x16x32_bf16 v[44:47], v[140:143], v[100:103], v[44:47]
    ds_read_b128 v[116:119], v169 offset:4096
    s_waitcnt lgkmcnt(6)
    v_mfma_f32_16x16x32_bf16 v[76:79], v[140:143], v[104:107], v[76:79]
    s_add_u32 m0, s64, 0
    v_lshlrev_b32 v150, 3, v150
    v_lshlrev_b32 v148, 8, v148
    v_mfma_f32_16x16x32_bf16 v[16:19], v[120:123], v[96:99], v[16:19]
    s_mov_b32 s67, 8192
    v_add3_u32 v148, v148, v149, v150
    v_add_u32 v148, s75, v148
    s_waitcnt lgkmcnt(3)
    s_waitcnt vmcnt(4)
    s_barrier
    v_mfma_f32_16x16x32_bf16 v[48:51], v[120:123], v[100:103], v[48:51]
    ds_read_b64_tr_b16 v[136:137], v192 offset:8192
    v_mfma_f32_16x16x32_bf16 v[80:83], v[120:123], v[104:107], v[80:83]
    buffer_load_dwordx4 v205, s[48:51], s67 offen nt lds
    v_mfma_f32_16x16x32_bf16 v[20:23], v[124:127], v[96:99], v[20:23]
    ds_read_b64_tr_b16 v[138:139], v192 offset:9216
    v_mfma_f32_16x16x32_bf16 v[52:55], v[124:127], v[100:103], v[52:55]
    buffer_load_dwordx4 v206, s[48:51], s67 offen offset:1024 nt lds
    v_mfma_f32_16x16x32_bf16 v[84:87], v[124:127], v[104:107], v[84:87]
    ds_read_b64_tr_b16 v[140:141], v193 offset:8192
    v_mfma_f32_16x16x32_bf16 v[24:27], v[128:131], v[96:99], v[24:27]
    ds_read_b64_tr_b16 v[142:143], v193 offset:9216
    v_mfma_f32_16x16x32_bf16 v[56:59], v[128:131], v[100:103], v[56:59]
    ds_read_b64_tr_b16 v[120:121], v194 offset:8192
    v_mfma_f32_16x16x32_bf16 v[88:91], v[128:131], v[104:107], v[88:91]
    ds_read_b64_tr_b16 v[122:123], v194 offset:9216
    v_mfma_f32_16x16x32_bf16 v[28:31], v[132:135], v[96:99], v[28:31]
    ds_read_b64_tr_b16 v[124:125], v195 offset:8192
    v_mfma_f32_16x16x32_bf16 v[60:63], v[132:135], v[100:103], v[60:63]
    ds_read_b64_tr_b16 v[126:127], v195 offset:9216
    s_waitcnt lgkmcnt(8)
    v_mfma_f32_16x16x32_bf16 v[92:95], v[132:135], v[104:107], v[92:95]
    ds_read_b64_tr_b16 v[128:129], v196 offset:8192
    s_waitcnt lgkmcnt(7)
    v_mfma_f32_16x16x32_bf16 v[0:3], v[136:139], v[108:111], v[0:3]
    ds_read_b64_tr_b16 v[132:133], v197 offset:8192
    v_mfma_f32_16x16x32_bf16 v[32:35], v[136:139], v[112:115], v[32:35]
    ds_read_b64_tr_b16 v[130:131], v196 offset:9216
    s_waitcnt lgkmcnt(7)
    v_mfma_f32_16x16x32_bf16 v[64:67], v[136:139], v[116:119], v[64:67]
    ds_read_b64_tr_b16 v[136:137], v198 offset:8192
    v_mfma_f32_16x16x32_bf16 v[4:7], v[140:143], v[108:111], v[4:7]
    ds_read_b64_tr_b16 v[134:135], v197 offset:9216
    v_mfma_f32_16x16x32_bf16 v[36:39], v[140:143], v[112:115], v[36:39]
    ds_read_b64_tr_b16 v[138:139], v198 offset:9216
    s_waitcnt lgkmcnt(8)
    v_mfma_f32_16x16x32_bf16 v[68:71], v[140:143], v[116:119], v[68:71]
    ds_read_b64_tr_b16 v[140:141], v199 offset:8192
    v_mfma_f32_16x16x32_bf16 v[8:11], v[120:123], v[108:111], v[8:11]
    ds_read_b64_tr_b16 v[142:143], v199 offset:9216
    v_mov_b32 v192, v148
    v_mfma_f32_16x16x32_bf16 v[40:43], v[120:123], v[112:115], v[40:43]
    s_waitcnt lgkmcnt(8)
    v_xor_b32 v193, 32, v148
    v_xor_b32 v194, 64, v148
    v_mfma_f32_16x16x32_bf16 v[72:75], v[120:123], v[116:119], v[72:75]
    v_xor_b32 v195, 96, v148
    v_xor_b32 v196, 128, v148
    v_mfma_f32_16x16x32_bf16 v[12:15], v[124:127], v[108:111], v[12:15]
    v_xor_b32 v197, 160, v148
    v_xor_b32 v198, 192, v148
    v_mfma_f32_16x16x32_bf16 v[44:47], v[124:127], v[112:115], v[44:47]
    s_waitcnt lgkmcnt(5)
    v_xor_b32 v199, 224, v148
    s_add_u32 m0, s64, 8192
    v_mfma_f32_16x16x32_bf16 v[76:79], v[124:127], v[116:119], v[76:79]
    s_mov_b32 s67, 16384
    v_mfma_f32_16x16x32_bf16 v[16:19], v[128:131], v[108:111], v[16:19]
    s_waitcnt lgkmcnt(0)
    s_barrier
    v_mfma_f32_16x16x32_bf16 v[48:51], v[128:131], v[112:115], v[48:51]
    buffer_load_dwordx4 v205, s[48:51], s67 offen nt lds
    v_mfma_f32_16x16x32_bf16 v[80:83], v[128:131], v[116:119], v[80:83]
    buffer_load_dwordx4 v206, s[48:51], s67 offen offset:1024 nt lds
    v_mfma_f32_16x16x32_bf16 v[20:23], v[132:135], v[108:111], v[20:23]
    ds_read_b128 a[16:19], v200 offset:49152
    s_add_u32 m0, s64, 32768
    v_mfma_f32_16x16x32_bf16 v[52:55], v[132:135], v[112:115], v[52:55]
    ds_read_b128 a[20:23], v201 offset:49152
    v_mfma_f32_16x16x32_bf16 v[84:87], v[132:135], v[116:119], v[84:87]
    ds_read_b128 a[24:27], v202 offset:49152
    s_mov_b32 s66, 32768
    v_mfma_f32_16x16x32_bf16 v[24:27], v[136:139], v[108:111], v[24:27]
    buffer_load_dwordx4 v205, s[44:47], s66 offen nt lds
    v_mfma_f32_16x16x32_bf16 v[56:59], v[136:139], v[112:115], v[56:59]
    buffer_load_dwordx4 v206, s[44:47], s66 offen offset:1024 nt lds
    v_mfma_f32_16x16x32_bf16 v[88:91], v[136:139], v[116:119], v[88:91]
    ds_read_b128 a[28:31], v203 offset:49152
    v_mfma_f32_16x16x32_bf16 v[28:31], v[140:143], v[108:111], v[28:31]
    v_mfma_f32_16x16x32_bf16 v[60:63], v[140:143], v[112:115], v[60:63]
    v_mfma_f32_16x16x32_bf16 v[92:95], v[140:143], v[116:119], v[92:95]
    s_waitcnt lgkmcnt(0)
    s_mov_b32 s68, 0x3e0293ee
    v_mul_f32 v0, s68, v0
    v_mul_f32 v1, s68, v1
    v_mul_f32 v2, s68, v2
    v_mul_f32 v3, s68, v3
    v_mul_f32 v4, s68, v4
    v_mul_f32 v5, s68, v5
    v_mul_f32 v6, s68, v6
    v_mul_f32 v7, s68, v7
    v_cvt_pk_bf16_f32 v144, v0, v1
    v_cvt_pk_bf16_f32 v145, v2, v3
    v_cvt_pk_bf16_f32 v146, v4, v5
    v_cvt_pk_bf16_f32 v147, v6, v7
    v_mul_f32 v8, s68, v8
    v_mul_f32 v9, s68, v9
    v_mul_f32 v10, s68, v10
    v_mul_f32 v11, s68, v11
    v_mul_f32 v12, s68, v12
    v_mul_f32 v13, s68, v13
    v_mul_f32 v14, s68, v14
    v_mul_f32 v15, s68, v15
    v_cvt_pk_bf16_f32 v148, v8, v9
    v_cvt_pk_bf16_f32 v149, v10, v11
    v_cvt_pk_bf16_f32 v150, v12, v13
    v_cvt_pk_bf16_f32 v151, v14, v15
    v_mul_f32 v16, s68, v16
    v_mul_f32 v17, s68, v17
    v_mul_f32 v18, s68, v18
    v_mul_f32 v19, s68, v19
    v_mul_f32 v20, s68, v20
    v_mul_f32 v21, s68, v21
    v_mul_f32 v22, s68, v22
    v_mul_f32 v23, s68, v23
    v_cvt_pk_bf16_f32 v152, v16, v17
    v_cvt_pk_bf16_f32 v153, v18, v19
    v_cvt_pk_bf16_f32 v154, v20, v21
    v_cvt_pk_bf16_f32 v155, v22, v23
    v_mul_f32 v24, s68, v24
    v_mul_f32 v25, s68, v25
    v_mul_f32 v26, s68, v26
    v_mul_f32 v27, s68, v27
    v_mul_f32 v28, s68, v28
    v_mul_f32 v29, s68, v29
    v_mul_f32 v30, s68, v30
    v_mul_f32 v31, s68, v31
    v_cvt_pk_bf16_f32 v156, v24, v25
    v_cvt_pk_bf16_f32 v157, v26, v27
    v_cvt_pk_bf16_f32 v158, v28, v29
    v_cvt_pk_bf16_f32 v159, v30, v31
    v_mul_f32 v32, s68, v32
    v_mul_f32 v33, s68, v33
    v_mul_f32 v34, s68, v34
    v_mul_f32 v35, s68, v35
    v_mul_f32 v36, s68, v36
    v_mul_f32 v37, s68, v37
    v_mul_f32 v38, s68, v38
    v_mul_f32 v39, s68, v39
    v_cvt_pk_bf16_f32 v160, v32, v33
    v_cvt_pk_bf16_f32 v161, v34, v35
    v_cvt_pk_bf16_f32 v162, v36, v37
    v_cvt_pk_bf16_f32 v163, v38, v39
    v_mul_f32 v40, s68, v40
    v_mul_f32 v41, s68, v41
    v_mul_f32 v42, s68, v42
    v_mul_f32 v43, s68, v43
    v_mul_f32 v44, s68, v44
    v_mul_f32 v45, s68, v45
    v_mul_f32 v46, s68, v46
    v_mul_f32 v47, s68, v47
    v_cvt_pk_bf16_f32 v164, v40, v41
    v_cvt_pk_bf16_f32 v165, v42, v43
    v_cvt_pk_bf16_f32 v166, v44, v45
    v_cvt_pk_bf16_f32 v167, v46, v47
    v_mul_f32 v48, s68, v48
    v_mul_f32 v49, s68, v49
    v_mul_f32 v50, s68, v50
    v_mul_f32 v51, s68, v51
    v_mul_f32 v52, s68, v52
    v_mul_f32 v53, s68, v53
    v_mul_f32 v54, s68, v54
    v_mul_f32 v55, s68, v55
    v_cvt_pk_bf16_f32 v168, v48, v49
    v_cvt_pk_bf16_f32 v169, v50, v51
    v_cvt_pk_bf16_f32 v170, v52, v53
    v_cvt_pk_bf16_f32 v171, v54, v55
    v_mul_f32 v56, s68, v56
    v_mul_f32 v57, s68, v57
    v_mul_f32 v58, s68, v58
    v_mul_f32 v59, s68, v59
    v_mul_f32 v60, s68, v60
    v_mul_f32 v61, s68, v61
    v_mul_f32 v62, s68, v62
    v_mul_f32 v63, s68, v63
    v_cvt_pk_bf16_f32 v172, v56, v57
    v_cvt_pk_bf16_f32 v173, v58, v59
    v_cvt_pk_bf16_f32 v174, v60, v61
    v_cvt_pk_bf16_f32 v175, v62, v63
    v_mul_f32 v64, s68, v64
    v_mul_f32 v65, s68, v65
    v_mul_f32 v66, s68, v66
    v_mul_f32 v67, s68, v67
    v_mul_f32 v68, s68, v68
    v_mul_f32 v69, s68, v69
    v_mul_f32 v70, s68, v70
    v_mul_f32 v71, s68, v71
    v_cvt_pk_bf16_f32 v176, v64, v65
    v_cvt_pk_bf16_f32 v177, v66, v67
    v_cvt_pk_bf16_f32 v178, v68, v69
    v_cvt_pk_bf16_f32 v179, v70, v71
    v_mul_f32 v72, s68, v72
    v_mul_f32 v73, s68, v73
    v_mul_f32 v74, s68, v74
    v_mul_f32 v75, s68, v75
    v_mul_f32 v76, s68, v76
    v_mul_f32 v77, s68, v77
    v_mul_f32 v78, s68, v78
    v_mul_f32 v79, s68, v79
    v_cvt_pk_bf16_f32 v180, v72, v73
    v_cvt_pk_bf16_f32 v181, v74, v75
    v_cvt_pk_bf16_f32 v182, v76, v77
    v_cvt_pk_bf16_f32 v183, v78, v79
    v_mul_f32 v80, s68, v80
    v_mul_f32 v81, s68, v81
    v_mul_f32 v82, s68, v82
    v_mul_f32 v83, s68, v83
    v_mul_f32 v84, s68, v84
    v_mul_f32 v85, s68, v85
    v_mul_f32 v86, s68, v86
    v_mul_f32 v87, s68, v87
    v_cvt_pk_bf16_f32 v184, v80, v81
    v_cvt_pk_bf16_f32 v185, v82, v83
    v_cvt_pk_bf16_f32 v186, v84, v85
    v_cvt_pk_bf16_f32 v187, v86, v87
    v_mul_f32 v88, s68, v88
    v_mul_f32 v89, s68, v89
    v_mul_f32 v90, s68, v90
    v_mul_f32 v91, s68, v91
    v_mul_f32 v92, s68, v92
    v_mul_f32 v93, s68, v93
    v_mul_f32 v94, s68, v94
    v_mul_f32 v95, s68, v95
    v_cvt_pk_bf16_f32 v188, v88, v89
    v_cvt_pk_bf16_f32 v189, v90, v91
    v_cvt_pk_bf16_f32 v190, v92, v93
    v_cvt_pk_bf16_f32 v191, v94, v95
    v_permlane32_swap_b32 v144, v146
    v_permlane32_swap_b32 v145, v147
    v_permlane32_swap_b32 v148, v150
    v_permlane32_swap_b32 v149, v151
    v_permlane32_swap_b32 v152, v154
    v_permlane32_swap_b32 v153, v155
    v_permlane32_swap_b32 v156, v158
    v_permlane32_swap_b32 v157, v159
    v_permlane16_swap_b32 v144, v146
    v_permlane16_swap_b32 v145, v147
    v_permlane16_swap_b32 v148, v150
    v_permlane16_swap_b32 v149, v151
    v_permlane16_swap_b32 v152, v154
    v_permlane16_swap_b32 v153, v155
    v_permlane16_swap_b32 v156, v158
    v_permlane16_swap_b32 v157, v159
    v_permlane32_swap_b32 v160, v162
    v_permlane32_swap_b32 v161, v163
    v_permlane32_swap_b32 v164, v166
    v_permlane32_swap_b32 v165, v167
    v_permlane32_swap_b32 v168, v170
    v_permlane32_swap_b32 v169, v171
    v_permlane32_swap_b32 v172, v174
    v_permlane32_swap_b32 v173, v175
    v_permlane16_swap_b32 v160, v162
    v_permlane16_swap_b32 v161, v163
    v_permlane16_swap_b32 v164, v166
    v_permlane16_swap_b32 v165, v167
    v_permlane16_swap_b32 v168, v170
    v_permlane16_swap_b32 v169, v171
    v_permlane16_swap_b32 v172, v174
    v_permlane16_swap_b32 v173, v175
    v_permlane32_swap_b32 v176, v178
    v_permlane32_swap_b32 v177, v179
    v_permlane32_swap_b32 v180, v182
    v_permlane32_swap_b32 v181, v183
    v_permlane32_swap_b32 v184, v186
    v_permlane32_swap_b32 v185, v187
    v_permlane32_swap_b32 v188, v190
    v_permlane32_swap_b32 v189, v191
    v_permlane16_swap_b32 v176, v178
    v_permlane16_swap_b32 v177, v179
    v_permlane16_swap_b32 v180, v182
    v_permlane16_swap_b32 v181, v183
    v_permlane16_swap_b32 v184, v186
    v_permlane16_swap_b32 v185, v187
    v_permlane16_swap_b32 v188, v190
    v_permlane16_swap_b32 v189, v191
    s_barrier
    v_mfma_f32_16x16x32_bf16 v[96:99], a[16:19], v[144:147], 0
    s_add_u32 m0, s64, 40960
    s_mov_b32 s67, 24576
    v_mfma_f32_16x16x32_bf16 v[104:107], a[16:19], v[160:163], 0
    v_mfma_f32_16x16x32_bf16 v[112:115], a[16:19], v[176:179], 0
    buffer_load_dwordx4 v205, s[48:51], s67 offen nt lds
    v_mfma_f32_16x16x32_bf16 v[96:99], a[20:23], v[148:151], v[96:99]
    ds_read_b128 a[16:19], v200 offset:53248
    v_mfma_f32_16x16x32_bf16 v[104:107], a[20:23], v[164:167], v[104:107]
    buffer_load_dwordx4 v206, s[48:51], s67 offen offset:1024 nt lds
    v_mfma_f32_16x16x32_bf16 v[112:115], a[20:23], v[180:183], v[112:115]
    ds_read_b128 a[20:23], v201 offset:53248
    v_mfma_f32_16x16x32_bf16 v[96:99], a[24:27], v[152:155], v[96:99]
    v_mfma_f32_16x16x32_bf16 v[104:107], a[24:27], v[168:171], v[104:107]
    s_add_u32 m0, s64, 49152
    s_mov_b32 s67, 32768
    v_mfma_f32_16x16x32_bf16 v[112:115], a[24:27], v[184:187], v[112:115]
    ds_read_b128 a[24:27], v202 offset:53248
    v_mfma_f32_16x16x32_bf16 v[96:99], a[28:31], v[156:159], v[96:99]
    v_mfma_f32_16x16x32_bf16 v[104:107], a[28:31], v[172:175], v[104:107]
    s_waitcnt lgkmcnt(2)
    buffer_load_dwordx4 v205, s[48:51], s67 offen nt lds
    v_mfma_f32_16x16x32_bf16 v[112:115], a[28:31], v[188:191], v[112:115]
    ds_read_b128 a[28:31], v203 offset:53248
    v_mfma_f32_16x16x32_bf16 v[100:103], a[16:19], v[144:147], 0
    buffer_load_dwordx4 v206, s[48:51], s67 offen offset:1024 nt lds
    v_mfma_f32_16x16x32_bf16 v[108:111], a[16:19], v[160:163], 0
    s_waitcnt lgkmcnt(2)
    v_exp_f32 v96, v96
    v_mfma_f32_16x16x32_bf16 v[116:119], a[16:19], v[176:179], 0
    ds_read_b128 a[16:19], v200 offset:57344
    v_mfma_f32_16x16x32_bf16 v[100:103], a[20:23], v[148:151], v[100:103]
    v_exp_f32 v97, v97
    v_mfma_f32_16x16x32_bf16 v[108:111], a[20:23], v[164:167], v[108:111]
    s_waitcnt lgkmcnt(2)
    v_exp_f32 v104, v104
    v_mfma_f32_16x16x32_bf16 v[116:119], a[20:23], v[180:183], v[116:119]
    v_exp_f32 v98, v98
    v_mfma_f32_16x16x32_bf16 v[100:103], a[24:27], v[152:155], v[100:103]
    v_exp_f32 v99, v99
    v_mfma_f32_16x16x32_bf16 v[108:111], a[24:27], v[168:171], v[108:111]
    s_waitcnt lgkmcnt(1)
    v_exp_f32 v105, v105
    v_mfma_f32_16x16x32_bf16 v[116:119], a[24:27], v[184:187], v[116:119]
    v_exp_f32 v112, v112
    v_mfma_f32_16x16x32_bf16 v[100:103], a[28:31], v[156:159], v[100:103]
    ds_read_b128 a[20:23], v201 offset:57344
    v_cvt_pk_bf16_f32 v120, v96, v97
    v_mfma_f32_16x16x32_bf16 v[108:111], a[28:31], v[172:175], v[108:111]
    s_waitcnt lgkmcnt(1)
    v_exp_f32 v106, v106
    v_exp_f32 v107, v107
    v_exp_f32 v113, v113
    v_mfma_f32_16x16x32_bf16 v[116:119], a[28:31], v[188:191], v[116:119]
    v_exp_f32 v114, v114
    v_cvt_pk_bf16_f32 v121, v98, v99
    v_cvt_pk_bf16_f32 v124, v104, v105
    v_exp_f32 v115, v115
    s_barrier
    v_mfma_f32_16x16x32_bf16 v[96:99], a[16:19], v[144:147], 0
    ds_read_b128 a[24:27], v202 offset:57344
    v_cvt_pk_bf16_f32 v125, v106, v107
    v_cvt_pk_bf16_f32 v128, v112, v113
    v_mfma_f32_16x16x32_bf16 v[104:107], a[16:19], v[160:163], 0
    ds_read_b128 a[28:31], v203 offset:57344
    v_cvt_pk_bf16_f32 v129, v114, v115
    v_mfma_f32_16x16x32_bf16 v[112:115], a[16:19], v[176:179], 0
    ds_read_b128 a[16:19], v200 offset:61440
    s_waitcnt lgkmcnt(3)
    v_mfma_f32_16x16x32_bf16 v[96:99], a[20:23], v[148:151], v[96:99]
    v_exp_f32 v100, v100
    v_mfma_f32_16x16x32_bf16 v[104:107], a[20:23], v[164:167], v[104:107]
    s_waitcnt lgkmcnt(2)
    v_exp_f32 v101, v101
    v_mfma_f32_16x16x32_bf16 v[112:115], a[20:23], v[180:183], v[112:115]
    v_exp_f32 v108, v108
    v_mfma_f32_16x16x32_bf16 v[96:99], a[24:27], v[152:155], v[96:99]
    v_exp_f32 v102, v102
    v_mfma_f32_16x16x32_bf16 v[104:107], a[24:27], v[168:171], v[104:107]
    s_waitcnt lgkmcnt(1)
    v_exp_f32 v103, v103
    v_mfma_f32_16x16x32_bf16 v[112:115], a[24:27], v[184:187], v[112:115]
    v_exp_f32 v109, v109
    v_mfma_f32_16x16x32_bf16 v[96:99], a[28:31], v[156:159], v[96:99]
    v_exp_f32 v116, v116
    v_mfma_f32_16x16x32_bf16 v[104:107], a[28:31], v[172:175], v[104:107]
    ds_read_b128 a[20:23], v201 offset:61440
    v_cvt_pk_bf16_f32 v122, v100, v101
    v_exp_f32 v110, v110
    v_exp_f32 v111, v111
    v_exp_f32 v117, v117
    v_mfma_f32_16x16x32_bf16 v[112:115], a[28:31], v[188:191], v[112:115]
    s_waitcnt lgkmcnt(1)
    v_exp_f32 v118, v118
    v_cvt_pk_bf16_f32 v123, v102, v103
    v_cvt_pk_bf16_f32 v126, v108, v109
    v_exp_f32 v119, v119
    v_mfma_f32_16x16x32_bf16 v[100:103], a[16:19], v[144:147], 0
    ds_read_b128 a[24:27], v202 offset:61440
    v_cvt_pk_bf16_f32 v127, v110, v111
    v_cvt_pk_bf16_f32 v130, v116, v117
    v_mfma_f32_16x16x32_bf16 v[108:111], a[16:19], v[160:163], 0
    ds_read_b128 a[28:31], v203 offset:61440
    v_cvt_pk_bf16_f32 v131, v118, v119
    v_mfma_f32_16x16x32_bf16 v[116:119], a[16:19], v[176:179], 0
    ds_read_b64_tr_b16 a[32:33], v192 offset:57344
    s_waitcnt lgkmcnt(3)
    v_mfma_f32_16x16x32_bf16 v[100:103], a[20:23], v[148:151], v[100:103]
    ds_read_b64_tr_b16 a[36:37], v193 offset:57344
    v_mfma_f32_16x16x32_bf16 v[108:111], a[20:23], v[164:167], v[108:111]
    ds_read_b64_tr_b16 a[40:41], v194 offset:57344
    s_waitcnt lgkmcnt(4)
    v_mfma_f32_16x16x32_bf16 v[116:119], a[20:23], v[180:183], v[116:119]
    ds_read_b64_tr_b16 a[44:45], v195 offset:57344
    v_mfma_f32_16x16x32_bf16 v[100:103], a[24:27], v[152:155], v[100:103]
    ds_read_b64_tr_b16 a[34:35], v192 offset:61440
    v_mfma_f32_16x16x32_bf16 v[108:111], a[24:27], v[168:171], v[108:111]
    ds_read_b64_tr_b16 a[38:39], v193 offset:61440
    s_waitcnt lgkmcnt(6)
    v_mfma_f32_16x16x32_bf16 v[116:119], a[24:27], v[184:187], v[116:119]
    ds_read_b64_tr_b16 a[42:43], v194 offset:61440
    v_mfma_f32_16x16x32_bf16 v[100:103], a[28:31], v[156:159], v[100:103]
    ds_read_b64_tr_b16 a[46:47], v195 offset:61440
    s_add_u32 m0, s64, 65536
    v_mfma_f32_16x16x32_bf16 v[108:111], a[28:31], v[172:175], v[108:111]
    s_mov_b32 s66, 40960
    v_exp_f32 v96, v96
    v_mfma_f32_16x16x32_bf16 v[116:119], a[28:31], v[188:191], v[116:119]
    v_exp_f32 v97, v97
    s_waitcnt vmcnt(8)
    s_barrier
    v_mfma_f32_16x16x32_bf16 a[0:3], a[12:15], v[120:123], 0
    buffer_load_dwordx4 v205, s[44:47], s66 offen nt lds
    v_mfma_f32_16x16x32_bf16 a[4:7], a[12:15], v[124:127], 0
    s_waitcnt lgkmcnt(0)
    buffer_load_dwordx4 v206, s[44:47], s66 offen offset:1024 nt lds
    v_mfma_f32_16x16x32_bf16 a[8:11], a[12:15], v[128:131], 0
    ds_read_b128 a[16:19], v200
    v_cvt_pk_bf16_f32 v132, v96, v97
    v_mfma_f32_16x16x32_bf16 v[0:3], a[32:35], v[120:123], 0
    ds_read_b128 a[20:23], v201
    v_mfma_f32_16x16x32_bf16 v[32:35], a[32:35], v[124:127], 0
    ds_read_b128 a[24:27], v202
    v_mfma_f32_16x16x32_bf16 v[64:67], a[32:35], v[128:131], 0
    ds_read_b64_tr_b16 a[32:33], v196 offset:57344
    v_mfma_f32_16x16x32_bf16 v[4:7], a[36:39], v[120:123], 0
    ds_read_b64_tr_b16 a[34:35], v196 offset:61440
    v_mfma_f32_16x16x32_bf16 v[36:39], a[36:39], v[124:127], 0
    ds_read_b128 a[28:31], v203
    v_mfma_f32_16x16x32_bf16 v[68:71], a[36:39], v[128:131], 0
    ds_read_b64_tr_b16 a[36:37], v197 offset:57344
    v_mfma_f32_16x16x32_bf16 v[8:11], a[40:43], v[120:123], 0
    ds_read_b64_tr_b16 a[38:39], v197 offset:61440
    v_mfma_f32_16x16x32_bf16 v[40:43], a[40:43], v[124:127], 0
    v_exp_f32 v104, v104
    v_mfma_f32_16x16x32_bf16 v[72:75], a[40:43], v[128:131], 0
    ds_read_b64_tr_b16 a[40:41], v198 offset:57344
    v_mfma_f32_16x16x32_bf16 v[12:15], a[44:47], v[120:123], 0
    ds_read_b64_tr_b16 a[42:43], v198 offset:61440
    v_mfma_f32_16x16x32_bf16 v[44:47], a[44:47], v[124:127], 0
    s_waitcnt lgkmcnt(5)
    v_exp_f32 v98, v98
    v_mfma_f32_16x16x32_bf16 v[76:79], a[44:47], v[128:131], 0
    ds_read_b64_tr_b16 a[44:45], v199 offset:57344
    v_mfma_f32_16x16x32_bf16 v[16:19], a[32:35], v[120:123], 0
    ds_read_b64_tr_b16 a[46:47], v199 offset:61440
    v_mfma_f32_16x16x32_bf16 v[48:51], a[32:35], v[124:127], 0
    s_waitcnt lgkmcnt(4)
    v_exp_f32 v99, v99
    v_mfma_f32_16x16x32_bf16 v[80:83], a[32:35], v[128:131], 0
    v_exp_f32 v105, v105
    v_mfma_f32_16x16x32_bf16 v[20:23], a[36:39], v[120:123], 0
    v_exp_f32 v112, v112
    v_mfma_f32_16x16x32_bf16 v[52:55], a[36:39], v[124:127], 0
    s_waitcnt lgkmcnt(2)
    v_exp_f32 v106, v106
    v_mfma_f32_16x16x32_bf16 v[84:87], a[36:39], v[128:131], 0
    v_exp_f32 v107, v107
    v_mfma_f32_16x16x32_bf16 v[24:27], a[40:43], v[120:123], 0
    v_exp_f32 v113, v113
    v_mfma_f32_16x16x32_bf16 v[56:59], a[40:43], v[124:127], 0
    s_waitcnt lgkmcnt(0)
    v_exp_f32 v114, v114
    v_mfma_f32_16x16x32_bf16 v[88:91], a[40:43], v[128:131], 0
    v_exp_f32 v115, v115
    v_mfma_f32_16x16x32_bf16 v[28:31], a[44:47], v[120:123], 0
    v_exp_f32 v100, v100
    v_mfma_f32_16x16x32_bf16 v[60:63], a[44:47], v[124:127], 0
    v_exp_f32 v101, v101
    v_mfma_f32_16x16x32_bf16 v[92:95], a[44:47], v[128:131], 0
    v_exp_f32 v108, v108
    v_cvt_pk_bf16_f32 v133, v98, v99
    v_cvt_pk_bf16_f32 v136, v104, v105
    v_mfma_f32_16x16x32_bf16 v[96:99], a[16:19], v[144:147], 0
    v_exp_f32 v102, v102
    v_cvt_pk_bf16_f32 v137, v106, v107
    v_cvt_pk_bf16_f32 v140, v112, v113
    v_mfma_f32_16x16x32_bf16 v[104:107], a[16:19], v[160:163], 0
    v_exp_f32 v103, v103
    v_cvt_pk_bf16_f32 v141, v114, v115
    v_mfma_f32_16x16x32_bf16 v[112:115], a[16:19], v[176:179], 0
    ds_read_b128 a[16:19], v200 offset:4096
    v_cvt_pk_bf16_f32 v134, v100, v101
    v_mfma_f32_16x16x32_bf16 v[96:99], a[20:23], v[148:151], v[96:99]
    v_exp_f32 v109, v109
    v_mfma_f32_16x16x32_bf16 v[104:107], a[20:23], v[164:167], v[104:107]
    v_exp_f32 v116, v116
    v_mfma_f32_16x16x32_bf16 v[112:115], a[20:23], v[180:183], v[112:115]
    ds_read_b128 a[20:23], v201 offset:4096
    v_cvt_pk_bf16_f32 v135, v102, v103
    v_mfma_f32_16x16x32_bf16 v[96:99], a[24:27], v[152:155], v[96:99]
    v_exp_f32 v110, v110
    v_mfma_f32_16x16x32_bf16 v[104:107], a[24:27], v[168:171], v[104:107]
    v_exp_f32 v111, v111
    v_mfma_f32_16x16x32_bf16 v[112:115], a[24:27], v[184:187], v[112:115]
    v_exp_f32 v117, v117
    v_mfma_f32_16x16x32_bf16 v[96:99], a[28:31], v[156:159], v[96:99]
    v_exp_f32 v118, v118
    v_mfma_f32_16x16x32_bf16 v[104:107], a[28:31], v[172:175], v[104:107]
    s_waitcnt lgkmcnt(1)
    v_exp_f32 v119, v119
    v_mfma_f32_16x16x32_bf16 v[112:115], a[28:31], v[188:191], v[112:115]
    ds_read_b128 a[24:27], v202 offset:4096
    v_cvt_pk_bf16_f32 v138, v108, v109
    v_mfma_f32_16x16x32_bf16 v[100:103], a[16:19], v[144:147], 0
    ds_read_b128 a[28:31], v203 offset:4096
    v_cvt_pk_bf16_f32 v139, v110, v111
    v_cvt_pk_bf16_f32 v142, v116, v117
    v_mfma_f32_16x16x32_bf16 v[108:111], a[16:19], v[160:163], 0
    ds_read_b64_tr_b16 a[32:33], v192
    v_cvt_pk_bf16_f32 v143, v118, v119
    v_mfma_f32_16x16x32_bf16 v[116:119], a[16:19], v[176:179], 0
    ds_read_b64_tr_b16 a[36:37], v193
    s_waitcnt lgkmcnt(4)
    v_mfma_f32_16x16x32_bf16 v[100:103], a[20:23], v[148:151], v[100:103]
    ds_read_b64_tr_b16 a[40:41], v194
    v_mfma_f32_16x16x32_bf16 v[108:111], a[20:23], v[164:167], v[108:111]
    ds_read_b64_tr_b16 a[44:45], v195
    s_waitcnt lgkmcnt(5)
    v_mfma_f32_16x16x32_bf16 v[116:119], a[20:23], v[180:183], v[116:119]
    ds_read_b64_tr_b16 a[34:35], v192 offset:4096
    v_mfma_f32_16x16x32_bf16 v[100:103], a[24:27], v[152:155], v[100:103]
    ds_read_b64_tr_b16 a[38:39], v193 offset:4096
    v_mfma_f32_16x16x32_bf16 v[108:111], a[24:27], v[168:171], v[108:111]
    ds_read_b64_tr_b16 a[42:43], v194 offset:4096
    s_waitcnt lgkmcnt(7)
    v_mfma_f32_16x16x32_bf16 v[116:119], a[24:27], v[184:187], v[116:119]
    ds_read_b64_tr_b16 a[46:47], v195 offset:4096
    v_mfma_f32_16x16x32_bf16 v[100:103], a[28:31], v[156:159], v[100:103]
    s_add_u32 m0, s64, 73728
    v_exp_f32 v96, v96
    v_mfma_f32_16x16x32_bf16 v[108:111], a[28:31], v[172:175], v[108:111]
    s_mov_b32 s66, 49152
    v_exp_f32 v97, v97
    v_mfma_f32_16x16x32_bf16 v[116:119], a[28:31], v[188:191], v[116:119]
    v_exp_f32 v104, v104
    s_waitcnt vmcnt(8)
    s_barrier
    v_mfma_f32_16x16x32_bf16 a[0:3], a[12:15], v[132:135], a[0:3]
    buffer_load_dwordx4 v205, s[44:47], s66 offen nt lds
    v_mfma_f32_16x16x32_bf16 a[4:7], a[12:15], v[136:139], a[4:7]
    s_waitcnt lgkmcnt(0)
    buffer_load_dwordx4 v206, s[44:47], s66 offen offset:1024 nt lds
    v_mfma_f32_16x16x32_bf16 a[8:11], a[12:15], v[140:143], a[8:11]
    ds_read_b128 a[16:19], v200 offset:8192
    v_cvt_pk_bf16_f32 v120, v96, v97
    v_mfma_f32_16x16x32_bf16 v[0:3], a[32:35], v[132:135], v[0:3]
    ds_read_b128 a[20:23], v201 offset:8192
    v_mfma_f32_16x16x32_bf16 v[32:35], a[32:35], v[136:139], v[32:35]
    ds_read_b128 a[24:27], v202 offset:8192
    v_mfma_f32_16x16x32_bf16 v[64:67], a[32:35], v[140:143], v[64:67]
    ds_read_b64_tr_b16 a[32:33], v196
    v_mfma_f32_16x16x32_bf16 v[4:7], a[36:39], v[132:135], v[4:7]
    ds_read_b64_tr_b16 a[34:35], v196 offset:4096
    v_mfma_f32_16x16x32_bf16 v[36:39], a[36:39], v[136:139], v[36:39]
    ds_read_b128 a[28:31], v203 offset:8192
    v_mfma_f32_16x16x32_bf16 v[68:71], a[36:39], v[140:143], v[68:71]
    ds_read_b64_tr_b16 a[36:37], v197
    v_mfma_f32_16x16x32_bf16 v[8:11], a[40:43], v[132:135], v[8:11]
    ds_read_b64_tr_b16 a[38:39], v197 offset:4096
    v_mfma_f32_16x16x32_bf16 v[40:43], a[40:43], v[136:139], v[40:43]
    v_exp_f32 v98, v98
    v_mfma_f32_16x16x32_bf16 v[72:75], a[40:43], v[140:143], v[72:75]
    ds_read_b64_tr_b16 a[40:41], v198
    v_mfma_f32_16x16x32_bf16 v[12:15], a[44:47], v[132:135], v[12:15]
    ds_read_b64_tr_b16 a[42:43], v198 offset:4096
    v_mfma_f32_16x16x32_bf16 v[44:47], a[44:47], v[136:139], v[44:47]
    s_waitcnt lgkmcnt(5)
    v_exp_f32 v99, v99
    v_mfma_f32_16x16x32_bf16 v[76:79], a[44:47], v[140:143], v[76:79]
    ds_read_b64_tr_b16 a[44:45], v199
    v_cvt_pk_bf16_f32 v121, v98, v99
    v_mfma_f32_16x16x32_bf16 v[16:19], a[32:35], v[132:135], v[16:19]
    ds_read_b64_tr_b16 a[46:47], v199 offset:4096
    v_mfma_f32_16x16x32_bf16 v[48:51], a[32:35], v[136:139], v[48:51]
    s_waitcnt lgkmcnt(4)
    v_exp_f32 v105, v105
    v_mfma_f32_16x16x32_bf16 v[80:83], a[32:35], v[140:143], v[80:83]
    v_exp_f32 v112, v112
    v_mfma_f32_16x16x32_bf16 v[20:23], a[36:39], v[132:135], v[20:23]
    v_exp_f32 v106, v106
    v_mfma_f32_16x16x32_bf16 v[52:55], a[36:39], v[136:139], v[52:55]
    s_waitcnt lgkmcnt(2)
    v_exp_f32 v107, v107
    v_mfma_f32_16x16x32_bf16 v[84:87], a[36:39], v[140:143], v[84:87]
    v_exp_f32 v113, v113
    v_mfma_f32_16x16x32_bf16 v[24:27], a[40:43], v[132:135], v[24:27]
    v_exp_f32 v114, v114
    v_mfma_f32_16x16x32_bf16 v[56:59], a[40:43], v[136:139], v[56:59]
    s_waitcnt lgkmcnt(0)
    v_exp_f32 v115, v115
    v_mfma_f32_16x16x32_bf16 v[88:91], a[40:43], v[140:143], v[88:91]
    v_exp_f32 v100, v100
    v_mfma_f32_16x16x32_bf16 v[28:31], a[44:47], v[132:135], v[28:31]
    v_exp_f32 v101, v101
    v_mfma_f32_16x16x32_bf16 v[60:63], a[44:47], v[136:139], v[60:63]
    v_exp_f32 v108, v108
    v_mfma_f32_16x16x32_bf16 v[92:95], a[44:47], v[140:143], v[92:95]
    v_exp_f32 v102, v102
    v_cvt_pk_bf16_f32 v124, v104, v105
    v_mfma_f32_16x16x32_bf16 v[96:99], a[16:19], v[144:147], 0
    v_exp_f32 v103, v103
    v_cvt_pk_bf16_f32 v125, v106, v107
    v_cvt_pk_bf16_f32 v128, v112, v113
    v_mfma_f32_16x16x32_bf16 v[104:107], a[16:19], v[160:163], 0
    v_exp_f32 v109, v109
    v_cvt_pk_bf16_f32 v129, v114, v115
    v_mfma_f32_16x16x32_bf16 v[112:115], a[16:19], v[176:179], 0
    ds_read_b128 a[16:19], v200 offset:12288
    v_cvt_pk_bf16_f32 v122, v100, v101
    v_mfma_f32_16x16x32_bf16 v[96:99], a[20:23], v[148:151], v[96:99]
    v_exp_f32 v116, v116
    v_mfma_f32_16x16x32_bf16 v[104:107], a[20:23], v[164:167], v[104:107]
    v_exp_f32 v110, v110
    v_mfma_f32_16x16x32_bf16 v[112:115], a[20:23], v[180:183], v[112:115]
    ds_read_b128 a[20:23], v201 offset:12288
    v_cvt_pk_bf16_f32 v123, v102, v103
    v_mfma_f32_16x16x32_bf16 v[96:99], a[24:27], v[152:155], v[96:99]
    v_exp_f32 v111, v111
    v_mfma_f32_16x16x32_bf16 v[104:107], a[24:27], v[168:171], v[104:107]
    v_exp_f32 v117, v117
    v_mfma_f32_16x16x32_bf16 v[112:115], a[24:27], v[184:187], v[112:115]
    v_exp_f32 v118, v118
    v_mfma_f32_16x16x32_bf16 v[96:99], a[28:31], v[156:159], v[96:99]
    v_exp_f32 v119, v119
    v_mfma_f32_16x16x32_bf16 v[104:107], a[28:31], v[172:175], v[104:107]
    ds_read_b128 a[24:27], v202 offset:12288
    s_waitcnt lgkmcnt(2)
    v_mfma_f32_16x16x32_bf16 v[112:115], a[28:31], v[188:191], v[112:115]
    ds_read_b128 a[28:31], v203 offset:12288
    v_cvt_pk_bf16_f32 v126, v108, v109
    v_mfma_f32_16x16x32_bf16 v[100:103], a[16:19], v[144:147], 0
    ds_read_b64_tr_b16 a[32:33], v192 offset:8192
    v_cvt_pk_bf16_f32 v127, v110, v111
    v_cvt_pk_bf16_f32 v130, v116, v117
    v_mfma_f32_16x16x32_bf16 v[108:111], a[16:19], v[160:163], 0
    ds_read_b64_tr_b16 a[36:37], v193 offset:8192
    v_cvt_pk_bf16_f32 v131, v118, v119
    v_mfma_f32_16x16x32_bf16 v[116:119], a[16:19], v[176:179], 0
    ds_read_b64_tr_b16 a[40:41], v194 offset:8192
    s_waitcnt lgkmcnt(5)
    v_mfma_f32_16x16x32_bf16 v[100:103], a[20:23], v[148:151], v[100:103]
    ds_read_b64_tr_b16 a[44:45], v195 offset:8192
    v_mfma_f32_16x16x32_bf16 v[108:111], a[20:23], v[164:167], v[108:111]
    ds_read_b64_tr_b16 a[34:35], v192 offset:12288
    s_waitcnt lgkmcnt(6)
    v_mfma_f32_16x16x32_bf16 v[116:119], a[20:23], v[180:183], v[116:119]
    ds_read_b64_tr_b16 a[38:39], v193 offset:12288
    v_mfma_f32_16x16x32_bf16 v[100:103], a[24:27], v[152:155], v[100:103]
    ds_read_b64_tr_b16 a[42:43], v194 offset:12288
    v_mfma_f32_16x16x32_bf16 v[108:111], a[24:27], v[168:171], v[108:111]
    ds_read_b64_tr_b16 a[46:47], v195 offset:12288
    s_waitcnt lgkmcnt(8)
    v_mfma_f32_16x16x32_bf16 v[116:119], a[24:27], v[184:187], v[116:119]
    v_exp_f32 v96, v96
    v_mfma_f32_16x16x32_bf16 v[100:103], a[28:31], v[156:159], v[100:103]
    s_add_u32 m0, s64, 16384
    v_exp_f32 v97, v97
    v_mfma_f32_16x16x32_bf16 v[108:111], a[28:31], v[172:175], v[108:111]
    s_mov_b32 s66, 57344
    v_exp_f32 v104, v104
    v_mfma_f32_16x16x32_bf16 v[116:119], a[28:31], v[188:191], v[116:119]
    v_exp_f32 v98, v98
    s_waitcnt vmcnt(6)
    s_barrier
    v_mfma_f32_16x16x32_bf16 a[0:3], a[12:15], v[120:123], a[0:3]
    buffer_load_dwordx4 v205, s[44:47], s66 offen nt lds
    v_mfma_f32_16x16x32_bf16 a[4:7], a[12:15], v[124:127], a[4:7]
    s_waitcnt lgkmcnt(0)
    buffer_load_dwordx4 v206, s[44:47], s66 offen offset:1024 nt lds
    v_mfma_f32_16x16x32_bf16 a[8:11], a[12:15], v[128:131], a[8:11]
    ds_read_b128 a[16:19], v200 offset:16384
    v_cvt_pk_bf16_f32 v132, v96, v97
    v_mfma_f32_16x16x32_bf16 v[0:3], a[32:35], v[120:123], v[0:3]
    ds_read_b128 a[20:23], v201 offset:16384
    v_mfma_f32_16x16x32_bf16 v[32:35], a[32:35], v[124:127], v[32:35]
    ds_read_b128 a[24:27], v202 offset:16384
    v_mfma_f32_16x16x32_bf16 v[64:67], a[32:35], v[128:131], v[64:67]
    ds_read_b64_tr_b16 a[32:33], v196 offset:8192
    v_mfma_f32_16x16x32_bf16 v[4:7], a[36:39], v[120:123], v[4:7]
    ds_read_b64_tr_b16 a[34:35], v196 offset:12288
    v_mfma_f32_16x16x32_bf16 v[36:39], a[36:39], v[124:127], v[36:39]
    ds_read_b128 a[28:31], v203 offset:16384
    v_mfma_f32_16x16x32_bf16 v[68:71], a[36:39], v[128:131], v[68:71]
    ds_read_b64_tr_b16 a[36:37], v197 offset:8192
    v_mfma_f32_16x16x32_bf16 v[8:11], a[40:43], v[120:123], v[8:11]
    ds_read_b64_tr_b16 a[38:39], v197 offset:12288
    v_mfma_f32_16x16x32_bf16 v[40:43], a[40:43], v[124:127], v[40:43]
    v_exp_f32 v99, v99
    v_mfma_f32_16x16x32_bf16 v[72:75], a[40:43], v[128:131], v[72:75]
    ds_read_b64_tr_b16 a[40:41], v198 offset:8192
    v_cvt_pk_bf16_f32 v133, v98, v99
    v_mfma_f32_16x16x32_bf16 v[12:15], a[44:47], v[120:123], v[12:15]
    ds_read_b64_tr_b16 a[42:43], v198 offset:12288
    v_mfma_f32_16x16x32_bf16 v[44:47], a[44:47], v[124:127], v[44:47]
    s_waitcnt lgkmcnt(5)
    v_exp_f32 v105, v105
    v_mfma_f32_16x16x32_bf16 v[76:79], a[44:47], v[128:131], v[76:79]
    ds_read_b64_tr_b16 a[44:45], v199 offset:8192
    v_cvt_pk_bf16_f32 v136, v104, v105
    v_mfma_f32_16x16x32_bf16 v[16:19], a[32:35], v[120:123], v[16:19]
    ds_read_b64_tr_b16 a[46:47], v199 offset:12288
    v_mfma_f32_16x16x32_bf16 v[48:51], a[32:35], v[124:127], v[48:51]
    s_waitcnt lgkmcnt(4)
    v_exp_f32 v112, v112
    v_mfma_f32_16x16x32_bf16 v[80:83], a[32:35], v[128:131], v[80:83]
    v_exp_f32 v106, v106
    v_mfma_f32_16x16x32_bf16 v[20:23], a[36:39], v[120:123], v[20:23]
    v_exp_f32 v107, v107
    v_mfma_f32_16x16x32_bf16 v[52:55], a[36:39], v[124:127], v[52:55]
    s_waitcnt lgkmcnt(2)
    v_exp_f32 v113, v113
    v_mfma_f32_16x16x32_bf16 v[84:87], a[36:39], v[128:131], v[84:87]
    v_exp_f32 v114, v114
    v_mfma_f32_16x16x32_bf16 v[24:27], a[40:43], v[120:123], v[24:27]
    v_exp_f32 v115, v115
    v_mfma_f32_16x16x32_bf16 v[56:59], a[40:43], v[124:127], v[56:59]
    s_waitcnt lgkmcnt(0)
    v_exp_f32 v100, v100
    v_mfma_f32_16x16x32_bf16 v[88:91], a[40:43], v[128:131], v[88:91]
    v_exp_f32 v101, v101
    v_mfma_f32_16x16x32_bf16 v[28:31], a[44:47], v[120:123], v[28:31]
    v_exp_f32 v108, v108
    v_mfma_f32_16x16x32_bf16 v[60:63], a[44:47], v[124:127], v[60:63]
    v_exp_f32 v102, v102
    v_mfma_f32_16x16x32_bf16 v[92:95], a[44:47], v[128:131], v[92:95]
    v_exp_f32 v103, v103
    v_mfma_f32_16x16x32_bf16 v[96:99], a[16:19], v[144:147], 0
    v_exp_f32 v109, v109
    v_cvt_pk_bf16_f32 v137, v106, v107
    v_cvt_pk_bf16_f32 v140, v112, v113
    v_mfma_f32_16x16x32_bf16 v[104:107], a[16:19], v[160:163], 0
    v_exp_f32 v116, v116
    v_cvt_pk_bf16_f32 v141, v114, v115
    v_mfma_f32_16x16x32_bf16 v[112:115], a[16:19], v[176:179], 0
    ds_read_b128 a[16:19], v200 offset:20480
    v_cvt_pk_bf16_f32 v134, v100, v101
    v_mfma_f32_16x16x32_bf16 v[96:99], a[20:23], v[148:151], v[96:99]
    v_exp_f32 v110, v110
    v_mfma_f32_16x16x32_bf16 v[104:107], a[20:23], v[164:167], v[104:107]
    v_exp_f32 v111, v111
    v_mfma_f32_16x16x32_bf16 v[112:115], a[20:23], v[180:183], v[112:115]
    ds_read_b128 a[20:23], v201 offset:20480
    v_cvt_pk_bf16_f32 v135, v102, v103
    v_mfma_f32_16x16x32_bf16 v[96:99], a[24:27], v[152:155], v[96:99]
    v_exp_f32 v117, v117
    v_mfma_f32_16x16x32_bf16 v[104:107], a[24:27], v[168:171], v[104:107]
    v_exp_f32 v118, v118
    v_mfma_f32_16x16x32_bf16 v[112:115], a[24:27], v[184:187], v[112:115]
    v_exp_f32 v119, v119
    v_mfma_f32_16x16x32_bf16 v[96:99], a[28:31], v[156:159], v[96:99]
    ds_read_b128 a[24:27], v202 offset:20480
    v_cvt_pk_bf16_f32 v138, v108, v109
    v_mfma_f32_16x16x32_bf16 v[104:107], a[28:31], v[172:175], v[104:107]
    ds_read_b64_tr_b16 a[32:33], v192 offset:40960
    s_waitcnt lgkmcnt(3)
    v_mfma_f32_16x16x32_bf16 v[112:115], a[28:31], v[188:191], v[112:115]
    ds_read_b128 a[28:31], v203 offset:20480
    v_cvt_pk_bf16_f32 v139, v110, v111
    v_mfma_f32_16x16x32_bf16 v[100:103], a[16:19], v[144:147], 0
    ds_read_b64_tr_b16 a[36:37], v193 offset:40960
    v_cvt_pk_bf16_f32 v142, v116, v117
    v_mfma_f32_16x16x32_bf16 v[108:111], a[16:19], v[160:163], 0
    ds_read_b64_tr_b16 a[40:41], v194 offset:40960
    v_cvt_pk_bf16_f32 v143, v118, v119
    v_mfma_f32_16x16x32_bf16 v[116:119], a[16:19], v[176:179], 0
    ds_read_b64_tr_b16 a[44:45], v195 offset:40960
    s_waitcnt lgkmcnt(6)
    v_mfma_f32_16x16x32_bf16 v[100:103], a[20:23], v[148:151], v[100:103]
    ds_read_b64_tr_b16 a[34:35], v192 offset:45056
    v_mfma_f32_16x16x32_bf16 v[108:111], a[20:23], v[164:167], v[108:111]
    ds_read_b64_tr_b16 a[38:39], v193 offset:45056
    s_waitcnt lgkmcnt(7)
    v_mfma_f32_16x16x32_bf16 v[116:119], a[20:23], v[180:183], v[116:119]
    ds_read_b64_tr_b16 a[42:43], v194 offset:45056
    v_mfma_f32_16x16x32_bf16 v[100:103], a[24:27], v[152:155], v[100:103]
    ds_read_b64_tr_b16 a[46:47], v195 offset:45056
    v_mfma_f32_16x16x32_bf16 v[108:111], a[24:27], v[168:171], v[108:111]
    s_waitcnt lgkmcnt(7)
    v_exp_f32 v96, v96
    v_mfma_f32_16x16x32_bf16 v[116:119], a[24:27], v[184:187], v[116:119]
    v_exp_f32 v97, v97
    v_mfma_f32_16x16x32_bf16 v[100:103], a[28:31], v[156:159], v[100:103]
    s_add_u32 m0, s64, 24576
    v_exp_f32 v104, v104
    v_mfma_f32_16x16x32_bf16 v[108:111], a[28:31], v[172:175], v[108:111]
    s_mov_b32 s66, 65536
    v_exp_f32 v98, v98
    v_mfma_f32_16x16x32_bf16 v[116:119], a[28:31], v[188:191], v[116:119]
    v_exp_f32 v99, v99
    s_waitcnt vmcnt(4)
    s_barrier
    v_mfma_f32_16x16x32_bf16 a[0:3], a[12:15], v[132:135], a[0:3]
    buffer_load_dwordx4 v205, s[44:47], s66 offen nt lds
    v_mfma_f32_16x16x32_bf16 a[4:7], a[12:15], v[136:139], a[4:7]
    s_waitcnt lgkmcnt(0)
    buffer_load_dwordx4 v206, s[44:47], s66 offen offset:1024 nt lds
    v_mfma_f32_16x16x32_bf16 a[8:11], a[12:15], v[140:143], a[8:11]
    ds_read_b128 a[16:19], v200 offset:49152
    s_add_u32 m0, s64, 57344
    v_mfma_f32_16x16x32_bf16 v[0:3], a[32:35], v[132:135], v[0:3]
    ds_read_b128 a[20:23], v201 offset:49152
    s_mov_b32 s67, 40960
    v_mfma_f32_16x16x32_bf16 v[32:35], a[32:35], v[136:139], v[32:35]
    buffer_load_dwordx4 v205, s[48:51], s67 offen nt lds
    v_mfma_f32_16x16x32_bf16 v[64:67], a[32:35], v[140:143], v[64:67]
    ds_read_b64_tr_b16 a[32:33], v196 offset:40960
    v_cvt_pk_bf16_f32 v120, v96, v97
    v_mfma_f32_16x16x32_bf16 v[4:7], a[36:39], v[132:135], v[4:7]
    ds_read_b64_tr_b16 a[34:35], v196 offset:45056
    v_cvt_pk_bf16_f32 v121, v98, v99
    v_mfma_f32_16x16x32_bf16 v[36:39], a[36:39], v[136:139], v[36:39]
    buffer_load_dwordx4 v206, s[48:51], s67 offen offset:1024 nt lds
    v_mfma_f32_16x16x32_bf16 v[68:71], a[36:39], v[140:143], v[68:71]
    ds_read_b64_tr_b16 a[36:37], v197 offset:40960
    v_mfma_f32_16x16x32_bf16 v[8:11], a[40:43], v[132:135], v[8:11]
    ds_read_b64_tr_b16 a[38:39], v197 offset:45056
    v_mfma_f32_16x16x32_bf16 v[40:43], a[40:43], v[136:139], v[40:43]
    ds_read_b128 a[24:27], v202 offset:49152
    v_mfma_f32_16x16x32_bf16 v[72:75], a[40:43], v[140:143], v[72:75]
    ds_read_b64_tr_b16 a[40:41], v198 offset:40960
    v_mfma_f32_16x16x32_bf16 v[12:15], a[44:47], v[132:135], v[12:15]
    ds_read_b64_tr_b16 a[42:43], v198 offset:45056
    v_mfma_f32_16x16x32_bf16 v[44:47], a[44:47], v[136:139], v[44:47]
    ds_read_b128 a[28:31], v203 offset:49152
    s_waitcnt lgkmcnt(6)
    v_mfma_f32_16x16x32_bf16 v[76:79], a[44:47], v[140:143], v[76:79]
    ds_read_b64_tr_b16 a[44:45], v199 offset:40960
    v_mfma_f32_16x16x32_bf16 v[16:19], a[32:35], v[132:135], v[16:19]
    ds_read_b64_tr_b16 a[46:47], v199 offset:45056
    v_mfma_f32_16x16x32_bf16 v[48:51], a[32:35], v[136:139], v[48:51]
    s_waitcnt lgkmcnt(6)
    v_exp_f32 v105, v105
    v_mfma_f32_16x16x32_bf16 v[80:83], a[32:35], v[140:143], v[80:83]
    v_exp_f32 v112, v112
    v_mfma_f32_16x16x32_bf16 v[20:23], a[36:39], v[132:135], v[20:23]
    v_exp_f32 v106, v106
    v_mfma_f32_16x16x32_bf16 v[52:55], a[36:39], v[136:139], v[52:55]
    s_waitcnt lgkmcnt(3)
    v_exp_f32 v107, v107
    v_mfma_f32_16x16x32_bf16 v[84:87], a[36:39], v[140:143], v[84:87]
    v_exp_f32 v113, v113
    v_mfma_f32_16x16x32_bf16 v[24:27], a[40:43], v[132:135], v[24:27]
    v_exp_f32 v114, v114
    v_mfma_f32_16x16x32_bf16 v[56:59], a[40:43], v[136:139], v[56:59]
    s_waitcnt lgkmcnt(0)
    v_exp_f32 v115, v115
    v_mfma_f32_16x16x32_bf16 v[88:91], a[40:43], v[140:143], v[88:91]
    v_exp_f32 v100, v100
    v_mfma_f32_16x16x32_bf16 v[28:31], a[44:47], v[132:135], v[28:31]
    v_exp_f32 v101, v101
    v_mfma_f32_16x16x32_bf16 v[60:63], a[44:47], v[136:139], v[60:63]
    v_exp_f32 v108, v108
    v_mfma_f32_16x16x32_bf16 v[92:95], a[44:47], v[140:143], v[92:95]
    v_exp_f32 v102, v102
    v_cvt_pk_bf16_f32 v124, v104, v105
    v_mfma_f32_16x16x32_bf16 v[96:99], a[16:19], v[144:147], 0
    v_exp_f32 v103, v103
    v_cvt_pk_bf16_f32 v125, v106, v107
    v_cvt_pk_bf16_f32 v128, v112, v113
    v_mfma_f32_16x16x32_bf16 v[104:107], a[16:19], v[160:163], 0
    v_exp_f32 v109, v109
    v_cvt_pk_bf16_f32 v129, v114, v115
    v_mfma_f32_16x16x32_bf16 v[112:115], a[16:19], v[176:179], 0
    ds_read_b128 a[16:19], v200 offset:53248
    v_cvt_pk_bf16_f32 v122, v100, v101
    v_mfma_f32_16x16x32_bf16 v[96:99], a[20:23], v[148:151], v[96:99]
    v_exp_f32 v116, v116
    v_mfma_f32_16x16x32_bf16 v[104:107], a[20:23], v[164:167], v[104:107]
    v_exp_f32 v110, v110
    v_mfma_f32_16x16x32_bf16 v[112:115], a[20:23], v[180:183], v[112:115]
    ds_read_b128 a[20:23], v201 offset:53248
    v_cvt_pk_bf16_f32 v123, v102, v103
    v_mfma_f32_16x16x32_bf16 v[96:99], a[24:27], v[152:155], v[96:99]
    v_exp_f32 v111, v111
    v_mfma_f32_16x16x32_bf16 v[104:107], a[24:27], v[168:171], v[104:107]
    v_exp_f32 v117, v117
    v_mfma_f32_16x16x32_bf16 v[112:115], a[24:27], v[184:187], v[112:115]
    v_exp_f32 v118, v118
    v_mfma_f32_16x16x32_bf16 v[96:99], a[28:31], v[156:159], v[96:99]
    v_exp_f32 v119, v119
    v_mfma_f32_16x16x32_bf16 v[104:107], a[28:31], v[172:175], v[104:107]
    ds_read_b128 a[24:27], v202 offset:53248
    s_waitcnt lgkmcnt(2)
    v_mfma_f32_16x16x32_bf16 v[112:115], a[28:31], v[188:191], v[112:115]
    ds_read_b128 a[28:31], v203 offset:53248
    v_cvt_pk_bf16_f32 v126, v108, v109
    v_mfma_f32_16x16x32_bf16 v[100:103], a[16:19], v[144:147], 0
    ds_read_b64_tr_b16 a[32:33], v192 offset:49152
    v_cvt_pk_bf16_f32 v127, v110, v111
    v_cvt_pk_bf16_f32 v130, v116, v117
    v_mfma_f32_16x16x32_bf16 v[108:111], a[16:19], v[160:163], 0
    ds_read_b64_tr_b16 a[36:37], v193 offset:49152
    v_cvt_pk_bf16_f32 v131, v118, v119
    v_mfma_f32_16x16x32_bf16 v[116:119], a[16:19], v[176:179], 0
    ds_read_b64_tr_b16 a[40:41], v194 offset:49152
    s_waitcnt lgkmcnt(5)
    v_mfma_f32_16x16x32_bf16 v[100:103], a[20:23], v[148:151], v[100:103]
    ds_read_b64_tr_b16 a[44:45], v195 offset:49152
    v_mfma_f32_16x16x32_bf16 v[108:111], a[20:23], v[164:167], v[108:111]
    ds_read_b64_tr_b16 a[34:35], v192 offset:53248
    s_waitcnt lgkmcnt(6)
    v_mfma_f32_16x16x32_bf16 v[116:119], a[20:23], v[180:183], v[116:119]
    ds_read_b64_tr_b16 a[38:39], v193 offset:53248
    v_mfma_f32_16x16x32_bf16 v[100:103], a[24:27], v[152:155], v[100:103]
    ds_read_b64_tr_b16 a[42:43], v194 offset:53248
    v_mfma_f32_16x16x32_bf16 v[108:111], a[24:27], v[168:171], v[108:111]
    ds_read_b64_tr_b16 a[46:47], v195 offset:53248
    s_waitcnt lgkmcnt(8)
    v_mfma_f32_16x16x32_bf16 v[116:119], a[24:27], v[184:187], v[116:119]
    v_exp_f32 v96, v96
    v_mfma_f32_16x16x32_bf16 v[100:103], a[28:31], v[156:159], v[100:103]
    s_add_u32 m0, s64, 32768
    v_exp_f32 v97, v97
    v_mfma_f32_16x16x32_bf16 v[108:111], a[28:31], v[172:175], v[108:111]
    s_mov_b32 s66, 73728
    v_exp_f32 v104, v104
    v_mfma_f32_16x16x32_bf16 v[116:119], a[28:31], v[188:191], v[116:119]
    v_exp_f32 v98, v98
    s_waitcnt vmcnt(0)
    s_barrier
    v_mfma_f32_16x16x32_bf16 a[0:3], a[12:15], v[120:123], a[0:3]
    buffer_load_dwordx4 v205, s[44:47], s66 offen nt lds
    v_mfma_f32_16x16x32_bf16 a[4:7], a[12:15], v[124:127], a[4:7]
    s_waitcnt lgkmcnt(0)
    buffer_load_dwordx4 v206, s[44:47], s66 offen offset:1024 nt lds
    v_mfma_f32_16x16x32_bf16 a[8:11], a[12:15], v[128:131], a[8:11]
    ds_read_b128 a[16:19], v200 offset:57344
    s_add_u32 m0, s64, 0
    v_mfma_f32_16x16x32_bf16 v[0:3], a[32:35], v[120:123], v[0:3]
    ds_read_b128 a[20:23], v201 offset:57344
    s_mov_b32 s67, 49152
    v_mfma_f32_16x16x32_bf16 v[32:35], a[32:35], v[124:127], v[32:35]
    buffer_load_dwordx4 v205, s[48:51], s67 offen nt lds
    v_mfma_f32_16x16x32_bf16 v[64:67], a[32:35], v[128:131], v[64:67]
    ds_read_b64_tr_b16 a[32:33], v196 offset:49152
    v_cvt_pk_bf16_f32 v132, v96, v97
    v_mfma_f32_16x16x32_bf16 v[4:7], a[36:39], v[120:123], v[4:7]
    ds_read_b64_tr_b16 a[34:35], v196 offset:53248
    v_mfma_f32_16x16x32_bf16 v[36:39], a[36:39], v[124:127], v[36:39]
    buffer_load_dwordx4 v206, s[48:51], s67 offen offset:1024 nt lds
    v_mfma_f32_16x16x32_bf16 v[68:71], a[36:39], v[128:131], v[68:71]
    ds_read_b64_tr_b16 a[36:37], v197 offset:49152
    v_mfma_f32_16x16x32_bf16 v[8:11], a[40:43], v[120:123], v[8:11]
    ds_read_b64_tr_b16 a[38:39], v197 offset:53248
    v_mfma_f32_16x16x32_bf16 v[40:43], a[40:43], v[124:127], v[40:43]
    ds_read_b128 a[24:27], v202 offset:57344
    v_mfma_f32_16x16x32_bf16 v[72:75], a[40:43], v[128:131], v[72:75]
    ds_read_b64_tr_b16 a[40:41], v198 offset:49152
    v_mfma_f32_16x16x32_bf16 v[12:15], a[44:47], v[120:123], v[12:15]
    ds_read_b64_tr_b16 a[42:43], v198 offset:53248
    v_mfma_f32_16x16x32_bf16 v[44:47], a[44:47], v[124:127], v[44:47]
    ds_read_b128 a[28:31], v203 offset:57344
    s_waitcnt lgkmcnt(6)
    v_mfma_f32_16x16x32_bf16 v[76:79], a[44:47], v[128:131], v[76:79]
    ds_read_b64_tr_b16 a[44:45], v199 offset:49152
    v_mfma_f32_16x16x32_bf16 v[16:19], a[32:35], v[120:123], v[16:19]
    ds_read_b64_tr_b16 a[46:47], v199 offset:53248
    v_mfma_f32_16x16x32_bf16 v[48:51], a[32:35], v[124:127], v[48:51]
    s_waitcnt lgkmcnt(6)
    v_exp_f32 v99, v99
    v_mfma_f32_16x16x32_bf16 v[80:83], a[32:35], v[128:131], v[80:83]
    v_exp_f32 v105, v105
    v_mfma_f32_16x16x32_bf16 v[20:23], a[36:39], v[120:123], v[20:23]
    v_exp_f32 v112, v112
    v_mfma_f32_16x16x32_bf16 v[52:55], a[36:39], v[124:127], v[52:55]
    s_waitcnt lgkmcnt(3)
    v_exp_f32 v106, v106
    v_mfma_f32_16x16x32_bf16 v[84:87], a[36:39], v[128:131], v[84:87]
    v_exp_f32 v107, v107
    v_mfma_f32_16x16x32_bf16 v[24:27], a[40:43], v[120:123], v[24:27]
    v_exp_f32 v113, v113
    v_mfma_f32_16x16x32_bf16 v[56:59], a[40:43], v[124:127], v[56:59]
    s_waitcnt lgkmcnt(0)
    v_exp_f32 v114, v114
    v_mfma_f32_16x16x32_bf16 v[88:91], a[40:43], v[128:131], v[88:91]
    v_exp_f32 v115, v115
    v_mfma_f32_16x16x32_bf16 v[28:31], a[44:47], v[120:123], v[28:31]
    v_exp_f32 v100, v100
    v_mfma_f32_16x16x32_bf16 v[60:63], a[44:47], v[124:127], v[60:63]
    v_exp_f32 v101, v101
    v_mfma_f32_16x16x32_bf16 v[92:95], a[44:47], v[128:131], v[92:95]
    v_exp_f32 v108, v108
    v_cvt_pk_bf16_f32 v133, v98, v99
    v_cvt_pk_bf16_f32 v136, v104, v105
    v_mfma_f32_16x16x32_bf16 v[96:99], a[16:19], v[144:147], 0
    v_exp_f32 v102, v102
    v_cvt_pk_bf16_f32 v137, v106, v107
    v_cvt_pk_bf16_f32 v140, v112, v113
    v_mfma_f32_16x16x32_bf16 v[104:107], a[16:19], v[160:163], 0
    v_exp_f32 v103, v103
    v_cvt_pk_bf16_f32 v141, v114, v115
    v_mfma_f32_16x16x32_bf16 v[112:115], a[16:19], v[176:179], 0
    ds_read_b128 a[16:19], v200 offset:61440
    v_cvt_pk_bf16_f32 v134, v100, v101
    v_mfma_f32_16x16x32_bf16 v[96:99], a[20:23], v[148:151], v[96:99]
    v_exp_f32 v109, v109
    v_mfma_f32_16x16x32_bf16 v[104:107], a[20:23], v[164:167], v[104:107]
    v_exp_f32 v116, v116
    v_mfma_f32_16x16x32_bf16 v[112:115], a[20:23], v[180:183], v[112:115]
    ds_read_b128 a[20:23], v201 offset:61440
    v_cvt_pk_bf16_f32 v135, v102, v103
    v_mfma_f32_16x16x32_bf16 v[96:99], a[24:27], v[152:155], v[96:99]
    v_exp_f32 v110, v110
    v_mfma_f32_16x16x32_bf16 v[104:107], a[24:27], v[168:171], v[104:107]
    v_exp_f32 v111, v111
    v_mfma_f32_16x16x32_bf16 v[112:115], a[24:27], v[184:187], v[112:115]
    v_exp_f32 v117, v117
    v_mfma_f32_16x16x32_bf16 v[96:99], a[28:31], v[156:159], v[96:99]
    v_exp_f32 v118, v118
    v_mfma_f32_16x16x32_bf16 v[104:107], a[28:31], v[172:175], v[104:107]
    s_waitcnt lgkmcnt(1)
    v_exp_f32 v119, v119
    v_mfma_f32_16x16x32_bf16 v[112:115], a[28:31], v[188:191], v[112:115]
    ds_read_b128 a[24:27], v202 offset:61440
    v_cvt_pk_bf16_f32 v138, v108, v109
    v_mfma_f32_16x16x32_bf16 v[100:103], a[16:19], v[144:147], 0
    ds_read_b128 a[28:31], v203 offset:61440
    v_cvt_pk_bf16_f32 v139, v110, v111
    v_cvt_pk_bf16_f32 v142, v116, v117
    v_mfma_f32_16x16x32_bf16 v[108:111], a[16:19], v[160:163], 0
    ds_read_b64_tr_b16 a[32:33], v192 offset:57344
    v_cvt_pk_bf16_f32 v143, v118, v119
    v_mfma_f32_16x16x32_bf16 v[116:119], a[16:19], v[176:179], 0
    ds_read_b64_tr_b16 a[36:37], v193 offset:57344
    s_waitcnt lgkmcnt(4)
    v_mfma_f32_16x16x32_bf16 v[100:103], a[20:23], v[148:151], v[100:103]
    ds_read_b64_tr_b16 a[40:41], v194 offset:57344
    v_mfma_f32_16x16x32_bf16 v[108:111], a[20:23], v[164:167], v[108:111]
    ds_read_b64_tr_b16 a[44:45], v195 offset:57344
    s_waitcnt lgkmcnt(5)
    v_mfma_f32_16x16x32_bf16 v[116:119], a[20:23], v[180:183], v[116:119]
    ds_read_b64_tr_b16 a[34:35], v192 offset:61440
    v_mfma_f32_16x16x32_bf16 v[100:103], a[24:27], v[152:155], v[100:103]
    ds_read_b64_tr_b16 a[38:39], v193 offset:61440
    v_mfma_f32_16x16x32_bf16 v[108:111], a[24:27], v[168:171], v[108:111]
    ds_read_b64_tr_b16 a[42:43], v194 offset:61440
    s_waitcnt lgkmcnt(7)
    v_mfma_f32_16x16x32_bf16 v[116:119], a[24:27], v[184:187], v[116:119]
    ds_read_b64_tr_b16 a[46:47], v195 offset:61440
    v_mfma_f32_16x16x32_bf16 v[100:103], a[28:31], v[156:159], v[100:103]
    s_add_u32 m0, s64, 65536
    v_exp_f32 v96, v96
    v_mfma_f32_16x16x32_bf16 v[108:111], a[28:31], v[172:175], v[108:111]
    s_mov_b32 s66, 81920
    v_exp_f32 v97, v97
    v_mfma_f32_16x16x32_bf16 v[116:119], a[28:31], v[188:191], v[116:119]
    v_exp_f32 v104, v104
    s_waitcnt vmcnt(0)
    s_barrier
    v_mfma_f32_16x16x32_bf16 a[0:3], a[12:15], v[132:135], a[0:3]
    buffer_load_dwordx4 v205, s[44:47], s66 offen nt lds
    v_mfma_f32_16x16x32_bf16 a[4:7], a[12:15], v[136:139], a[4:7]
    s_waitcnt lgkmcnt(0)
    buffer_load_dwordx4 v206, s[44:47], s66 offen offset:1024 nt lds
    v_mfma_f32_16x16x32_bf16 a[8:11], a[12:15], v[140:143], a[8:11]
    ds_read_b128 a[16:19], v200
    s_add_u32 m0, s64, 8192
    v_mfma_f32_16x16x32_bf16 v[0:3], a[32:35], v[132:135], v[0:3]
    ds_read_b128 a[20:23], v201
    s_mov_b32 s67, 57344
    v_mfma_f32_16x16x32_bf16 v[32:35], a[32:35], v[136:139], v[32:35]
    buffer_load_dwordx4 v205, s[48:51], s67 offen nt lds
    v_mfma_f32_16x16x32_bf16 v[64:67], a[32:35], v[140:143], v[64:67]
    ds_read_b64_tr_b16 a[32:33], v196 offset:57344
    v_cvt_pk_bf16_f32 v120, v96, v97
    v_mfma_f32_16x16x32_bf16 v[4:7], a[36:39], v[132:135], v[4:7]
    ds_read_b64_tr_b16 a[34:35], v196 offset:61440
    v_mfma_f32_16x16x32_bf16 v[36:39], a[36:39], v[136:139], v[36:39]
    buffer_load_dwordx4 v206, s[48:51], s67 offen offset:1024 nt lds
    v_mfma_f32_16x16x32_bf16 v[68:71], a[36:39], v[140:143], v[68:71]
    ds_read_b64_tr_b16 a[36:37], v197 offset:57344
    v_mfma_f32_16x16x32_bf16 v[8:11], a[40:43], v[132:135], v[8:11]
    ds_read_b64_tr_b16 a[38:39], v197 offset:61440
    v_mfma_f32_16x16x32_bf16 v[40:43], a[40:43], v[136:139], v[40:43]
    ds_read_b128 a[24:27], v202
    v_mfma_f32_16x16x32_bf16 v[72:75], a[40:43], v[140:143], v[72:75]
    ds_read_b64_tr_b16 a[40:41], v198 offset:57344
    v_mfma_f32_16x16x32_bf16 v[12:15], a[44:47], v[132:135], v[12:15]
    ds_read_b64_tr_b16 a[42:43], v198 offset:61440
    v_mfma_f32_16x16x32_bf16 v[44:47], a[44:47], v[136:139], v[44:47]
    ds_read_b128 a[28:31], v203
    s_waitcnt lgkmcnt(6)
    v_mfma_f32_16x16x32_bf16 v[76:79], a[44:47], v[140:143], v[76:79]
    ds_read_b64_tr_b16 a[44:45], v199 offset:57344
    v_mfma_f32_16x16x32_bf16 v[16:19], a[32:35], v[132:135], v[16:19]
    ds_read_b64_tr_b16 a[46:47], v199 offset:61440
    v_mfma_f32_16x16x32_bf16 v[48:51], a[32:35], v[136:139], v[48:51]
    s_waitcnt lgkmcnt(6)
    v_exp_f32 v98, v98
    v_mfma_f32_16x16x32_bf16 v[80:83], a[32:35], v[140:143], v[80:83]
    v_exp_f32 v99, v99
    v_mfma_f32_16x16x32_bf16 v[20:23], a[36:39], v[132:135], v[20:23]
    v_exp_f32 v105, v105
    v_mfma_f32_16x16x32_bf16 v[52:55], a[36:39], v[136:139], v[52:55]
    s_waitcnt lgkmcnt(3)
    v_exp_f32 v112, v112
    v_mfma_f32_16x16x32_bf16 v[84:87], a[36:39], v[140:143], v[84:87]
    v_exp_f32 v106, v106
    v_mfma_f32_16x16x32_bf16 v[24:27], a[40:43], v[132:135], v[24:27]
    v_exp_f32 v107, v107
    v_mfma_f32_16x16x32_bf16 v[56:59], a[40:43], v[136:139], v[56:59]
    s_waitcnt lgkmcnt(0)
    v_exp_f32 v113, v113
    v_mfma_f32_16x16x32_bf16 v[88:91], a[40:43], v[140:143], v[88:91]
    v_exp_f32 v114, v114
    v_mfma_f32_16x16x32_bf16 v[28:31], a[44:47], v[132:135], v[28:31]
    v_exp_f32 v115, v115
    v_mfma_f32_16x16x32_bf16 v[60:63], a[44:47], v[136:139], v[60:63]
    v_exp_f32 v100, v100
    v_mfma_f32_16x16x32_bf16 v[92:95], a[44:47], v[140:143], v[92:95]
    v_exp_f32 v101, v101
    v_cvt_pk_bf16_f32 v121, v98, v99
    v_cvt_pk_bf16_f32 v124, v104, v105
    v_mfma_f32_16x16x32_bf16 v[96:99], a[16:19], v[144:147], 0
    v_exp_f32 v108, v108
    v_cvt_pk_bf16_f32 v125, v106, v107
    v_cvt_pk_bf16_f32 v128, v112, v113
    v_mfma_f32_16x16x32_bf16 v[104:107], a[16:19], v[160:163], 0
    v_exp_f32 v102, v102
    v_cvt_pk_bf16_f32 v129, v114, v115
    v_mfma_f32_16x16x32_bf16 v[112:115], a[16:19], v[176:179], 0
    ds_read_b128 a[16:19], v200 offset:4096
    v_cvt_pk_bf16_f32 v122, v100, v101
    v_mfma_f32_16x16x32_bf16 v[96:99], a[20:23], v[148:151], v[96:99]
    v_exp_f32 v103, v103
    v_mfma_f32_16x16x32_bf16 v[104:107], a[20:23], v[164:167], v[104:107]
    v_exp_f32 v109, v109
    v_mfma_f32_16x16x32_bf16 v[112:115], a[20:23], v[180:183], v[112:115]
    v_exp_f32 v116, v116
    v_mfma_f32_16x16x32_bf16 v[96:99], a[24:27], v[152:155], v[96:99]
    ds_read_b128 a[20:23], v201 offset:4096
    v_cvt_pk_bf16_f32 v123, v102, v103
    v_mfma_f32_16x16x32_bf16 v[104:107], a[24:27], v[168:171], v[104:107]
    v_exp_f32 v110, v110
    v_mfma_f32_16x16x32_bf16 v[112:115], a[24:27], v[184:187], v[112:115]
    v_exp_f32 v111, v111
    v_mfma_f32_16x16x32_bf16 v[96:99], a[28:31], v[156:159], v[96:99]
    v_exp_f32 v117, v117
    v_mfma_f32_16x16x32_bf16 v[104:107], a[28:31], v[172:175], v[104:107]
    s_waitcnt lgkmcnt(1)
    v_exp_f32 v118, v118
    v_mfma_f32_16x16x32_bf16 v[112:115], a[28:31], v[188:191], v[112:115]
    v_exp_f32 v119, v119
    v_cvt_pk_bf16_f32 v126, v108, v109
    v_mfma_f32_16x16x32_bf16 v[100:103], a[16:19], v[144:147], 0
    ds_read_b128 a[24:27], v202 offset:4096
    v_cvt_pk_bf16_f32 v127, v110, v111
    v_cvt_pk_bf16_f32 v130, v116, v117
    v_mfma_f32_16x16x32_bf16 v[108:111], a[16:19], v[160:163], 0
    ds_read_b128 a[28:31], v203 offset:4096
    v_cvt_pk_bf16_f32 v131, v118, v119
    v_mfma_f32_16x16x32_bf16 v[116:119], a[16:19], v[176:179], 0
    ds_read_b64_tr_b16 a[32:33], v192
    s_waitcnt lgkmcnt(3)
    v_mfma_f32_16x16x32_bf16 v[100:103], a[20:23], v[148:151], v[100:103]
    ds_read_b64_tr_b16 a[36:37], v193
    v_mfma_f32_16x16x32_bf16 v[108:111], a[20:23], v[164:167], v[108:111]
    ds_read_b64_tr_b16 a[40:41], v194
    s_waitcnt lgkmcnt(4)
    v_mfma_f32_16x16x32_bf16 v[116:119], a[20:23], v[180:183], v[116:119]
    ds_read_b64_tr_b16 a[44:45], v195
    v_mfma_f32_16x16x32_bf16 v[100:103], a[24:27], v[152:155], v[100:103]
    ds_read_b64_tr_b16 a[34:35], v192 offset:4096
    v_mfma_f32_16x16x32_bf16 v[108:111], a[24:27], v[168:171], v[108:111]
    ds_read_b64_tr_b16 a[38:39], v193 offset:4096
    s_waitcnt lgkmcnt(6)
    v_mfma_f32_16x16x32_bf16 v[116:119], a[24:27], v[184:187], v[116:119]
    ds_read_b64_tr_b16 a[42:43], v194 offset:4096
    v_mfma_f32_16x16x32_bf16 v[100:103], a[28:31], v[156:159], v[100:103]
    ds_read_b64_tr_b16 a[46:47], v195 offset:4096
    s_add_u32 m0, s64, 73728
    v_mfma_f32_16x16x32_bf16 v[108:111], a[28:31], v[172:175], v[108:111]
    s_mov_b32 s66, 90112
    v_exp_f32 v96, v96
    v_mfma_f32_16x16x32_bf16 v[116:119], a[28:31], v[188:191], v[116:119]
    v_exp_f32 v97, v97
    s_waitcnt vmcnt(0)
    s_barrier
    v_mfma_f32_16x16x32_bf16 a[0:3], a[12:15], v[120:123], a[0:3]
    buffer_load_dwordx4 v205, s[44:47], s66 offen nt lds
    v_mfma_f32_16x16x32_bf16 a[4:7], a[12:15], v[124:127], a[4:7]
    s_waitcnt lgkmcnt(0)
    buffer_load_dwordx4 v206, s[44:47], s66 offen offset:1024 nt lds
    v_mfma_f32_16x16x32_bf16 a[8:11], a[12:15], v[128:131], a[8:11]
    ds_read_b128 a[16:19], v200 offset:8192
    s_add_u32 m0, s64, 40960
    v_mfma_f32_16x16x32_bf16 v[0:3], a[32:35], v[120:123], v[0:3]
    ds_read_b128 a[20:23], v201 offset:8192
    s_mov_b32 s67, 65536
    v_mfma_f32_16x16x32_bf16 v[32:35], a[32:35], v[124:127], v[32:35]
    buffer_load_dwordx4 v205, s[48:51], s67 offen nt lds
    v_mfma_f32_16x16x32_bf16 v[64:67], a[32:35], v[128:131], v[64:67]
    ds_read_b64_tr_b16 a[32:33], v196
    v_cvt_pk_bf16_f32 v132, v96, v97
    v_mfma_f32_16x16x32_bf16 v[4:7], a[36:39], v[120:123], v[4:7]
    ds_read_b64_tr_b16 a[34:35], v196 offset:4096
    v_mfma_f32_16x16x32_bf16 v[36:39], a[36:39], v[124:127], v[36:39]
    buffer_load_dwordx4 v206, s[48:51], s67 offen offset:1024 nt lds
    v_mfma_f32_16x16x32_bf16 v[68:71], a[36:39], v[128:131], v[68:71]
    ds_read_b64_tr_b16 a[36:37], v197
    v_mfma_f32_16x16x32_bf16 v[8:11], a[40:43], v[120:123], v[8:11]
    ds_read_b64_tr_b16 a[38:39], v197 offset:4096
    v_mfma_f32_16x16x32_bf16 v[40:43], a[40:43], v[124:127], v[40:43]
    ds_read_b128 a[24:27], v202 offset:8192
    v_mfma_f32_16x16x32_bf16 v[72:75], a[40:43], v[128:131], v[72:75]
    ds_read_b64_tr_b16 a[40:41], v198
    v_mfma_f32_16x16x32_bf16 v[12:15], a[44:47], v[120:123], v[12:15]
    ds_read_b64_tr_b16 a[42:43], v198 offset:4096
    v_mfma_f32_16x16x32_bf16 v[44:47], a[44:47], v[124:127], v[44:47]
    ds_read_b128 a[28:31], v203 offset:8192
    s_waitcnt lgkmcnt(6)
    v_mfma_f32_16x16x32_bf16 v[76:79], a[44:47], v[128:131], v[76:79]
    ds_read_b64_tr_b16 a[44:45], v199
    v_mfma_f32_16x16x32_bf16 v[16:19], a[32:35], v[120:123], v[16:19]
    ds_read_b64_tr_b16 a[46:47], v199 offset:4096
    v_mfma_f32_16x16x32_bf16 v[48:51], a[32:35], v[124:127], v[48:51]
    s_waitcnt lgkmcnt(6)
    v_exp_f32 v104, v104
    v_mfma_f32_16x16x32_bf16 v[80:83], a[32:35], v[128:131], v[80:83]
    v_exp_f32 v98, v98
    v_mfma_f32_16x16x32_bf16 v[20:23], a[36:39], v[120:123], v[20:23]
    v_exp_f32 v99, v99
    v_mfma_f32_16x16x32_bf16 v[52:55], a[36:39], v[124:127], v[52:55]
    s_waitcnt lgkmcnt(3)
    v_exp_f32 v105, v105
    v_mfma_f32_16x16x32_bf16 v[84:87], a[36:39], v[128:131], v[84:87]
    v_exp_f32 v112, v112
    v_mfma_f32_16x16x32_bf16 v[24:27], a[40:43], v[120:123], v[24:27]
    v_exp_f32 v106, v106
    v_mfma_f32_16x16x32_bf16 v[56:59], a[40:43], v[124:127], v[56:59]
    s_waitcnt lgkmcnt(0)
    v_exp_f32 v107, v107
    v_mfma_f32_16x16x32_bf16 v[88:91], a[40:43], v[128:131], v[88:91]
    v_exp_f32 v113, v113
    v_mfma_f32_16x16x32_bf16 v[28:31], a[44:47], v[120:123], v[28:31]
    v_exp_f32 v114, v114
    v_mfma_f32_16x16x32_bf16 v[60:63], a[44:47], v[124:127], v[60:63]
    v_exp_f32 v115, v115
    v_mfma_f32_16x16x32_bf16 v[92:95], a[44:47], v[128:131], v[92:95]
    v_exp_f32 v100, v100
    v_cvt_pk_bf16_f32 v133, v98, v99
    v_cvt_pk_bf16_f32 v136, v104, v105
    v_mfma_f32_16x16x32_bf16 v[96:99], a[16:19], v[144:147], 0
    v_exp_f32 v101, v101
    v_cvt_pk_bf16_f32 v137, v106, v107
    v_cvt_pk_bf16_f32 v140, v112, v113
    v_mfma_f32_16x16x32_bf16 v[104:107], a[16:19], v[160:163], 0
    v_exp_f32 v108, v108
    v_cvt_pk_bf16_f32 v141, v114, v115
    v_mfma_f32_16x16x32_bf16 v[112:115], a[16:19], v[176:179], 0
    ds_read_b128 a[16:19], v200 offset:12288
    v_cvt_pk_bf16_f32 v134, v100, v101
    v_mfma_f32_16x16x32_bf16 v[96:99], a[20:23], v[148:151], v[96:99]
    v_exp_f32 v102, v102
    v_mfma_f32_16x16x32_bf16 v[104:107], a[20:23], v[164:167], v[104:107]
    v_exp_f32 v103, v103
    v_mfma_f32_16x16x32_bf16 v[112:115], a[20:23], v[180:183], v[112:115]
    v_exp_f32 v109, v109
    v_mfma_f32_16x16x32_bf16 v[96:99], a[24:27], v[152:155], v[96:99]
    v_exp_f32 v116, v116
    v_mfma_f32_16x16x32_bf16 v[104:107], a[24:27], v[168:171], v[104:107]
    ds_read_b128 a[20:23], v201 offset:12288
    v_cvt_pk_bf16_f32 v135, v102, v103
    v_mfma_f32_16x16x32_bf16 v[112:115], a[24:27], v[184:187], v[112:115]
    v_exp_f32 v110, v110
    v_mfma_f32_16x16x32_bf16 v[96:99], a[28:31], v[156:159], v[96:99]
    v_exp_f32 v111, v111
    v_mfma_f32_16x16x32_bf16 v[104:107], a[28:31], v[172:175], v[104:107]
    s_waitcnt lgkmcnt(1)
    v_exp_f32 v117, v117
    v_mfma_f32_16x16x32_bf16 v[112:115], a[28:31], v[188:191], v[112:115]
    v_exp_f32 v118, v118
    v_cvt_pk_bf16_f32 v138, v108, v109
    v_exp_f32 v119, v119
    v_mfma_f32_16x16x32_bf16 v[100:103], a[16:19], v[144:147], 0
    ds_read_b128 a[24:27], v202 offset:12288
    v_cvt_pk_bf16_f32 v139, v110, v111
    v_cvt_pk_bf16_f32 v142, v116, v117
    v_mfma_f32_16x16x32_bf16 v[108:111], a[16:19], v[160:163], 0
    ds_read_b128 a[28:31], v203 offset:12288
    v_cvt_pk_bf16_f32 v143, v118, v119
    v_mfma_f32_16x16x32_bf16 v[116:119], a[16:19], v[176:179], 0
    ds_read_b64_tr_b16 a[32:33], v192 offset:8192
    s_waitcnt lgkmcnt(3)
    v_mfma_f32_16x16x32_bf16 v[100:103], a[20:23], v[148:151], v[100:103]
    ds_read_b64_tr_b16 a[36:37], v193 offset:8192
    v_mfma_f32_16x16x32_bf16 v[108:111], a[20:23], v[164:167], v[108:111]
    ds_read_b64_tr_b16 a[40:41], v194 offset:8192
    s_waitcnt lgkmcnt(4)
    v_mfma_f32_16x16x32_bf16 v[116:119], a[20:23], v[180:183], v[116:119]
    ds_read_b64_tr_b16 a[44:45], v195 offset:8192
    v_mfma_f32_16x16x32_bf16 v[100:103], a[24:27], v[152:155], v[100:103]
    ds_read_b64_tr_b16 a[34:35], v192 offset:12288
    v_mfma_f32_16x16x32_bf16 v[108:111], a[24:27], v[168:171], v[108:111]
    ds_read_b64_tr_b16 a[38:39], v193 offset:12288
    s_waitcnt lgkmcnt(6)
    v_mfma_f32_16x16x32_bf16 v[116:119], a[24:27], v[184:187], v[116:119]
    ds_read_b64_tr_b16 a[42:43], v194 offset:12288
    v_mfma_f32_16x16x32_bf16 v[100:103], a[28:31], v[156:159], v[100:103]
    ds_read_b64_tr_b16 a[46:47], v195 offset:12288
    s_add_u32 m0, s64, 16384
    v_mfma_f32_16x16x32_bf16 v[108:111], a[28:31], v[172:175], v[108:111]
    s_mov_b32 s66, 98304
    v_exp_f32 v96, v96
    v_mfma_f32_16x16x32_bf16 v[116:119], a[28:31], v[188:191], v[116:119]
    v_exp_f32 v97, v97
    s_waitcnt vmcnt(0)
    s_barrier
    v_mfma_f32_16x16x32_bf16 a[0:3], a[12:15], v[132:135], a[0:3]
    buffer_load_dwordx4 v205, s[44:47], s66 offen nt lds
    v_mfma_f32_16x16x32_bf16 a[4:7], a[12:15], v[136:139], a[4:7]
    s_waitcnt lgkmcnt(0)
    buffer_load_dwordx4 v206, s[44:47], s66 offen offset:1024 nt lds
    v_mfma_f32_16x16x32_bf16 a[8:11], a[12:15], v[140:143], a[8:11]
    ds_read_b128 a[16:19], v200 offset:16384
    s_add_u32 m0, s64, 49152
    v_mfma_f32_16x16x32_bf16 v[0:3], a[32:35], v[132:135], v[0:3]
    ds_read_b128 a[20:23], v201 offset:16384
    s_mov_b32 s67, 73728
    v_mfma_f32_16x16x32_bf16 v[32:35], a[32:35], v[136:139], v[32:35]
    buffer_load_dwordx4 v205, s[48:51], s67 offen nt lds
    v_mfma_f32_16x16x32_bf16 v[64:67], a[32:35], v[140:143], v[64:67]
    ds_read_b64_tr_b16 a[32:33], v196 offset:8192
    v_cvt_pk_bf16_f32 v120, v96, v97
    v_mfma_f32_16x16x32_bf16 v[4:7], a[36:39], v[132:135], v[4:7]
    ds_read_b64_tr_b16 a[34:35], v196 offset:12288
    v_mfma_f32_16x16x32_bf16 v[36:39], a[36:39], v[136:139], v[36:39]
    buffer_load_dwordx4 v206, s[48:51], s67 offen offset:1024 nt lds
    v_mfma_f32_16x16x32_bf16 v[68:71], a[36:39], v[140:143], v[68:71]
    ds_read_b64_tr_b16 a[36:37], v197 offset:8192
    v_mfma_f32_16x16x32_bf16 v[8:11], a[40:43], v[132:135], v[8:11]
    ds_read_b64_tr_b16 a[38:39], v197 offset:12288
    v_mfma_f32_16x16x32_bf16 v[40:43], a[40:43], v[136:139], v[40:43]
    ds_read_b128 a[24:27], v202 offset:16384
    v_mfma_f32_16x16x32_bf16 v[72:75], a[40:43], v[140:143], v[72:75]
    ds_read_b64_tr_b16 a[40:41], v198 offset:8192
    v_mfma_f32_16x16x32_bf16 v[12:15], a[44:47], v[132:135], v[12:15]
    ds_read_b64_tr_b16 a[42:43], v198 offset:12288
    v_mfma_f32_16x16x32_bf16 v[44:47], a[44:47], v[136:139], v[44:47]
    ds_read_b128 a[28:31], v203 offset:16384
    s_waitcnt lgkmcnt(6)
    v_mfma_f32_16x16x32_bf16 v[76:79], a[44:47], v[140:143], v[76:79]
    ds_read_b64_tr_b16 a[44:45], v199 offset:8192
    v_mfma_f32_16x16x32_bf16 v[16:19], a[32:35], v[132:135], v[16:19]
    ds_read_b64_tr_b16 a[46:47], v199 offset:12288
    v_mfma_f32_16x16x32_bf16 v[48:51], a[32:35], v[136:139], v[48:51]
    s_waitcnt lgkmcnt(6)
    v_exp_f32 v104, v104
    v_mfma_f32_16x16x32_bf16 v[80:83], a[32:35], v[140:143], v[80:83]
    v_exp_f32 v98, v98
    v_mfma_f32_16x16x32_bf16 v[20:23], a[36:39], v[132:135], v[20:23]
    v_exp_f32 v99, v99
    v_mfma_f32_16x16x32_bf16 v[52:55], a[36:39], v[136:139], v[52:55]
    s_waitcnt lgkmcnt(3)
    v_exp_f32 v105, v105
    v_mfma_f32_16x16x32_bf16 v[84:87], a[36:39], v[140:143], v[84:87]
    v_exp_f32 v112, v112
    v_mfma_f32_16x16x32_bf16 v[24:27], a[40:43], v[132:135], v[24:27]
    v_exp_f32 v106, v106
    v_mfma_f32_16x16x32_bf16 v[56:59], a[40:43], v[136:139], v[56:59]
    s_waitcnt lgkmcnt(0)
    v_exp_f32 v107, v107
    v_mfma_f32_16x16x32_bf16 v[88:91], a[40:43], v[140:143], v[88:91]
    v_exp_f32 v113, v113
    v_mfma_f32_16x16x32_bf16 v[28:31], a[44:47], v[132:135], v[28:31]
    v_exp_f32 v114, v114
    v_mfma_f32_16x16x32_bf16 v[60:63], a[44:47], v[136:139], v[60:63]
    v_exp_f32 v115, v115
    v_mfma_f32_16x16x32_bf16 v[92:95], a[44:47], v[140:143], v[92:95]
    v_exp_f32 v100, v100
    v_cvt_pk_bf16_f32 v121, v98, v99
    v_cvt_pk_bf16_f32 v124, v104, v105
    v_mfma_f32_16x16x32_bf16 v[96:99], a[16:19], v[144:147], 0
    v_exp_f32 v101, v101
    v_cvt_pk_bf16_f32 v125, v106, v107
    v_cvt_pk_bf16_f32 v128, v112, v113
    v_mfma_f32_16x16x32_bf16 v[104:107], a[16:19], v[160:163], 0
    v_exp_f32 v108, v108
    v_cvt_pk_bf16_f32 v129, v114, v115
    v_mfma_f32_16x16x32_bf16 v[112:115], a[16:19], v[176:179], 0
    ds_read_b128 a[16:19], v200 offset:20480
    v_cvt_pk_bf16_f32 v122, v100, v101
    v_mfma_f32_16x16x32_bf16 v[96:99], a[20:23], v[148:151], v[96:99]
    v_exp_f32 v102, v102
    v_mfma_f32_16x16x32_bf16 v[104:107], a[20:23], v[164:167], v[104:107]
    v_exp_f32 v103, v103
    v_mfma_f32_16x16x32_bf16 v[112:115], a[20:23], v[180:183], v[112:115]
    v_exp_f32 v109, v109
    v_mfma_f32_16x16x32_bf16 v[96:99], a[24:27], v[152:155], v[96:99]
    v_exp_f32 v116, v116
    v_mfma_f32_16x16x32_bf16 v[104:107], a[24:27], v[168:171], v[104:107]
    ds_read_b128 a[20:23], v201 offset:20480
    v_cvt_pk_bf16_f32 v123, v102, v103
    v_mfma_f32_16x16x32_bf16 v[112:115], a[24:27], v[184:187], v[112:115]
    v_exp_f32 v110, v110
    v_mfma_f32_16x16x32_bf16 v[96:99], a[28:31], v[156:159], v[96:99]
    v_exp_f32 v111, v111
    v_mfma_f32_16x16x32_bf16 v[104:107], a[28:31], v[172:175], v[104:107]
    s_waitcnt lgkmcnt(1)
    v_exp_f32 v117, v117
    v_mfma_f32_16x16x32_bf16 v[112:115], a[28:31], v[188:191], v[112:115]
    v_exp_f32 v118, v118
    v_cvt_pk_bf16_f32 v126, v108, v109
    v_exp_f32 v119, v119
    v_mfma_f32_16x16x32_bf16 v[100:103], a[16:19], v[144:147], 0
    ds_read_b128 a[24:27], v202 offset:20480
    v_cvt_pk_bf16_f32 v127, v110, v111
    v_cvt_pk_bf16_f32 v130, v116, v117
    v_mfma_f32_16x16x32_bf16 v[108:111], a[16:19], v[160:163], 0
    ds_read_b128 a[28:31], v203 offset:20480
    v_cvt_pk_bf16_f32 v131, v118, v119
    v_mfma_f32_16x16x32_bf16 v[116:119], a[16:19], v[176:179], 0
    ds_read_b64_tr_b16 a[32:33], v192 offset:40960
    s_waitcnt lgkmcnt(3)
    v_mfma_f32_16x16x32_bf16 v[100:103], a[20:23], v[148:151], v[100:103]
    ds_read_b64_tr_b16 a[36:37], v193 offset:40960
    v_mfma_f32_16x16x32_bf16 v[108:111], a[20:23], v[164:167], v[108:111]
    ds_read_b64_tr_b16 a[40:41], v194 offset:40960
    s_waitcnt lgkmcnt(4)
    v_mfma_f32_16x16x32_bf16 v[116:119], a[20:23], v[180:183], v[116:119]
    ds_read_b64_tr_b16 a[44:45], v195 offset:40960
    v_mfma_f32_16x16x32_bf16 v[100:103], a[24:27], v[152:155], v[100:103]
    ds_read_b64_tr_b16 a[34:35], v192 offset:45056
    v_mfma_f32_16x16x32_bf16 v[108:111], a[24:27], v[168:171], v[108:111]
    ds_read_b64_tr_b16 a[38:39], v193 offset:45056
    s_waitcnt lgkmcnt(6)
    v_mfma_f32_16x16x32_bf16 v[116:119], a[24:27], v[184:187], v[116:119]
    ds_read_b64_tr_b16 a[42:43], v194 offset:45056
    v_mfma_f32_16x16x32_bf16 v[100:103], a[28:31], v[156:159], v[100:103]
    ds_read_b64_tr_b16 a[46:47], v195 offset:45056
    s_add_u32 m0, s64, 24576
    v_mfma_f32_16x16x32_bf16 v[108:111], a[28:31], v[172:175], v[108:111]
    s_mov_b32 s66, 106496
    v_exp_f32 v96, v96
    v_mfma_f32_16x16x32_bf16 v[116:119], a[28:31], v[188:191], v[116:119]
    v_exp_f32 v97, v97
    s_waitcnt vmcnt(0)
    s_barrier
    v_mfma_f32_16x16x32_bf16 a[0:3], a[12:15], v[120:123], a[0:3]
    buffer_load_dwordx4 v205, s[44:47], s66 offen nt lds
    v_mfma_f32_16x16x32_bf16 a[4:7], a[12:15], v[124:127], a[4:7]
    s_waitcnt lgkmcnt(0)
    buffer_load_dwordx4 v206, s[44:47], s66 offen offset:1024 nt lds
    v_mfma_f32_16x16x32_bf16 a[8:11], a[12:15], v[128:131], a[8:11]
    ds_read_b128 a[16:19], v200 offset:49152
    s_add_u32 m0, s64, 57344
    v_mfma_f32_16x16x32_bf16 v[0:3], a[32:35], v[120:123], v[0:3]
    ds_read_b128 a[20:23], v201 offset:49152
    s_mov_b32 s67, 81920
    v_mfma_f32_16x16x32_bf16 v[32:35], a[32:35], v[124:127], v[32:35]
    buffer_load_dwordx4 v205, s[48:51], s67 offen nt lds
    v_mfma_f32_16x16x32_bf16 v[64:67], a[32:35], v[128:131], v[64:67]
    ds_read_b64_tr_b16 a[32:33], v196 offset:40960
    v_cvt_pk_bf16_f32 v132, v96, v97
    v_mfma_f32_16x16x32_bf16 v[4:7], a[36:39], v[120:123], v[4:7]
    ds_read_b64_tr_b16 a[34:35], v196 offset:45056
    v_mfma_f32_16x16x32_bf16 v[36:39], a[36:39], v[124:127], v[36:39]
    buffer_load_dwordx4 v206, s[48:51], s67 offen offset:1024 nt lds
    v_mfma_f32_16x16x32_bf16 v[68:71], a[36:39], v[128:131], v[68:71]
    ds_read_b64_tr_b16 a[36:37], v197 offset:40960
    v_mfma_f32_16x16x32_bf16 v[8:11], a[40:43], v[120:123], v[8:11]
    ds_read_b64_tr_b16 a[38:39], v197 offset:45056
    v_mfma_f32_16x16x32_bf16 v[40:43], a[40:43], v[124:127], v[40:43]
    ds_read_b128 a[24:27], v202 offset:49152
    v_mfma_f32_16x16x32_bf16 v[72:75], a[40:43], v[128:131], v[72:75]
    ds_read_b64_tr_b16 a[40:41], v198 offset:40960
    v_mfma_f32_16x16x32_bf16 v[12:15], a[44:47], v[120:123], v[12:15]
    ds_read_b64_tr_b16 a[42:43], v198 offset:45056
    v_mfma_f32_16x16x32_bf16 v[44:47], a[44:47], v[124:127], v[44:47]
    ds_read_b128 a[28:31], v203 offset:49152
    s_waitcnt lgkmcnt(6)
    v_mfma_f32_16x16x32_bf16 v[76:79], a[44:47], v[128:131], v[76:79]
    ds_read_b64_tr_b16 a[44:45], v199 offset:40960
    v_mfma_f32_16x16x32_bf16 v[16:19], a[32:35], v[120:123], v[16:19]
    ds_read_b64_tr_b16 a[46:47], v199 offset:45056
    v_mfma_f32_16x16x32_bf16 v[48:51], a[32:35], v[124:127], v[48:51]
    s_waitcnt lgkmcnt(6)
    v_exp_f32 v104, v104
    v_mfma_f32_16x16x32_bf16 v[80:83], a[32:35], v[128:131], v[80:83]
    v_exp_f32 v98, v98
    v_mfma_f32_16x16x32_bf16 v[20:23], a[36:39], v[120:123], v[20:23]
    v_exp_f32 v99, v99
    v_mfma_f32_16x16x32_bf16 v[52:55], a[36:39], v[124:127], v[52:55]
    s_waitcnt lgkmcnt(3)
    v_exp_f32 v105, v105
    v_mfma_f32_16x16x32_bf16 v[84:87], a[36:39], v[128:131], v[84:87]
    v_exp_f32 v112, v112
    v_mfma_f32_16x16x32_bf16 v[24:27], a[40:43], v[120:123], v[24:27]
    v_exp_f32 v106, v106
    v_mfma_f32_16x16x32_bf16 v[56:59], a[40:43], v[124:127], v[56:59]
    s_waitcnt lgkmcnt(0)
    v_exp_f32 v107, v107
    v_mfma_f32_16x16x32_bf16 v[88:91], a[40:43], v[128:131], v[88:91]
    v_exp_f32 v113, v113
    v_mfma_f32_16x16x32_bf16 v[28:31], a[44:47], v[120:123], v[28:31]
    v_exp_f32 v114, v114
    v_mfma_f32_16x16x32_bf16 v[60:63], a[44:47], v[124:127], v[60:63]
    v_exp_f32 v115, v115
    v_mfma_f32_16x16x32_bf16 v[92:95], a[44:47], v[128:131], v[92:95]
    v_exp_f32 v100, v100
    v_cvt_pk_bf16_f32 v133, v98, v99
    v_cvt_pk_bf16_f32 v136, v104, v105
    v_mfma_f32_16x16x32_bf16 v[96:99], a[16:19], v[144:147], 0
    v_exp_f32 v101, v101
    v_cvt_pk_bf16_f32 v137, v106, v107
    v_cvt_pk_bf16_f32 v140, v112, v113
    v_mfma_f32_16x16x32_bf16 v[104:107], a[16:19], v[160:163], 0
    v_exp_f32 v108, v108
    v_cvt_pk_bf16_f32 v141, v114, v115
    v_mfma_f32_16x16x32_bf16 v[112:115], a[16:19], v[176:179], 0
    ds_read_b128 a[16:19], v200 offset:53248
    v_cvt_pk_bf16_f32 v134, v100, v101
    v_mfma_f32_16x16x32_bf16 v[96:99], a[20:23], v[148:151], v[96:99]
    v_exp_f32 v102, v102
    v_mfma_f32_16x16x32_bf16 v[104:107], a[20:23], v[164:167], v[104:107]
    v_exp_f32 v103, v103
    v_mfma_f32_16x16x32_bf16 v[112:115], a[20:23], v[180:183], v[112:115]
    v_exp_f32 v109, v109
    v_mfma_f32_16x16x32_bf16 v[96:99], a[24:27], v[152:155], v[96:99]
    v_exp_f32 v116, v116
    v_mfma_f32_16x16x32_bf16 v[104:107], a[24:27], v[168:171], v[104:107]
    ds_read_b128 a[20:23], v201 offset:53248
    v_cvt_pk_bf16_f32 v135, v102, v103
    v_mfma_f32_16x16x32_bf16 v[112:115], a[24:27], v[184:187], v[112:115]
    v_exp_f32 v110, v110
    v_mfma_f32_16x16x32_bf16 v[96:99], a[28:31], v[156:159], v[96:99]
    v_exp_f32 v111, v111
    v_mfma_f32_16x16x32_bf16 v[104:107], a[28:31], v[172:175], v[104:107]
    s_waitcnt lgkmcnt(1)
    v_exp_f32 v117, v117
    v_mfma_f32_16x16x32_bf16 v[112:115], a[28:31], v[188:191], v[112:115]
    v_exp_f32 v118, v118
    v_cvt_pk_bf16_f32 v138, v108, v109
    v_exp_f32 v119, v119
    v_mfma_f32_16x16x32_bf16 v[100:103], a[16:19], v[144:147], 0
    ds_read_b128 a[24:27], v202 offset:53248
    v_cvt_pk_bf16_f32 v139, v110, v111
    v_cvt_pk_bf16_f32 v142, v116, v117
    v_mfma_f32_16x16x32_bf16 v[108:111], a[16:19], v[160:163], 0
    ds_read_b128 a[28:31], v203 offset:53248
    v_cvt_pk_bf16_f32 v143, v118, v119
    v_mfma_f32_16x16x32_bf16 v[116:119], a[16:19], v[176:179], 0
    ds_read_b64_tr_b16 a[32:33], v192 offset:49152
    s_waitcnt lgkmcnt(3)
    v_mfma_f32_16x16x32_bf16 v[100:103], a[20:23], v[148:151], v[100:103]
    ds_read_b64_tr_b16 a[36:37], v193 offset:49152
    v_mfma_f32_16x16x32_bf16 v[108:111], a[20:23], v[164:167], v[108:111]
    ds_read_b64_tr_b16 a[40:41], v194 offset:49152
    s_waitcnt lgkmcnt(4)
    v_mfma_f32_16x16x32_bf16 v[116:119], a[20:23], v[180:183], v[116:119]
    ds_read_b64_tr_b16 a[44:45], v195 offset:49152
    v_mfma_f32_16x16x32_bf16 v[100:103], a[24:27], v[152:155], v[100:103]
    ds_read_b64_tr_b16 a[34:35], v192 offset:53248
    v_mfma_f32_16x16x32_bf16 v[108:111], a[24:27], v[168:171], v[108:111]
    ds_read_b64_tr_b16 a[38:39], v193 offset:53248
    s_waitcnt lgkmcnt(6)
    v_mfma_f32_16x16x32_bf16 v[116:119], a[24:27], v[184:187], v[116:119]
    ds_read_b64_tr_b16 a[42:43], v194 offset:53248
    v_mfma_f32_16x16x32_bf16 v[100:103], a[28:31], v[156:159], v[100:103]
    ds_read_b64_tr_b16 a[46:47], v195 offset:53248
    s_add_u32 m0, s64, 32768
    v_mfma_f32_16x16x32_bf16 v[108:111], a[28:31], v[172:175], v[108:111]
    s_mov_b32 s66, 114688
    v_exp_f32 v96, v96
    v_mfma_f32_16x16x32_bf16 v[116:119], a[28:31], v[188:191], v[116:119]
    v_exp_f32 v97, v97
    s_waitcnt vmcnt(0)
    s_barrier
    v_mfma_f32_16x16x32_bf16 a[0:3], a[12:15], v[132:135], a[0:3]
    buffer_load_dwordx4 v205, s[44:47], s66 offen nt lds
    v_mfma_f32_16x16x32_bf16 a[4:7], a[12:15], v[136:139], a[4:7]
    s_waitcnt lgkmcnt(0)
    buffer_load_dwordx4 v206, s[44:47], s66 offen offset:1024 nt lds
    v_mfma_f32_16x16x32_bf16 a[8:11], a[12:15], v[140:143], a[8:11]
    ds_read_b128 a[16:19], v200 offset:57344
    s_add_u32 m0, s64, 0
    v_mfma_f32_16x16x32_bf16 v[0:3], a[32:35], v[132:135], v[0:3]
    ds_read_b128 a[20:23], v201 offset:57344
    s_mov_b32 s67, 90112
    v_mfma_f32_16x16x32_bf16 v[32:35], a[32:35], v[136:139], v[32:35]
    buffer_load_dwordx4 v205, s[48:51], s67 offen nt lds
    v_mfma_f32_16x16x32_bf16 v[64:67], a[32:35], v[140:143], v[64:67]
    ds_read_b64_tr_b16 a[32:33], v196 offset:49152
    v_cvt_pk_bf16_f32 v120, v96, v97
    v_mfma_f32_16x16x32_bf16 v[4:7], a[36:39], v[132:135], v[4:7]
    ds_read_b64_tr_b16 a[34:35], v196 offset:53248
    v_mfma_f32_16x16x32_bf16 v[36:39], a[36:39], v[136:139], v[36:39]
    buffer_load_dwordx4 v206, s[48:51], s67 offen offset:1024 nt lds
    v_mfma_f32_16x16x32_bf16 v[68:71], a[36:39], v[140:143], v[68:71]
    ds_read_b64_tr_b16 a[36:37], v197 offset:49152
    v_mfma_f32_16x16x32_bf16 v[8:11], a[40:43], v[132:135], v[8:11]
    ds_read_b64_tr_b16 a[38:39], v197 offset:53248
    v_mfma_f32_16x16x32_bf16 v[40:43], a[40:43], v[136:139], v[40:43]
    ds_read_b128 a[24:27], v202 offset:57344
    v_mfma_f32_16x16x32_bf16 v[72:75], a[40:43], v[140:143], v[72:75]
    ds_read_b64_tr_b16 a[40:41], v198 offset:49152
    v_mfma_f32_16x16x32_bf16 v[12:15], a[44:47], v[132:135], v[12:15]
    ds_read_b64_tr_b16 a[42:43], v198 offset:53248
    v_mfma_f32_16x16x32_bf16 v[44:47], a[44:47], v[136:139], v[44:47]
    ds_read_b128 a[28:31], v203 offset:57344
    s_waitcnt lgkmcnt(6)
    v_mfma_f32_16x16x32_bf16 v[76:79], a[44:47], v[140:143], v[76:79]
    ds_read_b64_tr_b16 a[44:45], v199 offset:49152
    v_mfma_f32_16x16x32_bf16 v[16:19], a[32:35], v[132:135], v[16:19]
    ds_read_b64_tr_b16 a[46:47], v199 offset:53248
    v_mfma_f32_16x16x32_bf16 v[48:51], a[32:35], v[136:139], v[48:51]
    s_waitcnt lgkmcnt(6)
    v_exp_f32 v104, v104
    v_mfma_f32_16x16x32_bf16 v[80:83], a[32:35], v[140:143], v[80:83]
    v_exp_f32 v98, v98
    v_mfma_f32_16x16x32_bf16 v[20:23], a[36:39], v[132:135], v[20:23]
    v_exp_f32 v99, v99
    v_mfma_f32_16x16x32_bf16 v[52:55], a[36:39], v[136:139], v[52:55]
    s_waitcnt lgkmcnt(3)
    v_exp_f32 v105, v105
    v_mfma_f32_16x16x32_bf16 v[84:87], a[36:39], v[140:143], v[84:87]
    v_exp_f32 v112, v112
    v_mfma_f32_16x16x32_bf16 v[24:27], a[40:43], v[132:135], v[24:27]
    v_exp_f32 v106, v106
    v_mfma_f32_16x16x32_bf16 v[56:59], a[40:43], v[136:139], v[56:59]
    s_waitcnt lgkmcnt(0)
    v_exp_f32 v107, v107
    v_mfma_f32_16x16x32_bf16 v[88:91], a[40:43], v[140:143], v[88:91]
    v_exp_f32 v113, v113
    v_mfma_f32_16x16x32_bf16 v[28:31], a[44:47], v[132:135], v[28:31]
    v_exp_f32 v114, v114
    v_mfma_f32_16x16x32_bf16 v[60:63], a[44:47], v[136:139], v[60:63]
    v_exp_f32 v115, v115
    v_mfma_f32_16x16x32_bf16 v[92:95], a[44:47], v[140:143], v[92:95]
    v_exp_f32 v100, v100
    v_cvt_pk_bf16_f32 v121, v98, v99
    v_cvt_pk_bf16_f32 v124, v104, v105
    v_mfma_f32_16x16x32_bf16 v[96:99], a[16:19], v[144:147], 0
    v_exp_f32 v101, v101
    v_cvt_pk_bf16_f32 v125, v106, v107
    v_cvt_pk_bf16_f32 v128, v112, v113
    v_mfma_f32_16x16x32_bf16 v[104:107], a[16:19], v[160:163], 0
    v_exp_f32 v108, v108
    v_cvt_pk_bf16_f32 v129, v114, v115
    v_mfma_f32_16x16x32_bf16 v[112:115], a[16:19], v[176:179], 0
    ds_read_b128 a[16:19], v200 offset:61440
    v_cvt_pk_bf16_f32 v122, v100, v101
    v_mfma_f32_16x16x32_bf16 v[96:99], a[20:23], v[148:151], v[96:99]
    v_exp_f32 v102, v102
    v_mfma_f32_16x16x32_bf16 v[104:107], a[20:23], v[164:167], v[104:107]
    v_exp_f32 v103, v103
    v_mfma_f32_16x16x32_bf16 v[112:115], a[20:23], v[180:183], v[112:115]
    v_exp_f32 v109, v109
    v_mfma_f32_16x16x32_bf16 v[96:99], a[24:27], v[152:155], v[96:99]
    v_exp_f32 v116, v116
    v_mfma_f32_16x16x32_bf16 v[104:107], a[24:27], v[168:171], v[104:107]
    ds_read_b128 a[20:23], v201 offset:61440
    v_cvt_pk_bf16_f32 v123, v102, v103
    v_mfma_f32_16x16x32_bf16 v[112:115], a[24:27], v[184:187], v[112:115]
    v_exp_f32 v110, v110
    v_mfma_f32_16x16x32_bf16 v[96:99], a[28:31], v[156:159], v[96:99]
    v_exp_f32 v111, v111
    v_mfma_f32_16x16x32_bf16 v[104:107], a[28:31], v[172:175], v[104:107]
    s_waitcnt lgkmcnt(1)
    v_exp_f32 v117, v117
    v_mfma_f32_16x16x32_bf16 v[112:115], a[28:31], v[188:191], v[112:115]
    v_exp_f32 v118, v118
    v_cvt_pk_bf16_f32 v126, v108, v109
    v_exp_f32 v119, v119
    v_mfma_f32_16x16x32_bf16 v[100:103], a[16:19], v[144:147], 0
    ds_read_b128 a[24:27], v202 offset:61440
    v_cvt_pk_bf16_f32 v127, v110, v111
    v_cvt_pk_bf16_f32 v130, v116, v117
    v_mfma_f32_16x16x32_bf16 v[108:111], a[16:19], v[160:163], 0
    ds_read_b128 a[28:31], v203 offset:61440
    v_cvt_pk_bf16_f32 v131, v118, v119
    v_mfma_f32_16x16x32_bf16 v[116:119], a[16:19], v[176:179], 0
    ds_read_b64_tr_b16 a[32:33], v192 offset:57344
    s_waitcnt lgkmcnt(3)
    v_mfma_f32_16x16x32_bf16 v[100:103], a[20:23], v[148:151], v[100:103]
    ds_read_b64_tr_b16 a[36:37], v193 offset:57344
    v_mfma_f32_16x16x32_bf16 v[108:111], a[20:23], v[164:167], v[108:111]
    ds_read_b64_tr_b16 a[40:41], v194 offset:57344
    s_waitcnt lgkmcnt(4)
    v_mfma_f32_16x16x32_bf16 v[116:119], a[20:23], v[180:183], v[116:119]
    ds_read_b64_tr_b16 a[44:45], v195 offset:57344
    v_mfma_f32_16x16x32_bf16 v[100:103], a[24:27], v[152:155], v[100:103]
    ds_read_b64_tr_b16 a[34:35], v192 offset:61440
    v_mfma_f32_16x16x32_bf16 v[108:111], a[24:27], v[168:171], v[108:111]
    ds_read_b64_tr_b16 a[38:39], v193 offset:61440
    s_waitcnt lgkmcnt(6)
    v_mfma_f32_16x16x32_bf16 v[116:119], a[24:27], v[184:187], v[116:119]
    ds_read_b64_tr_b16 a[42:43], v194 offset:61440
    v_mfma_f32_16x16x32_bf16 v[100:103], a[28:31], v[156:159], v[100:103]
    ds_read_b64_tr_b16 a[46:47], v195 offset:61440
    s_add_u32 m0, s64, 65536
    v_mfma_f32_16x16x32_bf16 v[108:111], a[28:31], v[172:175], v[108:111]
    s_mov_b32 s66, 122880
    v_exp_f32 v96, v96
    v_mfma_f32_16x16x32_bf16 v[116:119], a[28:31], v[188:191], v[116:119]
    v_exp_f32 v97, v97
    s_waitcnt vmcnt(0)
    s_barrier
    v_mfma_f32_16x16x32_bf16 a[0:3], a[12:15], v[120:123], a[0:3]
    buffer_load_dwordx4 v205, s[44:47], s66 offen nt lds
    v_mfma_f32_16x16x32_bf16 a[4:7], a[12:15], v[124:127], a[4:7]
    s_waitcnt lgkmcnt(0)
    buffer_load_dwordx4 v206, s[44:47], s66 offen offset:1024 nt lds
    v_mfma_f32_16x16x32_bf16 a[8:11], a[12:15], v[128:131], a[8:11]
    ds_read_b128 a[16:19], v200
    s_add_u32 m0, s64, 8192
    v_mfma_f32_16x16x32_bf16 v[0:3], a[32:35], v[120:123], v[0:3]
    ds_read_b128 a[20:23], v201
    s_mov_b32 s67, 98304
    v_mfma_f32_16x16x32_bf16 v[32:35], a[32:35], v[124:127], v[32:35]
    buffer_load_dwordx4 v205, s[48:51], s67 offen nt lds
    v_mfma_f32_16x16x32_bf16 v[64:67], a[32:35], v[128:131], v[64:67]
    ds_read_b64_tr_b16 a[32:33], v196 offset:57344
    v_cvt_pk_bf16_f32 v132, v96, v97
    v_mfma_f32_16x16x32_bf16 v[4:7], a[36:39], v[120:123], v[4:7]
    ds_read_b64_tr_b16 a[34:35], v196 offset:61440
    v_mfma_f32_16x16x32_bf16 v[36:39], a[36:39], v[124:127], v[36:39]
    buffer_load_dwordx4 v206, s[48:51], s67 offen offset:1024 nt lds
    v_mfma_f32_16x16x32_bf16 v[68:71], a[36:39], v[128:131], v[68:71]
    ds_read_b64_tr_b16 a[36:37], v197 offset:57344
    v_mfma_f32_16x16x32_bf16 v[8:11], a[40:43], v[120:123], v[8:11]
    ds_read_b64_tr_b16 a[38:39], v197 offset:61440
    v_mfma_f32_16x16x32_bf16 v[40:43], a[40:43], v[124:127], v[40:43]
    ds_read_b128 a[24:27], v202
    v_mfma_f32_16x16x32_bf16 v[72:75], a[40:43], v[128:131], v[72:75]
    ds_read_b64_tr_b16 a[40:41], v198 offset:57344
    v_mfma_f32_16x16x32_bf16 v[12:15], a[44:47], v[120:123], v[12:15]
    ds_read_b64_tr_b16 a[42:43], v198 offset:61440
    v_mfma_f32_16x16x32_bf16 v[44:47], a[44:47], v[124:127], v[44:47]
    ds_read_b128 a[28:31], v203
    s_waitcnt lgkmcnt(6)
    v_mfma_f32_16x16x32_bf16 v[76:79], a[44:47], v[128:131], v[76:79]
    ds_read_b64_tr_b16 a[44:45], v199 offset:57344
    v_mfma_f32_16x16x32_bf16 v[16:19], a[32:35], v[120:123], v[16:19]
    ds_read_b64_tr_b16 a[46:47], v199 offset:61440
    v_mfma_f32_16x16x32_bf16 v[48:51], a[32:35], v[124:127], v[48:51]
    s_waitcnt lgkmcnt(6)
    v_exp_f32 v104, v104
    v_mfma_f32_16x16x32_bf16 v[80:83], a[32:35], v[128:131], v[80:83]
    v_exp_f32 v98, v98
    v_mfma_f32_16x16x32_bf16 v[20:23], a[36:39], v[120:123], v[20:23]
    v_exp_f32 v99, v99
    v_mfma_f32_16x16x32_bf16 v[52:55], a[36:39], v[124:127], v[52:55]
    s_waitcnt lgkmcnt(3)
    v_exp_f32 v105, v105
    v_mfma_f32_16x16x32_bf16 v[84:87], a[36:39], v[128:131], v[84:87]
    v_exp_f32 v112, v112
    v_mfma_f32_16x16x32_bf16 v[24:27], a[40:43], v[120:123], v[24:27]
    v_exp_f32 v106, v106
    v_mfma_f32_16x16x32_bf16 v[56:59], a[40:43], v[124:127], v[56:59]
    s_waitcnt lgkmcnt(0)
    v_exp_f32 v107, v107
    v_mfma_f32_16x16x32_bf16 v[88:91], a[40:43], v[128:131], v[88:91]
    v_exp_f32 v113, v113
    v_mfma_f32_16x16x32_bf16 v[28:31], a[44:47], v[120:123], v[28:31]
    v_exp_f32 v114, v114
    v_mfma_f32_16x16x32_bf16 v[60:63], a[44:47], v[124:127], v[60:63]
    v_exp_f32 v115, v115
    v_mfma_f32_16x16x32_bf16 v[92:95], a[44:47], v[128:131], v[92:95]
    v_exp_f32 v100, v100
    v_cvt_pk_bf16_f32 v133, v98, v99
    v_cvt_pk_bf16_f32 v136, v104, v105
    v_mfma_f32_16x16x32_bf16 v[96:99], a[16:19], v[144:147], 0
    v_exp_f32 v101, v101
    v_cvt_pk_bf16_f32 v137, v106, v107
    v_cvt_pk_bf16_f32 v140, v112, v113
    v_mfma_f32_16x16x32_bf16 v[104:107], a[16:19], v[160:163], 0
    v_exp_f32 v108, v108
    v_cvt_pk_bf16_f32 v141, v114, v115
    v_mfma_f32_16x16x32_bf16 v[112:115], a[16:19], v[176:179], 0
    ds_read_b128 a[16:19], v200 offset:4096
    v_cvt_pk_bf16_f32 v134, v100, v101
    v_mfma_f32_16x16x32_bf16 v[96:99], a[20:23], v[148:151], v[96:99]
    v_exp_f32 v102, v102
    v_mfma_f32_16x16x32_bf16 v[104:107], a[20:23], v[164:167], v[104:107]
    v_exp_f32 v103, v103
    v_mfma_f32_16x16x32_bf16 v[112:115], a[20:23], v[180:183], v[112:115]
    v_exp_f32 v109, v109
    v_mfma_f32_16x16x32_bf16 v[96:99], a[24:27], v[152:155], v[96:99]
    v_exp_f32 v116, v116
    v_mfma_f32_16x16x32_bf16 v[104:107], a[24:27], v[168:171], v[104:107]
    ds_read_b128 a[20:23], v201 offset:4096
    v_cvt_pk_bf16_f32 v135, v102, v103
    v_mfma_f32_16x16x32_bf16 v[112:115], a[24:27], v[184:187], v[112:115]
    v_exp_f32 v110, v110
    v_mfma_f32_16x16x32_bf16 v[96:99], a[28:31], v[156:159], v[96:99]
    v_exp_f32 v111, v111
    v_mfma_f32_16x16x32_bf16 v[104:107], a[28:31], v[172:175], v[104:107]
    s_waitcnt lgkmcnt(1)
    v_exp_f32 v117, v117
    v_mfma_f32_16x16x32_bf16 v[112:115], a[28:31], v[188:191], v[112:115]
    v_exp_f32 v118, v118
    v_cvt_pk_bf16_f32 v138, v108, v109
    v_exp_f32 v119, v119
    v_mfma_f32_16x16x32_bf16 v[100:103], a[16:19], v[144:147], 0
    ds_read_b128 a[24:27], v202 offset:4096
    v_cvt_pk_bf16_f32 v139, v110, v111
    v_cvt_pk_bf16_f32 v142, v116, v117
    v_mfma_f32_16x16x32_bf16 v[108:111], a[16:19], v[160:163], 0
    ds_read_b128 a[28:31], v203 offset:4096
    v_cvt_pk_bf16_f32 v143, v118, v119
    v_mfma_f32_16x16x32_bf16 v[116:119], a[16:19], v[176:179], 0
    ds_read_b64_tr_b16 a[32:33], v192
    s_waitcnt lgkmcnt(3)
    v_mfma_f32_16x16x32_bf16 v[100:103], a[20:23], v[148:151], v[100:103]
    ds_read_b64_tr_b16 a[36:37], v193
    v_mfma_f32_16x16x32_bf16 v[108:111], a[20:23], v[164:167], v[108:111]
    ds_read_b64_tr_b16 a[40:41], v194
    s_waitcnt lgkmcnt(4)
    v_mfma_f32_16x16x32_bf16 v[116:119], a[20:23], v[180:183], v[116:119]
    ds_read_b64_tr_b16 a[44:45], v195
    v_mfma_f32_16x16x32_bf16 v[100:103], a[24:27], v[152:155], v[100:103]
    ds_read_b64_tr_b16 a[34:35], v192 offset:4096
    v_mfma_f32_16x16x32_bf16 v[108:111], a[24:27], v[168:171], v[108:111]
    ds_read_b64_tr_b16 a[38:39], v193 offset:4096
    s_waitcnt lgkmcnt(6)
    v_mfma_f32_16x16x32_bf16 v[116:119], a[24:27], v[184:187], v[116:119]
    ds_read_b64_tr_b16 a[42:43], v194 offset:4096
    v_mfma_f32_16x16x32_bf16 v[100:103], a[28:31], v[156:159], v[100:103]
    ds_read_b64_tr_b16 a[46:47], v195 offset:4096
    v_mfma_f32_16x16x32_bf16 v[108:111], a[28:31], v[172:175], v[108:111]
    v_exp_f32 v96, v96
    v_mfma_f32_16x16x32_bf16 v[116:119], a[28:31], v[188:191], v[116:119]
    v_exp_f32 v97, v97
    s_waitcnt vmcnt(0)
    s_barrier
    v_mfma_f32_16x16x32_bf16 a[0:3], a[12:15], v[132:135], a[0:3]
    ds_read_b128 a[16:19], v200 offset:8192
    v_cvt_pk_bf16_f32 v120, v96, v97
    v_mfma_f32_16x16x32_bf16 a[4:7], a[12:15], v[136:139], a[4:7]
    ds_read_b128 a[20:23], v201 offset:8192
    s_waitcnt lgkmcnt(2)
    v_mfma_f32_16x16x32_bf16 a[8:11], a[12:15], v[140:143], a[8:11]
    ds_read_b128 a[24:27], v202 offset:8192
    s_add_u32 m0, s64, 40960
    v_mfma_f32_16x16x32_bf16 v[0:3], a[32:35], v[132:135], v[0:3]
    ds_read_b128 a[28:31], v203 offset:8192
    s_mov_b32 s67, 106496
    v_mfma_f32_16x16x32_bf16 v[32:35], a[32:35], v[136:139], v[32:35]
    buffer_load_dwordx4 v205, s[48:51], s67 offen nt lds
    v_mfma_f32_16x16x32_bf16 v[64:67], a[32:35], v[140:143], v[64:67]
    ds_read_b64_tr_b16 a[32:33], v196
    v_mfma_f32_16x16x32_bf16 v[4:7], a[36:39], v[132:135], v[4:7]
    ds_read_b64_tr_b16 a[34:35], v196 offset:4096
    v_mfma_f32_16x16x32_bf16 v[36:39], a[36:39], v[136:139], v[36:39]
    buffer_load_dwordx4 v206, s[48:51], s67 offen offset:1024 nt lds
    v_mfma_f32_16x16x32_bf16 v[68:71], a[36:39], v[140:143], v[68:71]
    ds_read_b64_tr_b16 a[36:37], v197
    v_mfma_f32_16x16x32_bf16 v[8:11], a[40:43], v[132:135], v[8:11]
    ds_read_b64_tr_b16 a[38:39], v197 offset:4096
    v_mfma_f32_16x16x32_bf16 v[40:43], a[40:43], v[136:139], v[40:43]
    v_exp_f32 v104, v104
    v_mfma_f32_16x16x32_bf16 v[72:75], a[40:43], v[140:143], v[72:75]
    ds_read_b64_tr_b16 a[40:41], v198
    v_mfma_f32_16x16x32_bf16 v[12:15], a[44:47], v[132:135], v[12:15]
    ds_read_b64_tr_b16 a[42:43], v198 offset:4096
    v_mfma_f32_16x16x32_bf16 v[44:47], a[44:47], v[136:139], v[44:47]
    s_waitcnt lgkmcnt(4)
    v_exp_f32 v98, v98
    v_mfma_f32_16x16x32_bf16 v[76:79], a[44:47], v[140:143], v[76:79]
    ds_read_b64_tr_b16 a[44:45], v199
    v_mfma_f32_16x16x32_bf16 v[16:19], a[32:35], v[132:135], v[16:19]
    ds_read_b64_tr_b16 a[46:47], v199 offset:4096
    v_mfma_f32_16x16x32_bf16 v[48:51], a[32:35], v[136:139], v[48:51]
    s_waitcnt lgkmcnt(4)
    v_exp_f32 v99, v99
    v_mfma_f32_16x16x32_bf16 v[80:83], a[32:35], v[140:143], v[80:83]
    v_exp_f32 v105, v105
    v_mfma_f32_16x16x32_bf16 v[20:23], a[36:39], v[132:135], v[20:23]
    v_exp_f32 v112, v112
    v_mfma_f32_16x16x32_bf16 v[52:55], a[36:39], v[136:139], v[52:55]
    s_waitcnt lgkmcnt(2)
    v_exp_f32 v106, v106
    v_mfma_f32_16x16x32_bf16 v[84:87], a[36:39], v[140:143], v[84:87]
    v_exp_f32 v107, v107
    v_mfma_f32_16x16x32_bf16 v[24:27], a[40:43], v[132:135], v[24:27]
    v_exp_f32 v113, v113
    v_mfma_f32_16x16x32_bf16 v[56:59], a[40:43], v[136:139], v[56:59]
    s_waitcnt lgkmcnt(0)
    v_exp_f32 v114, v114
    v_mfma_f32_16x16x32_bf16 v[88:91], a[40:43], v[140:143], v[88:91]
    v_exp_f32 v115, v115
    v_mfma_f32_16x16x32_bf16 v[28:31], a[44:47], v[132:135], v[28:31]
    v_exp_f32 v100, v100
    v_mfma_f32_16x16x32_bf16 v[60:63], a[44:47], v[136:139], v[60:63]
    v_exp_f32 v101, v101
    v_mfma_f32_16x16x32_bf16 v[92:95], a[44:47], v[140:143], v[92:95]
    v_exp_f32 v108, v108
    v_cvt_pk_bf16_f32 v121, v98, v99
    v_cvt_pk_bf16_f32 v124, v104, v105
    v_mfma_f32_16x16x32_bf16 v[96:99], a[16:19], v[144:147], 0
    v_exp_f32 v102, v102
    v_cvt_pk_bf16_f32 v125, v106, v107
    v_cvt_pk_bf16_f32 v128, v112, v113
    v_mfma_f32_16x16x32_bf16 v[104:107], a[16:19], v[160:163], 0
    v_exp_f32 v103, v103
    v_cvt_pk_bf16_f32 v129, v114, v115
    v_mfma_f32_16x16x32_bf16 v[112:115], a[16:19], v[176:179], 0
    ds_read_b128 a[16:19], v200 offset:12288
    v_cvt_pk_bf16_f32 v122, v100, v101
    v_mfma_f32_16x16x32_bf16 v[96:99], a[20:23], v[148:151], v[96:99]
    v_exp_f32 v109, v109
    v_mfma_f32_16x16x32_bf16 v[104:107], a[20:23], v[164:167], v[104:107]
    v_exp_f32 v116, v116
    v_mfma_f32_16x16x32_bf16 v[112:115], a[20:23], v[180:183], v[112:115]
    ds_read_b128 a[20:23], v201 offset:12288
    v_cvt_pk_bf16_f32 v123, v102, v103
    v_mfma_f32_16x16x32_bf16 v[96:99], a[24:27], v[152:155], v[96:99]
    v_exp_f32 v110, v110
    v_mfma_f32_16x16x32_bf16 v[104:107], a[24:27], v[168:171], v[104:107]
    v_exp_f32 v111, v111
    v_mfma_f32_16x16x32_bf16 v[112:115], a[24:27], v[184:187], v[112:115]
    v_exp_f32 v117, v117
    v_mfma_f32_16x16x32_bf16 v[96:99], a[28:31], v[156:159], v[96:99]
    v_exp_f32 v118, v118
    v_mfma_f32_16x16x32_bf16 v[104:107], a[28:31], v[172:175], v[104:107]
    s_waitcnt lgkmcnt(1)
    v_exp_f32 v119, v119
    v_mfma_f32_16x16x32_bf16 v[112:115], a[28:31], v[188:191], v[112:115]
    ds_read_b128 a[24:27], v202 offset:12288
    v_cvt_pk_bf16_f32 v126, v108, v109
    v_mfma_f32_16x16x32_bf16 v[100:103], a[16:19], v[144:147], 0
    ds_read_b128 a[28:31], v203 offset:12288
    v_cvt_pk_bf16_f32 v127, v110, v111
    v_cvt_pk_bf16_f32 v130, v116, v117
    v_mfma_f32_16x16x32_bf16 v[108:111], a[16:19], v[160:163], 0
    ds_read_b64_tr_b16 a[32:33], v192 offset:8192
    v_cvt_pk_bf16_f32 v131, v118, v119
    v_mfma_f32_16x16x32_bf16 v[116:119], a[16:19], v[176:179], 0
    ds_read_b64_tr_b16 a[36:37], v193 offset:8192
    s_waitcnt lgkmcnt(4)
    v_mfma_f32_16x16x32_bf16 v[100:103], a[20:23], v[148:151], v[100:103]
    ds_read_b64_tr_b16 a[40:41], v194 offset:8192
    v_mfma_f32_16x16x32_bf16 v[108:111], a[20:23], v[164:167], v[108:111]
    ds_read_b64_tr_b16 a[44:45], v195 offset:8192
    s_waitcnt lgkmcnt(5)
    v_mfma_f32_16x16x32_bf16 v[116:119], a[20:23], v[180:183], v[116:119]
    ds_read_b64_tr_b16 a[34:35], v192 offset:12288
    v_mfma_f32_16x16x32_bf16 v[100:103], a[24:27], v[152:155], v[100:103]
    ds_read_b64_tr_b16 a[38:39], v193 offset:12288
    v_mfma_f32_16x16x32_bf16 v[108:111], a[24:27], v[168:171], v[108:111]
    ds_read_b64_tr_b16 a[42:43], v194 offset:12288
    s_waitcnt lgkmcnt(7)
    v_mfma_f32_16x16x32_bf16 v[116:119], a[24:27], v[184:187], v[116:119]
    ds_read_b64_tr_b16 a[46:47], v195 offset:12288
    v_mfma_f32_16x16x32_bf16 v[100:103], a[28:31], v[156:159], v[100:103]
    v_exp_f32 v96, v96
    v_mfma_f32_16x16x32_bf16 v[108:111], a[28:31], v[172:175], v[108:111]
    v_exp_f32 v97, v97
    v_mfma_f32_16x16x32_bf16 v[116:119], a[28:31], v[188:191], v[116:119]
    v_exp_f32 v104, v104
    s_waitcnt vmcnt(0)
    s_barrier
    v_mfma_f32_16x16x32_bf16 a[0:3], a[12:15], v[120:123], a[0:3]
    ds_read_b128 a[16:19], v200 offset:16384
    v_cvt_pk_bf16_f32 v132, v96, v97
    v_mfma_f32_16x16x32_bf16 a[4:7], a[12:15], v[124:127], a[4:7]
    ds_read_b128 a[20:23], v201 offset:16384
    s_waitcnt lgkmcnt(2)
    v_mfma_f32_16x16x32_bf16 a[8:11], a[12:15], v[128:131], a[8:11]
    ds_read_b128 a[24:27], v202 offset:16384
    s_add_u32 m0, s64, 49152
    v_mfma_f32_16x16x32_bf16 v[0:3], a[32:35], v[120:123], v[0:3]
    ds_read_b128 a[28:31], v203 offset:16384
    s_mov_b32 s67, 114688
    v_mfma_f32_16x16x32_bf16 v[32:35], a[32:35], v[124:127], v[32:35]
    buffer_load_dwordx4 v205, s[48:51], s67 offen nt lds
    v_mfma_f32_16x16x32_bf16 v[64:67], a[32:35], v[128:131], v[64:67]
    ds_read_b64_tr_b16 a[32:33], v196 offset:8192
    v_mfma_f32_16x16x32_bf16 v[4:7], a[36:39], v[120:123], v[4:7]
    ds_read_b64_tr_b16 a[34:35], v196 offset:12288
    v_mfma_f32_16x16x32_bf16 v[36:39], a[36:39], v[124:127], v[36:39]
    buffer_load_dwordx4 v206, s[48:51], s67 offen offset:1024 nt lds
    v_mfma_f32_16x16x32_bf16 v[68:71], a[36:39], v[128:131], v[68:71]
    ds_read_b64_tr_b16 a[36:37], v197 offset:8192
    v_mfma_f32_16x16x32_bf16 v[8:11], a[40:43], v[120:123], v[8:11]
    ds_read_b64_tr_b16 a[38:39], v197 offset:12288
    v_mfma_f32_16x16x32_bf16 v[40:43], a[40:43], v[124:127], v[40:43]
    v_exp_f32 v98, v98
    v_mfma_f32_16x16x32_bf16 v[72:75], a[40:43], v[128:131], v[72:75]
    ds_read_b64_tr_b16 a[40:41], v198 offset:8192
    v_mfma_f32_16x16x32_bf16 v[12:15], a[44:47], v[120:123], v[12:15]
    ds_read_b64_tr_b16 a[42:43], v198 offset:12288
    v_mfma_f32_16x16x32_bf16 v[44:47], a[44:47], v[124:127], v[44:47]
    s_waitcnt lgkmcnt(4)
    v_exp_f32 v99, v99
    v_mfma_f32_16x16x32_bf16 v[76:79], a[44:47], v[128:131], v[76:79]
    ds_read_b64_tr_b16 a[44:45], v199 offset:8192
    v_min_u32 v204, 35, v207
    v_mfma_f32_16x16x32_bf16 v[16:19], a[32:35], v[120:123], v[16:19]
    ds_read_b64_tr_b16 a[46:47], v199 offset:12288
    v_lshl_add_u32 v204, v204, 7, s23
    v_mfma_f32_16x16x32_bf16 v[48:51], a[32:35], v[124:127], v[48:51]
    s_waitcnt lgkmcnt(4)
    v_exp_f32 v105, v105
    v_mfma_f32_16x16x32_bf16 v[80:83], a[32:35], v[128:131], v[80:83]
    v_exp_f32 v112, v112
    v_mfma_f32_16x16x32_bf16 v[20:23], a[36:39], v[120:123], v[20:23]
    v_exp_f32 v106, v106
    v_mfma_f32_16x16x32_bf16 v[52:55], a[36:39], v[124:127], v[52:55]
    s_waitcnt lgkmcnt(2)
    v_exp_f32 v107, v107
    v_mfma_f32_16x16x32_bf16 v[84:87], a[36:39], v[128:131], v[84:87]
    v_exp_f32 v113, v113
    v_mfma_f32_16x16x32_bf16 v[24:27], a[40:43], v[120:123], v[24:27]
    v_exp_f32 v114, v114
    v_mfma_f32_16x16x32_bf16 v[56:59], a[40:43], v[124:127], v[56:59]
    s_waitcnt lgkmcnt(0)
    v_exp_f32 v115, v115
    v_mfma_f32_16x16x32_bf16 v[88:91], a[40:43], v[128:131], v[88:91]
    buffer_load_dword v204, v204, s[56:59], 0 offen
    v_mfma_f32_16x16x32_bf16 v[28:31], a[44:47], v[120:123], v[28:31]
    v_exp_f32 v100, v100
    v_mfma_f32_16x16x32_bf16 v[60:63], a[44:47], v[124:127], v[60:63]
    v_exp_f32 v101, v101
    v_mfma_f32_16x16x32_bf16 v[92:95], a[44:47], v[128:131], v[92:95]
    v_exp_f32 v108, v108
    v_cvt_pk_bf16_f32 v133, v98, v99
    v_cvt_pk_bf16_f32 v136, v104, v105
    v_mfma_f32_16x16x32_bf16 v[96:99], a[16:19], v[144:147], 0
    v_exp_f32 v102, v102
    v_cvt_pk_bf16_f32 v137, v106, v107
    v_cvt_pk_bf16_f32 v140, v112, v113
    v_mfma_f32_16x16x32_bf16 v[104:107], a[16:19], v[160:163], 0
    v_exp_f32 v103, v103
    v_cvt_pk_bf16_f32 v141, v114, v115
    v_mfma_f32_16x16x32_bf16 v[112:115], a[16:19], v[176:179], 0
    ds_read_b128 a[16:19], v200 offset:20480
    v_cvt_pk_bf16_f32 v134, v100, v101
    v_mfma_f32_16x16x32_bf16 v[96:99], a[20:23], v[148:151], v[96:99]
    v_exp_f32 v109, v109
    v_mfma_f32_16x16x32_bf16 v[104:107], a[20:23], v[164:167], v[104:107]
    v_exp_f32 v116, v116
    v_mfma_f32_16x16x32_bf16 v[112:115], a[20:23], v[180:183], v[112:115]
    ds_read_b128 a[20:23], v201 offset:20480
    v_cvt_pk_bf16_f32 v135, v102, v103
    v_mfma_f32_16x16x32_bf16 v[96:99], a[24:27], v[152:155], v[96:99]
    v_exp_f32 v110, v110
    v_mfma_f32_16x16x32_bf16 v[104:107], a[24:27], v[168:171], v[104:107]
    v_exp_f32 v111, v111
    v_mfma_f32_16x16x32_bf16 v[112:115], a[24:27], v[184:187], v[112:115]
    v_exp_f32 v117, v117
    v_mfma_f32_16x16x32_bf16 v[96:99], a[28:31], v[156:159], v[96:99]
    v_exp_f32 v118, v118
    v_mfma_f32_16x16x32_bf16 v[104:107], a[28:31], v[172:175], v[104:107]
    s_waitcnt lgkmcnt(1)
    v_exp_f32 v119, v119
    v_mfma_f32_16x16x32_bf16 v[112:115], a[28:31], v[188:191], v[112:115]
    ds_read_b128 a[24:27], v202 offset:20480
    v_cvt_pk_bf16_f32 v138, v108, v109
    v_mfma_f32_16x16x32_bf16 v[100:103], a[16:19], v[144:147], 0
    ds_read_b128 a[28:31], v203 offset:20480
    v_cvt_pk_bf16_f32 v139, v110, v111
    v_cvt_pk_bf16_f32 v142, v116, v117
    v_mfma_f32_16x16x32_bf16 v[108:111], a[16:19], v[160:163], 0
    ds_read_b64_tr_b16 a[32:33], v192 offset:40960
    v_cvt_pk_bf16_f32 v143, v118, v119
    v_mfma_f32_16x16x32_bf16 v[116:119], a[16:19], v[176:179], 0
    ds_read_b64_tr_b16 a[36:37], v193 offset:40960
    s_waitcnt lgkmcnt(4)
    v_mfma_f32_16x16x32_bf16 v[100:103], a[20:23], v[148:151], v[100:103]
    ds_read_b64_tr_b16 a[40:41], v194 offset:40960
    v_mfma_f32_16x16x32_bf16 v[108:111], a[20:23], v[164:167], v[108:111]
    ds_read_b64_tr_b16 a[44:45], v195 offset:40960
    s_waitcnt lgkmcnt(5)
    v_mfma_f32_16x16x32_bf16 v[116:119], a[20:23], v[180:183], v[116:119]
    ds_read_b64_tr_b16 a[34:35], v192 offset:45056
    v_mfma_f32_16x16x32_bf16 v[100:103], a[24:27], v[152:155], v[100:103]
    ds_read_b64_tr_b16 a[38:39], v193 offset:45056
    v_mfma_f32_16x16x32_bf16 v[108:111], a[24:27], v[168:171], v[108:111]
    ds_read_b64_tr_b16 a[42:43], v194 offset:45056
    s_waitcnt lgkmcnt(7)
    v_mfma_f32_16x16x32_bf16 v[116:119], a[24:27], v[184:187], v[116:119]
    ds_read_b64_tr_b16 a[46:47], v195 offset:45056
    v_mfma_f32_16x16x32_bf16 v[100:103], a[28:31], v[156:159], v[100:103]
    v_exp_f32 v96, v96
    v_mfma_f32_16x16x32_bf16 v[108:111], a[28:31], v[172:175], v[108:111]
    v_exp_f32 v97, v97
    v_mfma_f32_16x16x32_bf16 v[116:119], a[28:31], v[188:191], v[116:119]
    v_exp_f32 v104, v104
    s_waitcnt vmcnt(1)
    s_barrier
    v_mfma_f32_16x16x32_bf16 a[0:3], a[12:15], v[132:135], a[0:3]
    ds_read_b128 a[16:19], v200 offset:49152
    v_cvt_pk_bf16_f32 v120, v96, v97
    v_mfma_f32_16x16x32_bf16 a[4:7], a[12:15], v[136:139], a[4:7]
    ds_read_b128 a[20:23], v201 offset:49152
    s_waitcnt lgkmcnt(2)
    v_mfma_f32_16x16x32_bf16 a[8:11], a[12:15], v[140:143], a[8:11]
    ds_read_b128 a[24:27], v202 offset:49152
    s_add_u32 m0, s64, 57344
    v_mfma_f32_16x16x32_bf16 v[0:3], a[32:35], v[132:135], v[0:3]
    ds_read_b128 a[28:31], v203 offset:49152
    s_mov_b32 s67, 122880
    v_mfma_f32_16x16x32_bf16 v[32:35], a[32:35], v[136:139], v[32:35]
    buffer_load_dwordx4 v205, s[48:51], s67 offen nt lds
    v_mfma_f32_16x16x32_bf16 v[64:67], a[32:35], v[140:143], v[64:67]
    ds_read_b64_tr_b16 a[32:33], v196 offset:40960
    v_mfma_f32_16x16x32_bf16 v[4:7], a[36:39], v[132:135], v[4:7]
    ds_read_b64_tr_b16 a[34:35], v196 offset:45056
    v_mfma_f32_16x16x32_bf16 v[36:39], a[36:39], v[136:139], v[36:39]
    buffer_load_dwordx4 v206, s[48:51], s67 offen offset:1024 nt lds
    v_mfma_f32_16x16x32_bf16 v[68:71], a[36:39], v[140:143], v[68:71]
    ds_read_b64_tr_b16 a[36:37], v197 offset:40960
    v_mfma_f32_16x16x32_bf16 v[8:11], a[40:43], v[132:135], v[8:11]
    ds_read_b64_tr_b16 a[38:39], v197 offset:45056
    v_mfma_f32_16x16x32_bf16 v[40:43], a[40:43], v[136:139], v[40:43]
    v_exp_f32 v98, v98
    v_mfma_f32_16x16x32_bf16 v[72:75], a[40:43], v[140:143], v[72:75]
    ds_read_b64_tr_b16 a[40:41], v198 offset:40960
    v_mfma_f32_16x16x32_bf16 v[12:15], a[44:47], v[132:135], v[12:15]
    ds_read_b64_tr_b16 a[42:43], v198 offset:45056
    v_mfma_f32_16x16x32_bf16 v[44:47], a[44:47], v[136:139], v[44:47]
    s_waitcnt lgkmcnt(4)
    v_exp_f32 v99, v99
    v_mfma_f32_16x16x32_bf16 v[76:79], a[44:47], v[140:143], v[76:79]
    ds_read_b64_tr_b16 a[44:45], v199 offset:40960
    v_cvt_pk_bf16_f32 v121, v98, v99
    v_mfma_f32_16x16x32_bf16 v[16:19], a[32:35], v[132:135], v[16:19]
    ds_read_b64_tr_b16 a[46:47], v199 offset:45056
    v_mfma_f32_16x16x32_bf16 v[48:51], a[32:35], v[136:139], v[48:51]
    s_waitcnt lgkmcnt(4)
    v_exp_f32 v105, v105
    v_mfma_f32_16x16x32_bf16 v[80:83], a[32:35], v[140:143], v[80:83]
    v_exp_f32 v112, v112
    v_mfma_f32_16x16x32_bf16 v[20:23], a[36:39], v[132:135], v[20:23]
    v_exp_f32 v106, v106
    v_mfma_f32_16x16x32_bf16 v[52:55], a[36:39], v[136:139], v[52:55]
    s_waitcnt lgkmcnt(2)
    v_exp_f32 v107, v107
    v_mfma_f32_16x16x32_bf16 v[84:87], a[36:39], v[140:143], v[84:87]
    v_exp_f32 v113, v113
    v_mfma_f32_16x16x32_bf16 v[24:27], a[40:43], v[132:135], v[24:27]
    v_exp_f32 v114, v114
    v_mfma_f32_16x16x32_bf16 v[56:59], a[40:43], v[136:139], v[56:59]
    s_waitcnt lgkmcnt(0)
    v_exp_f32 v115, v115
    v_mfma_f32_16x16x32_bf16 v[88:91], a[40:43], v[140:143], v[88:91]
    v_exp_f32 v100, v100
    v_mfma_f32_16x16x32_bf16 v[28:31], a[44:47], v[132:135], v[28:31]
    v_exp_f32 v101, v101
    v_mfma_f32_16x16x32_bf16 v[60:63], a[44:47], v[136:139], v[60:63]
    v_exp_f32 v108, v108
    v_mfma_f32_16x16x32_bf16 v[92:95], a[44:47], v[140:143], v[92:95]
    v_exp_f32 v102, v102
    v_cvt_pk_bf16_f32 v124, v104, v105
    v_mfma_f32_16x16x32_bf16 v[96:99], a[16:19], v[144:147], 0
    v_exp_f32 v103, v103
    v_cvt_pk_bf16_f32 v125, v106, v107
    v_cvt_pk_bf16_f32 v128, v112, v113
    v_mfma_f32_16x16x32_bf16 v[104:107], a[16:19], v[160:163], 0
    v_exp_f32 v109, v109
    v_cvt_pk_bf16_f32 v129, v114, v115
    v_mfma_f32_16x16x32_bf16 v[112:115], a[16:19], v[176:179], 0
    ds_read_b128 a[16:19], v200 offset:53248
    v_cvt_pk_bf16_f32 v122, v100, v101
    v_mfma_f32_16x16x32_bf16 v[96:99], a[20:23], v[148:151], v[96:99]
    v_exp_f32 v116, v116
    v_mfma_f32_16x16x32_bf16 v[104:107], a[20:23], v[164:167], v[104:107]
    v_exp_f32 v110, v110
    v_mfma_f32_16x16x32_bf16 v[112:115], a[20:23], v[180:183], v[112:115]
    ds_read_b128 a[20:23], v201 offset:53248
    v_cvt_pk_bf16_f32 v123, v102, v103
    v_mfma_f32_16x16x32_bf16 v[96:99], a[24:27], v[152:155], v[96:99]
    v_exp_f32 v111, v111
    v_mfma_f32_16x16x32_bf16 v[104:107], a[24:27], v[168:171], v[104:107]
    v_exp_f32 v117, v117
    v_mfma_f32_16x16x32_bf16 v[112:115], a[24:27], v[184:187], v[112:115]
    v_exp_f32 v118, v118
    v_mfma_f32_16x16x32_bf16 v[96:99], a[28:31], v[156:159], v[96:99]
    v_exp_f32 v119, v119
    v_mfma_f32_16x16x32_bf16 v[104:107], a[28:31], v[172:175], v[104:107]
    ds_read_b128 a[24:27], v202 offset:53248
    s_waitcnt lgkmcnt(2)
    v_mfma_f32_16x16x32_bf16 v[112:115], a[28:31], v[188:191], v[112:115]
    ds_read_b128 a[28:31], v203 offset:53248
    v_cvt_pk_bf16_f32 v126, v108, v109
    v_mfma_f32_16x16x32_bf16 v[100:103], a[16:19], v[144:147], 0
    ds_read_b64_tr_b16 a[32:33], v192 offset:49152
    v_cvt_pk_bf16_f32 v127, v110, v111
    v_cvt_pk_bf16_f32 v130, v116, v117
    v_mfma_f32_16x16x32_bf16 v[108:111], a[16:19], v[160:163], 0
    ds_read_b64_tr_b16 a[36:37], v193 offset:49152
    v_cvt_pk_bf16_f32 v131, v118, v119
    v_mfma_f32_16x16x32_bf16 v[116:119], a[16:19], v[176:179], 0
    ds_read_b64_tr_b16 a[40:41], v194 offset:49152
    s_waitcnt lgkmcnt(5)
    v_mfma_f32_16x16x32_bf16 v[100:103], a[20:23], v[148:151], v[100:103]
    ds_read_b64_tr_b16 a[44:45], v195 offset:49152
    v_mfma_f32_16x16x32_bf16 v[108:111], a[20:23], v[164:167], v[108:111]
    ds_read_b64_tr_b16 a[34:35], v192 offset:53248
    s_waitcnt lgkmcnt(6)
    v_mfma_f32_16x16x32_bf16 v[116:119], a[20:23], v[180:183], v[116:119]
    ds_read_b64_tr_b16 a[38:39], v193 offset:53248
    v_mfma_f32_16x16x32_bf16 v[100:103], a[24:27], v[152:155], v[100:103]
    ds_read_b64_tr_b16 a[42:43], v194 offset:53248
    v_mfma_f32_16x16x32_bf16 v[108:111], a[24:27], v[168:171], v[108:111]
    ds_read_b64_tr_b16 a[46:47], v195 offset:53248
    s_waitcnt lgkmcnt(8)
    v_mfma_f32_16x16x32_bf16 v[116:119], a[24:27], v[184:187], v[116:119]
    v_exp_f32 v96, v96
    v_mfma_f32_16x16x32_bf16 v[100:103], a[28:31], v[156:159], v[100:103]
    v_exp_f32 v97, v97
    v_mfma_f32_16x16x32_bf16 v[108:111], a[28:31], v[172:175], v[108:111]
    v_exp_f32 v104, v104
    v_mfma_f32_16x16x32_bf16 v[116:119], a[28:31], v[188:191], v[116:119]
    v_exp_f32 v98, v98
    s_waitcnt vmcnt(0)
    s_barrier
    v_mfma_f32_16x16x32_bf16 a[0:3], a[12:15], v[120:123], a[0:3]
    v_exp_f32 v99, v99
    v_mfma_f32_16x16x32_bf16 a[4:7], a[12:15], v[124:127], a[4:7]
    s_waitcnt lgkmcnt(0)
    v_exp_f32 v100, v100
    v_mfma_f32_16x16x32_bf16 a[8:11], a[12:15], v[128:131], a[8:11]
    v_exp_f32 v101, v101
    v_mfma_f32_16x16x32_bf16 v[0:3], a[32:35], v[120:123], v[0:3]
    v_exp_f32 v108, v108
    v_mfma_f32_16x16x32_bf16 v[32:35], a[32:35], v[124:127], v[32:35]
    v_exp_f32 v105, v105
    v_mfma_f32_16x16x32_bf16 v[64:67], a[32:35], v[128:131], v[64:67]
    ds_read_b64_tr_b16 a[32:33], v196 offset:49152
    v_cvt_pk_bf16_f32 v132, v96, v97
    v_mfma_f32_16x16x32_bf16 v[4:7], a[36:39], v[120:123], v[4:7]
    ds_read_b64_tr_b16 a[34:35], v196 offset:53248
    v_cvt_pk_bf16_f32 v134, v100, v101
    v_mfma_f32_16x16x32_bf16 v[36:39], a[36:39], v[124:127], v[36:39]
    v_exp_f32 v112, v112
    v_mfma_f32_16x16x32_bf16 v[68:71], a[36:39], v[128:131], v[68:71]
    ds_read_b64_tr_b16 a[36:37], v197 offset:49152
    v_cvt_pk_bf16_f32 v133, v98, v99
    v_mfma_f32_16x16x32_bf16 v[8:11], a[40:43], v[120:123], v[8:11]
    ds_read_b64_tr_b16 a[38:39], v197 offset:53248
    v_cvt_pk_bf16_f32 v136, v104, v105
    v_mfma_f32_16x16x32_bf16 v[40:43], a[40:43], v[124:127], v[40:43]
    v_exp_f32 v102, v102
    v_mfma_f32_16x16x32_bf16 v[72:75], a[40:43], v[128:131], v[72:75]
    ds_read_b64_tr_b16 a[40:41], v198 offset:49152
    v_mfma_f32_16x16x32_bf16 v[12:15], a[44:47], v[120:123], v[12:15]
    ds_read_b64_tr_b16 a[42:43], v198 offset:53248
    v_mfma_f32_16x16x32_bf16 v[44:47], a[44:47], v[124:127], v[44:47]
    s_waitcnt lgkmcnt(4)
    v_exp_f32 v103, v103
    v_mfma_f32_16x16x32_bf16 v[76:79], a[44:47], v[128:131], v[76:79]
    ds_read_b64_tr_b16 a[44:45], v199 offset:49152
    v_cvt_pk_bf16_f32 v135, v102, v103
    v_mfma_f32_16x16x32_bf16 v[16:19], a[32:35], v[120:123], v[16:19]
    ds_read_b64_tr_b16 a[46:47], v199 offset:53248
    v_mfma_f32_16x16x32_bf16 v[48:51], a[32:35], v[124:127], v[48:51]
    s_waitcnt lgkmcnt(4)
    v_exp_f32 v109, v109
    v_mfma_f32_16x16x32_bf16 v[80:83], a[32:35], v[128:131], v[80:83]
    v_exp_f32 v116, v116
    v_mfma_f32_16x16x32_bf16 v[20:23], a[36:39], v[120:123], v[20:23]
    ds_read_b64_tr_b16 a[32:33], v192 offset:57344
    v_cvt_pk_bf16_f32 v138, v108, v109
    v_mfma_f32_16x16x32_bf16 v[52:55], a[36:39], v[124:127], v[52:55]
    s_waitcnt lgkmcnt(3)
    v_exp_f32 v106, v106
    v_mfma_f32_16x16x32_bf16 v[84:87], a[36:39], v[128:131], v[84:87]
    ds_read_b64_tr_b16 a[36:37], v193 offset:57344
    v_mfma_f32_16x16x32_bf16 v[24:27], a[40:43], v[120:123], v[24:27]
    v_exp_f32 v107, v107
    v_mfma_f32_16x16x32_bf16 v[56:59], a[40:43], v[124:127], v[56:59]
    s_waitcnt lgkmcnt(2)
    v_exp_f32 v113, v113
    v_mfma_f32_16x16x32_bf16 v[88:91], a[40:43], v[128:131], v[88:91]
    ds_read_b64_tr_b16 a[40:41], v194 offset:57344
    v_cvt_pk_bf16_f32 v137, v106, v107
    v_mfma_f32_16x16x32_bf16 v[28:31], a[44:47], v[120:123], v[28:31]
    v_exp_f32 v110, v110
    v_exp_f32 v111, v111
    v_exp_f32 v117, v117
    v_mfma_f32_16x16x32_bf16 v[60:63], a[44:47], v[124:127], v[60:63]
    ds_read_b64_tr_b16 a[34:35], v192 offset:61440
    v_cvt_pk_bf16_f32 v140, v112, v113
    ds_read_b64_tr_b16 a[38:39], v193 offset:61440
    ds_read_b64_tr_b16 a[42:43], v194 offset:61440
    v_exp_f32 v114, v114
    v_exp_f32 v115, v115
    v_exp_f32 v118, v118
    v_exp_f32 v119, v119
    v_mfma_f32_16x16x32_bf16 v[92:95], a[44:47], v[128:131], v[92:95]
    ds_read_b64_tr_b16 a[44:45], v195 offset:57344
    v_cvt_pk_bf16_f32 v139, v110, v111
    v_cvt_pk_bf16_f32 v142, v116, v117
    v_mfma_f32_16x16x32_bf16 a[0:3], a[12:15], v[132:135], a[0:3]
    ds_read_b64_tr_b16 a[46:47], v195 offset:61440
    v_cvt_pk_bf16_f32 v141, v114, v115
    v_cvt_pk_bf16_f32 v143, v118, v119
    v_mfma_f32_16x16x32_bf16 a[4:7], a[12:15], v[136:139], a[4:7]
    s_waitcnt lgkmcnt(0)
    v_mfma_f32_16x16x32_bf16 a[8:11], a[12:15], v[140:143], a[8:11]
    v_mfma_f32_16x16x32_bf16 v[0:3], a[32:35], v[132:135], v[0:3]
    v_mfma_f32_16x16x32_bf16 v[32:35], a[32:35], v[136:139], v[32:35]
    v_mfma_f32_16x16x32_bf16 v[64:67], a[32:35], v[140:143], v[64:67]
    ds_read_b64_tr_b16 a[32:33], v196 offset:57344
    v_mfma_f32_16x16x32_bf16 v[4:7], a[36:39], v[132:135], v[4:7]
    ds_read_b64_tr_b16 a[34:35], v196 offset:61440
    v_mfma_f32_16x16x32_bf16 v[36:39], a[36:39], v[136:139], v[36:39]
    v_mfma_f32_16x16x32_bf16 v[68:71], a[36:39], v[140:143], v[68:71]
    ds_read_b64_tr_b16 a[36:37], v197 offset:57344
    v_mfma_f32_16x16x32_bf16 v[8:11], a[40:43], v[132:135], v[8:11]
    ds_read_b64_tr_b16 a[38:39], v197 offset:61440
    v_mfma_f32_16x16x32_bf16 v[40:43], a[40:43], v[136:139], v[40:43]
    v_mfma_f32_16x16x32_bf16 v[72:75], a[40:43], v[140:143], v[72:75]
    ds_read_b64_tr_b16 a[40:41], v198 offset:57344
    v_mfma_f32_16x16x32_bf16 v[12:15], a[44:47], v[132:135], v[12:15]
    ds_read_b64_tr_b16 a[42:43], v198 offset:61440
    v_mfma_f32_16x16x32_bf16 v[44:47], a[44:47], v[136:139], v[44:47]
    s_waitcnt lgkmcnt(4)
    v_mfma_f32_16x16x32_bf16 v[76:79], a[44:47], v[140:143], v[76:79]
    ds_read_b64_tr_b16 a[44:45], v199 offset:57344
    v_mfma_f32_16x16x32_bf16 v[16:19], a[32:35], v[132:135], v[16:19]
    ds_read_b64_tr_b16 a[46:47], v199 offset:61440
    v_mfma_f32_16x16x32_bf16 v[48:51], a[32:35], v[136:139], v[48:51]
    s_waitcnt lgkmcnt(4)
    v_mfma_f32_16x16x32_bf16 v[80:83], a[32:35], v[140:143], v[80:83]
    v_mfma_f32_16x16x32_bf16 v[20:23], a[36:39], v[132:135], v[20:23]
    v_mfma_f32_16x16x32_bf16 v[52:55], a[36:39], v[136:139], v[52:55]
    s_waitcnt lgkmcnt(2)
    v_mfma_f32_16x16x32_bf16 v[84:87], a[36:39], v[140:143], v[84:87]
    v_mfma_f32_16x16x32_bf16 v[24:27], a[40:43], v[132:135], v[24:27]
    v_mfma_f32_16x16x32_bf16 v[56:59], a[40:43], v[136:139], v[56:59]
    s_waitcnt lgkmcnt(0)
    v_mfma_f32_16x16x32_bf16 v[88:91], a[40:43], v[140:143], v[88:91]
    v_mfma_f32_16x16x32_bf16 v[28:31], a[44:47], v[132:135], v[28:31]
    v_mfma_f32_16x16x32_bf16 v[60:63], a[44:47], v[136:139], v[60:63]
    v_mfma_f32_16x16x32_bf16 v[92:95], a[44:47], v[140:143], v[92:95]
    v_lshlrev_b32 v99, 4, v207
    v_accvgpr_read_b32 v96, a0
    v_accvgpr_read_b32 v97, a4
    v_accvgpr_read_b32 v98, a8
    s_mov_b32 s71, 0x2b800000
    s_mov_b32 s72, 0x53800000
    s_mov_b64 s[32:33], -1
    v_cmp_lt_f32 vcc, s71, v96
    s_nop 3
    s_and_b64 s[32:33], s[32:33], vcc
    v_cmp_gt_f32 vcc, s72, v96
    s_nop 3
    s_and_b64 s[32:33], s[32:33], vcc
    v_cmp_lt_f32 vcc, s71, v97
    s_nop 3
    s_and_b64 s[32:33], s[32:33], vcc
    v_cmp_gt_f32 vcc, s72, v97
    s_nop 3
    s_and_b64 s[32:33], s[32:33], vcc
    v_cmp_lt_f32 vcc, s71, v98
    s_nop 3
    s_and_b64 s[32:33], s[32:33], vcc
    v_cmp_gt_f32 vcc, s72, v98
    s_nop 3
    s_and_b64 s[32:33], s[32:33], vcc
    s_cmp_eq_u64 s[32:33], exec
    s_cselect_b32 s69, 0, 1
    v_rcp_f32 v96, v96
    v_rcp_f32 v97, v97
    v_rcp_f32 v98, v98
    v_mul_f32 v0, v96, v0
    v_mul_f32 v1, v96, v1
    v_mul_f32 v2, v96, v2
    v_mul_f32 v3, v96, v3
    v_mul_f32 v4, v96, v4
    v_mul_f32 v5, v96, v5
    v_mul_f32 v6, v96, v6
    v_mul_f32 v7, v96, v7
    v_cvt_pk_bf16_f32 v100, v0, v1
    v_cvt_pk_bf16_f32 v101, v2, v3
    v_cvt_pk_bf16_f32 v102, v4, v5
    v_cvt_pk_bf16_f32 v103, v6, v7
    s_mov_b32 s66, 0
    buffer_store_dwordx4 v[100:103], v99, s[52:55], s66 offen sc1
    v_mul_f32 v8, v96, v8
    v_mul_f32 v9, v96, v9
    v_mul_f32 v10, v96, v10
    v_mul_f32 v11, v96, v11
    v_mul_f32 v12, v96, v12
    v_mul_f32 v13, v96, v13
    v_mul_f32 v14, v96, v14
    v_mul_f32 v15, v96, v15
    v_cvt_pk_bf16_f32 v104, v8, v9
    v_cvt_pk_bf16_f32 v105, v10, v11
    v_cvt_pk_bf16_f32 v106, v12, v13
    v_cvt_pk_bf16_f32 v107, v14, v15
    s_mov_b32 s66, 98304
    buffer_store_dwordx4 v[104:107], v99, s[52:55], s66 offen sc1
    v_mul_f32 v16, v96, v16
    v_mul_f32 v17, v96, v17
    v_mul_f32 v18, v96, v18
    v_mul_f32 v19, v96, v19
    v_mul_f32 v20, v96, v20
    v_mul_f32 v21, v96, v21
    v_mul_f32 v22, v96, v22
    v_mul_f32 v23, v96, v23
    v_cvt_pk_bf16_f32 v108, v16, v17
    v_cvt_pk_bf16_f32 v109, v18, v19
    v_cvt_pk_bf16_f32 v110, v20, v21
    v_cvt_pk_bf16_f32 v111, v22, v23
    s_mov_b32 s66, 196608
    buffer_store_dwordx4 v[108:111], v99, s[52:55], s66 offen sc1
    v_mul_f32 v24, v96, v24
    v_mul_f32 v25, v96, v25
    v_mul_f32 v26, v96, v26
    v_mul_f32 v27, v96, v27
    v_mul_f32 v28, v96, v28
    v_mul_f32 v29, v96, v29
    v_mul_f32 v30, v96, v30
    v_mul_f32 v31, v96, v31
    v_cvt_pk_bf16_f32 v112, v24, v25
    v_cvt_pk_bf16_f32 v113, v26, v27
    v_cvt_pk_bf16_f32 v114, v28, v29
    v_cvt_pk_bf16_f32 v115, v30, v31
    s_mov_b32 s66, 294912
    buffer_store_dwordx4 v[112:115], v99, s[52:55], s66 offen sc1
    v_mul_f32 v32, v97, v32
    v_mul_f32 v33, v97, v33
    v_mul_f32 v34, v97, v34
    v_mul_f32 v35, v97, v35
    v_mul_f32 v36, v97, v36
    v_mul_f32 v37, v97, v37
    v_mul_f32 v38, v97, v38
    v_mul_f32 v39, v97, v39
    v_cvt_pk_bf16_f32 v116, v32, v33
    v_cvt_pk_bf16_f32 v117, v34, v35
    v_cvt_pk_bf16_f32 v118, v36, v37
    v_cvt_pk_bf16_f32 v119, v38, v39
    s_mov_b32 s66, 0
    buffer_store_dwordx4 v[116:119], v99, s[52:55], s66 offen offset:1024 sc1
    v_mul_f32 v40, v97, v40
    v_mul_f32 v41, v97, v41
    v_mul_f32 v42, v97, v42
    v_mul_f32 v43, v97, v43
    v_mul_f32 v44, v97, v44
    v_mul_f32 v45, v97, v45
    v_mul_f32 v46, v97, v46
    v_mul_f32 v47, v97, v47
    v_cvt_pk_bf16_f32 v120, v40, v41
    v_cvt_pk_bf16_f32 v121, v42, v43
    v_cvt_pk_bf16_f32 v122, v44, v45
    v_cvt_pk_bf16_f32 v123, v46, v47
    s_mov_b32 s66, 98304
    buffer_store_dwordx4 v[120:123], v99, s[52:55], s66 offen offset:1024 sc1
    v_mul_f32 v48, v97, v48
    v_mul_f32 v49, v97, v49
    v_mul_f32 v50, v97, v50
    v_mul_f32 v51, v97, v51
    v_mul_f32 v52, v97, v52
    v_mul_f32 v53, v97, v53
    v_mul_f32 v54, v97, v54
    v_mul_f32 v55, v97, v55
    v_cvt_pk_bf16_f32 v100, v48, v49
    v_cvt_pk_bf16_f32 v101, v50, v51
    v_cvt_pk_bf16_f32 v102, v52, v53
    v_cvt_pk_bf16_f32 v103, v54, v55
    s_mov_b32 s66, 196608
    buffer_store_dwordx4 v[100:103], v99, s[52:55], s66 offen offset:1024 sc1
    v_mul_f32 v56, v97, v56
    v_mul_f32 v57, v97, v57
    v_mul_f32 v58, v97, v58
    v_mul_f32 v59, v97, v59
    v_mul_f32 v60, v97, v60
    v_mul_f32 v61, v97, v61
    v_mul_f32 v62, v97, v62
    v_mul_f32 v63, v97, v63
    v_cvt_pk_bf16_f32 v104, v56, v57
    v_cvt_pk_bf16_f32 v105, v58, v59
    v_cvt_pk_bf16_f32 v106, v60, v61
    v_cvt_pk_bf16_f32 v107, v62, v63
    s_mov_b32 s66, 294912
    buffer_store_dwordx4 v[104:107], v99, s[52:55], s66 offen offset:1024 sc1
    v_mul_f32 v64, v98, v64
    v_mul_f32 v65, v98, v65
    v_mul_f32 v66, v98, v66
    v_mul_f32 v67, v98, v67
    v_mul_f32 v68, v98, v68
    v_mul_f32 v69, v98, v69
    v_mul_f32 v70, v98, v70
    v_mul_f32 v71, v98, v71
    v_cvt_pk_bf16_f32 v108, v64, v65
    v_cvt_pk_bf16_f32 v109, v66, v67
    v_cvt_pk_bf16_f32 v110, v68, v69
    v_cvt_pk_bf16_f32 v111, v70, v71
    s_mov_b32 s66, 0
    buffer_store_dwordx4 v[108:111], v99, s[52:55], s66 offen offset:2048 sc1
    v_mul_f32 v72, v98, v72
    v_mul_f32 v73, v98, v73
    v_mul_f32 v74, v98, v74
    v_mul_f32 v75, v98, v75
    v_mul_f32 v76, v98, v76
    v_mul_f32 v77, v98, v77
    v_mul_f32 v78, v98, v78
    v_mul_f32 v79, v98, v79
    v_cvt_pk_bf16_f32 v112, v72, v73
    v_cvt_pk_bf16_f32 v113, v74, v75
    v_cvt_pk_bf16_f32 v114, v76, v77
    v_cvt_pk_bf16_f32 v115, v78, v79
    s_mov_b32 s66, 98304
    buffer_store_dwordx4 v[112:115], v99, s[52:55], s66 offen offset:2048 sc1
    v_mul_f32 v80, v98, v80
    v_mul_f32 v81, v98, v81
    v_mul_f32 v82, v98, v82
    v_mul_f32 v83, v98, v83
    v_mul_f32 v84, v98, v84
    v_mul_f32 v85, v98, v85
    v_mul_f32 v86, v98, v86
    v_mul_f32 v87, v98, v87
    v_cvt_pk_bf16_f32 v116, v80, v81
    v_cvt_pk_bf16_f32 v117, v82, v83
    v_cvt_pk_bf16_f32 v118, v84, v85
    v_cvt_pk_bf16_f32 v119, v86, v87
    s_mov_b32 s66, 196608
    buffer_store_dwordx4 v[116:119], v99, s[52:55], s66 offen offset:2048 sc1
    v_mul_f32 v88, v98, v88
    v_mul_f32 v89, v98, v89
    v_mul_f32 v90, v98, v90
    v_mul_f32 v91, v98, v91
    v_mul_f32 v92, v98, v92
    v_mul_f32 v93, v98, v93
    v_mul_f32 v94, v98, v94
    v_mul_f32 v95, v98, v95
    v_cvt_pk_bf16_f32 v120, v88, v89
    v_cvt_pk_bf16_f32 v121, v90, v91
    v_cvt_pk_bf16_f32 v122, v92, v93
    v_cvt_pk_bf16_f32 v123, v94, v95
    s_mov_b32 s66, 294912
    buffer_store_dwordx4 v[120:123], v99, s[52:55], s66 offen offset:2048 sc1
    v_mov_b32 v96, s69
    v_mov_b32 v97, 65536
    s_lshl_b32 s7, s70, 2
    s_add_u32 s7, s7, s3
    s_lshl_b32 s7, s7, 2
    v_add_u32 v98, s7, v97
    ds_write_b32 v98, v96
    s_waitcnt lgkmcnt(0)
    s_barrier
    ds_read_b128 v[100:103], v97
    ds_read_b128 v[104:107], v97 offset:16
    s_waitcnt lgkmcnt(0)
    v_or_b32 v100, v100, v101
    v_or_b32 v100, v100, v102
    v_or_b32 v100, v100, v103
    v_or_b32 v100, v100, v104
    v_or_b32 v100, v100, v105
    v_or_b32 v100, v100, v106
    v_or_b32 v100, v100, v107
    s_nop 0
    v_readfirstlane_b32 s69, v100
    s_nop 3
    s_cmp_lg_u32 s69, 0
    s_cbranch_scc1 L_k1_slow
L_k1_done:
    s_endpgm
L_k1_slow:
    s_nop 7
    s_waitcnt vmcnt(0)
    s_waitcnt lgkmcnt(0)
    s_barrier
    v_mov_b32 v140, 0xff800000
    v_mov_b32 v141, 0xff800000
    v_mov_b32 v142, 0xff800000
    s_mov_b32 s73, 0
L_k1_p1:
    s_lshl_b32 s66, s73, 13
    s_add_u32 m0, s64, 16384
    s_nop 0
    buffer_load_dwordx4 v205, s[44:47], s66 offen nt lds
    buffer_load_dwordx4 v206, s[44:47], s66 offen offset:1024 nt lds
    s_waitcnt vmcnt(0)
    s_barrier
    ds_read_b128 a[16:19], v200
    s_waitcnt lgkmcnt(0)
    v_mfma_f32_16x16x32_bf16 v[96:99], a[16:19], v[144:147], 0
    v_mfma_f32_16x16x32_bf16 v[104:107], a[16:19], v[160:163], 0
    v_mfma_f32_16x16x32_bf16 v[112:115], a[16:19], v[176:179], 0
    s_nop 1
    ds_read_b128 a[16:19], v201
    s_waitcnt lgkmcnt(0)
    v_mfma_f32_16x16x32_bf16 v[96:99], a[16:19], v[148:151], v[96:99]
    v_mfma_f32_16x16x32_bf16 v[104:107], a[16:19], v[164:167], v[104:107]
    v_mfma_f32_16x16x32_bf16 v[112:115], a[16:19], v[180:183], v[112:115]
    s_nop 1
    ds_read_b128 a[16:19], v202
    s_waitcnt lgkmcnt(0)
    v_mfma_f32_16x16x32_bf16 v[96:99], a[16:19], v[152:155], v[96:99]
    v_mfma_f32_16x16x32_bf16 v[104:107], a[16:19], v[168:171], v[104:107]
    v_mfma_f32_16x16x32_bf16 v[112:115], a[16:19], v[184:187], v[112:115]
    s_nop 1
    ds_read_b128 a[16:19], v203
    s_waitcnt lgkmcnt(0)
    v_mfma_f32_16x16x32_bf16 v[96:99], a[16:19], v[156:159], v[96:99]
    v_mfma_f32_16x16x32_bf16 v[104:107], a[16:19], v[172:175], v[104:107]
    v_mfma_f32_16x16x32_bf16 v[112:115], a[16:19], v[188:191], v[112:115]
    s_nop 1
    ds_read_b128 a[16:19], v200 offset:4096
    s_waitcnt lgkmcnt(0)
    v_mfma_f32_16x16x32_bf16 v[100:103], a[16:19], v[144:147], 0
    v_mfma_f32_16x16x32_bf16 v[108:111], a[16:19], v[160:163], 0
    v_mfma_f32_16x16x32_bf16 v[116:119], a[16:19], v[176:179], 0
    s_nop 1
    ds_read_b128 a[16:19], v201 offset:4096
    s_waitcnt lgkmcnt(0)
    v_mfma_f32_16x16x32_bf16 v[100:103], a[16:19], v[148:151], v[100:103]
    v_mfma_f32_16x16x32_bf16 v[108:111], a[16:19], v[164:167], v[108:111]
    v_mfma_f32_16x16x32_bf16 v[116:119], a[16:19], v[180:183], v[116:119]
    s_nop 1
    ds_read_b128 a[16:19], v202 offset:4096
    s_waitcnt lgkmcnt(0)
    v_mfma_f32_16x16x32_bf16 v[100:103], a[16:19], v[152:155], v[100:103]
    v_mfma_f32_16x16x32_bf16 v[108:111], a[16:19], v[168:171], v[108:111]
    v_mfma_f32_16x16x32_bf16 v[116:119], a[16:19], v[184:187], v[116:119]
    s_nop 1
    ds_read_b128 a[16:19], v203 offset:4096
    s_waitcnt lgkmcnt(0)
    v_mfma_f32_16x16x32_bf16 v[100:103], a[16:19], v[156:159], v[100:103]
    v_mfma_f32_16x16x32_bf16 v[108:111], a[16:19], v[172:175], v[108:111]
    v_mfma_f32_16x16x32_bf16 v[116:119], a[16:19], v[188:191], v[116:119]
    s_nop 1
    v_max3_f32 v140, v140, v96, v97
    v_max3_f32 v140, v140, v98, v99
    s_nop 1
    v_max3_f32 v140, v140, v100, v101
    v_max3_f32 v140, v140, v102, v103
    v_max3_f32 v141, v141, v104, v105
    v_max3_f32 v141, v141, v106, v107
    v_max3_f32 v141, v141, v108, v109
    v_max3_f32 v141, v141, v110, v111
    v_max3_f32 v142, v142, v112, v113
    v_max3_f32 v142, v142, v114, v115
    v_max3_f32 v142, v142, v116, v117
    v_max3_f32 v142, v142, v118, v119
    s_barrier
    s_add_u32 s73, s73, 1
    s_cmp_lt_u32 s73, 16
    s_cbranch_scc1 L_k1_p1
    s_nop 3
    v_mov_b32 v143, v140
    s_nop 1
    v_permlane32_swap_b32 v140, v143
    v_max_f32 v140, v140, v143
    v_mov_b32 v143, v140
    s_nop 1
    v_permlane16_swap_b32 v140, v143
    v_max_f32 v140, v140, v143
    v_mov_b32 v143, v141
    s_nop 1
    v_permlane32_swap_b32 v141, v143
    v_max_f32 v141, v141, v143
    v_mov_b32 v143, v141
    s_nop 1
    v_permlane16_swap_b32 v141, v143
    v_max_f32 v141, v141, v143
    v_mov_b32 v143, v142
    s_nop 1
    v_permlane32_swap_b32 v142, v143
    v_max_f32 v142, v142, v143
    v_mov_b32 v143, v142
    s_nop 1
    v_permlane16_swap_b32 v142, v143
    v_max_f32 v142, v142, v143
    v_mov_b32 v0, 0
    v_mov_b32 v1, 0
    v_mov_b32 v2, 0
    v_mov_b32 v3, 0
    v_mov_b32 v4, 0
    v_mov_b32 v5, 0
    v_mov_b32 v6, 0
    v_mov_b32 v7, 0
    v_mov_b32 v8, 0
    v_mov_b32 v9, 0
    v_mov_b32 v10, 0
    v_mov_b32 v11, 0
    v_mov_b32 v12, 0
    v_mov_b32 v13, 0
    v_mov_b32 v14, 0
    v_mov_b32 v15, 0
    v_mov_b32 v16, 0
    v_mov_b32 v17, 0
    v_mov_b32 v18, 0
    v_mov_b32 v19, 0
    v_mov_b32 v20, 0
    v_mov_b32 v21, 0
    v_mov_b32 v22, 0
    v_mov_b32 v23, 0
    v_mov_b32 v24, 0
    v_mov_b32 v25, 0
    v_mov_b32 v26, 0
    v_mov_b32 v27, 0
    v_mov_b32 v28, 0
    v_mov_b32 v29, 0
    v_mov_b32 v30, 0
    v_mov_b32 v31, 0
    v_mov_b32 v32, 0
    v_mov_b32 v33, 0
    v_mov_b32 v34, 0
    v_mov_b32 v35, 0
    v_mov_b32 v36, 0
    v_mov_b32 v37, 0
    v_mov_b32 v38, 0
    v_mov_b32 v39, 0
    v_mov_b32 v40, 0
    v_mov_b32 v41, 0
    v_mov_b32 v42, 0
    v_mov_b32 v43, 0
    v_mov_b32 v44, 0
    v_mov_b32 v45, 0
    v_mov_b32 v46, 0
    v_mov_b32 v47, 0
    v_mov_b32 v48, 0
    v_mov_b32 v49, 0
    v_mov_b32 v50, 0
    v_mov_b32 v51, 0
    v_mov_b32 v52, 0
    v_mov_b32 v53, 0
    v_mov_b32 v54, 0
    v_mov_b32 v55, 0
    v_mov_b32 v56, 0
    v_mov_b32 v57, 0
    v_mov_b32 v58, 0
    v_mov_b32 v59, 0
    v_mov_b32 v60, 0
    v_mov_b32 v61, 0
    v_mov_b32 v62, 0
    v_mov_b32 v63, 0
    v_mov_b32 v64, 0
    v_mov_b32 v65, 0
    v_mov_b32 v66, 0
    v_mov_b32 v67, 0
    v_mov_b32 v68, 0
    v_mov_b32 v69, 0
    v_mov_b32 v70, 0
    v_mov_b32 v71, 0
    v_mov_b32 v72, 0
    v_mov_b32 v73, 0
    v_mov_b32 v74, 0
    v_mov_b32 v75, 0
    v_mov_b32 v76, 0
    v_mov_b32 v77, 0
    v_mov_b32 v78, 0
    v_mov_b32 v79, 0
    v_mov_b32 v80, 0
    v_mov_b32 v81, 0
    v_mov_b32 v82, 0
    v_mov_b32 v83, 0
    v_mov_b32 v84, 0
    v_mov_b32 v85, 0
    v_mov_b32 v86, 0
    v_mov_b32 v87, 0
    v_mov_b32 v88, 0
    v_mov_b32 v89, 0
    v_mov_b32 v90, 0
    v_mov_b32 v91, 0
    v_mov_b32 v92, 0
    v_mov_b32 v93, 0
    v_mov_b32 v94, 0
    v_mov_b32 v95, 0
    v_accvgpr_write_b32 a0, 0
    v_accvgpr_write_b32 a1, 0
    v_accvgpr_write_b32 a2, 0
    v_accvgpr_write_b32 a3, 0
    v_accvgpr_write_b32 a4, 0
    v_accvgpr_write_b32 a5, 0
    v_accvgpr_write_b32 a6, 0
    v_accvgpr_write_b32 a7, 0
    v_accvgpr_write_b32 a8, 0
    v_accvgpr_write_b32 a9, 0
    v_accvgpr_write_b32 a10, 0
    v_accvgpr_write_b32 a11, 0
    s_mov_b32 s73, 0
L_k1_p2:
    s_lshl_b32 s66, s73, 13
    s_add_u32 m0, s64, 16384
    s_nop 0
    buffer_load_dwordx4 v205, s[44:47], s66 offen nt lds
    buffer_load_dwordx4 v206, s[44:47], s66 offen offset:1024 nt lds
    s_add_u32 m0, s64, 0
    s_nop 0
    buffer_load_dwordx4 v205, s[48:51], s66 offen nt lds
    buffer_load_dwordx4 v206, s[48:51], s66 offen offset:1024 nt lds
    s_waitcnt vmcnt(0)
    s_barrier
    ds_read_b128 a[16:19], v200
    s_waitcnt lgkmcnt(0)
    v_mfma_f32_16x16x32_bf16 v[96:99], a[16:19], v[144:147], 0
    v_mfma_f32_16x16x32_bf16 v[104:107], a[16:19], v[160:163], 0
    v_mfma_f32_16x16x32_bf16 v[112:115], a[16:19], v[176:179], 0
    s_nop 1
    ds_read_b128 a[16:19], v201
    s_waitcnt lgkmcnt(0)
    v_mfma_f32_16x16x32_bf16 v[96:99], a[16:19], v[148:151], v[96:99]
    v_mfma_f32_16x16x32_bf16 v[104:107], a[16:19], v[164:167], v[104:107]
    v_mfma_f32_16x16x32_bf16 v[112:115], a[16:19], v[180:183], v[112:115]
    s_nop 1
    ds_read_b128 a[16:19], v202
    s_waitcnt lgkmcnt(0)
    v_mfma_f32_16x16x32_bf16 v[96:99], a[16:19], v[152:155], v[96:99]
    v_mfma_f32_16x16x32_bf16 v[104:107], a[16:19], v[168:171], v[104:107]
    v_mfma_f32_16x16x32_bf16 v[112:115], a[16:19], v[184:187], v[112:115]
    s_nop 1
    ds_read_b128 a[16:19], v203
    s_waitcnt lgkmcnt(0)
    v_mfma_f32_16x16x32_bf16 v[96:99], a[16:19], v[156:159], v[96:99]
    v_mfma_f32_16x16x32_bf16 v[104:107], a[16:19], v[172:175], v[104:107]
    v_mfma_f32_16x16x32_bf16 v[112:115], a[16:19], v[188:191], v[112:115]
    s_nop 1
    ds_read_b128 a[16:19], v200 offset:4096
    s_waitcnt lgkmcnt(0)
    v_mfma_f32_16x16x32_bf16 v[100:103], a[16:19], v[144:147], 0
    v_mfma_f32_16x16x32_bf16 v[108:111], a[16:19], v[160:163], 0
    v_mfma_f32_16x16x32_bf16 v[116:119], a[16:19], v[176:179], 0
    s_nop 1
    ds_read_b128 a[16:19], v201 offset:4096
    s_waitcnt lgkmcnt(0)
    v_mfma_f32_16x16x32_bf16 v[100:103], a[16:19], v[148:151], v[100:103]
    v_mfma_f32_16x16x32_bf16 v[108:111], a[16:19], v[164:167], v[108:111]
    v_mfma_f32_16x16x32_bf16 v[116:119], a[16:19], v[180:183], v[116:119]
    s_nop 1
    ds_read_b128 a[16:19], v202 offset:4096
    s_waitcnt lgkmcnt(0)
    v_mfma_f32_16x16x32_bf16 v[100:103], a[16:19], v[152:155], v[100:103]
    v_mfma_f32_16x16x32_bf16 v[108:111], a[16:19], v[168:171], v[108:111]
    v_mfma_f32_16x16x32_bf16 v[116:119], a[16:19], v[184:187], v[116:119]
    s_nop 1
    ds_read_b128 a[16:19], v203 offset:4096
    s_waitcnt lgkmcnt(0)
    v_mfma_f32_16x16x32_bf16 v[100:103], a[16:19], v[156:159], v[100:103]
    v_mfma_f32_16x16x32_bf16 v[108:111], a[16:19], v[172:175], v[108:111]
    v_mfma_f32_16x16x32_bf16 v[116:119], a[16:19], v[188:191], v[116:119]
    s_nop 1
    s_nop 7
    v_sub_f32 v96, v96, v140
    v_sub_f32 v97, v97, v140
    v_sub_f32 v98, v98, v140
    v_sub_f32 v99, v99, v140
    v_exp_f32 v96, v96
    v_exp_f32 v97, v97
    v_exp_f32 v98, v98
    v_exp_f32 v99, v99
    v_cvt_pk_bf16_f32 v120, v96, v97
    v_cvt_pk_bf16_f32 v121, v98, v99
    v_sub_f32 v100, v100, v140
    v_sub_f32 v101, v101, v140
    v_sub_f32 v102, v102, v140
    v_sub_f32 v103, v103, v140
    v_exp_f32 v100, v100
    v_exp_f32 v101, v101
    v_exp_f32 v102, v102
    v_exp_f32 v103, v103
    v_cvt_pk_bf16_f32 v122, v100, v101
    v_cvt_pk_bf16_f32 v123, v102, v103
    v_sub_f32 v104, v104, v141
    v_sub_f32 v105, v105, v141
    v_sub_f32 v106, v106, v141
    v_sub_f32 v107, v107, v141
    v_exp_f32 v104, v104
    v_exp_f32 v105, v105
    v_exp_f32 v106, v106
    v_exp_f32 v107, v107
    v_cvt_pk_bf16_f32 v124, v104, v105
    v_cvt_pk_bf16_f32 v125, v106, v107
    v_sub_f32 v108, v108, v141
    v_sub_f32 v109, v109, v141
    v_sub_f32 v110, v110, v141
    v_sub_f32 v111, v111, v141
    v_exp_f32 v108, v108
    v_exp_f32 v109, v109
    v_exp_f32 v110, v110
    v_exp_f32 v111, v111
    v_cvt_pk_bf16_f32 v126, v108, v109
    v_cvt_pk_bf16_f32 v127, v110, v111
    v_sub_f32 v112, v112, v142
    v_sub_f32 v113, v113, v142
    v_sub_f32 v114, v114, v142
    v_sub_f32 v115, v115, v142
    v_exp_f32 v112, v112
    v_exp_f32 v113, v113
    v_exp_f32 v114, v114
    v_exp_f32 v115, v115
    v_cvt_pk_bf16_f32 v128, v112, v113
    v_cvt_pk_bf16_f32 v129, v114, v115
    v_sub_f32 v116, v116, v142
    v_sub_f32 v117, v117, v142
    v_sub_f32 v118, v118, v142
    v_sub_f32 v119, v119, v142
    v_exp_f32 v116, v116
    v_exp_f32 v117, v117
    v_exp_f32 v118, v118
    v_exp_f32 v119, v119
    v_cvt_pk_bf16_f32 v130, v116, v117
    v_cvt_pk_bf16_f32 v131, v118, v119
    v_mfma_f32_16x16x32_bf16 a[0:3], a[12:15], v[120:123], a[0:3]
    v_mfma_f32_16x16x32_bf16 a[4:7], a[12:15], v[124:127], a[4:7]
    v_mfma_f32_16x16x32_bf16 a[8:11], a[12:15], v[128:131], a[8:11]
    ds_read_b64_tr_b16 a[32:33], v192
    ds_read_b64_tr_b16 a[34:35], v192 offset:4096
    s_waitcnt lgkmcnt(0)
    v_mfma_f32_16x16x32_bf16 v[0:3], a[32:35], v[120:123], v[0:3]
    v_mfma_f32_16x16x32_bf16 v[32:35], a[32:35], v[124:127], v[32:35]
    v_mfma_f32_16x16x32_bf16 v[64:67], a[32:35], v[128:131], v[64:67]
    s_nop 1
    ds_read_b64_tr_b16 a[32:33], v193
    ds_read_b64_tr_b16 a[34:35], v193 offset:4096
    s_waitcnt lgkmcnt(0)
    v_mfma_f32_16x16x32_bf16 v[4:7], a[32:35], v[120:123], v[4:7]
    v_mfma_f32_16x16x32_bf16 v[36:39], a[32:35], v[124:127], v[36:39]
    v_mfma_f32_16x16x32_bf16 v[68:71], a[32:35], v[128:131], v[68:71]
    s_nop 1
    ds_read_b64_tr_b16 a[32:33], v194
    ds_read_b64_tr_b16 a[34:35], v194 offset:4096
    s_waitcnt lgkmcnt(0)
    v_mfma_f32_16x16x32_bf16 v[8:11], a[32:35], v[120:123], v[8:11]
    v_mfma_f32_16x16x32_bf16 v[40:43], a[32:35], v[124:127], v[40:43]
    v_mfma_f32_16x16x32_bf16 v[72:75], a[32:35], v[128:131], v[72:75]
    s_nop 1
    ds_read_b64_tr_b16 a[32:33], v195
    ds_read_b64_tr_b16 a[34:35], v195 offset:4096
    s_waitcnt lgkmcnt(0)
    v_mfma_f32_16x16x32_bf16 v[12:15], a[32:35], v[120:123], v[12:15]
    v_mfma_f32_16x16x32_bf16 v[44:47], a[32:35], v[124:127], v[44:47]
    v_mfma_f32_16x16x32_bf16 v[76:79], a[32:35], v[128:131], v[76:79]
    s_nop 1
    ds_read_b64_tr_b16 a[32:33], v196
    ds_read_b64_tr_b16 a[34:35], v196 offset:4096
    s_waitcnt lgkmcnt(0)
    v_mfma_f32_16x16x32_bf16 v[16:19], a[32:35], v[120:123], v[16:19]
    v_mfma_f32_16x16x32_bf16 v[48:51], a[32:35], v[124:127], v[48:51]
    v_mfma_f32_16x16x32_bf16 v[80:83], a[32:35], v[128:131], v[80:83]
    s_nop 1
    ds_read_b64_tr_b16 a[32:33], v197
    ds_read_b64_tr_b16 a[34:35], v197 offset:4096
    s_waitcnt lgkmcnt(0)
    v_mfma_f32_16x16x32_bf16 v[20:23], a[32:35], v[120:123], v[20:23]
    v_mfma_f32_16x16x32_bf16 v[52:55], a[32:35], v[124:127], v[52:55]
    v_mfma_f32_16x16x32_bf16 v[84:87], a[32:35], v[128:131], v[84:87]
    s_nop 1
    ds_read_b64_tr_b16 a[32:33], v198
    ds_read_b64_tr_b16 a[34:35], v198 offset:4096
    s_waitcnt lgkmcnt(0)
    v_mfma_f32_16x16x32_bf16 v[24:27], a[32:35], v[120:123], v[24:27]
    v_mfma_f32_16x16x32_bf16 v[56:59], a[32:35], v[124:127], v[56:59]
    v_mfma_f32_16x16x32_bf16 v[88:91], a[32:35], v[128:131], v[88:91]
    s_nop 1
    ds_read_b64_tr_b16 a[32:33], v199
    ds_read_b64_tr_b16 a[34:35], v199 offset:4096
    s_waitcnt lgkmcnt(0)
    v_mfma_f32_16x16x32_bf16 v[28:31], a[32:35], v[120:123], v[28:31]
    v_mfma_f32_16x16x32_bf16 v[60:63], a[32:35], v[124:127], v[60:63]
    v_mfma_f32_16x16x32_bf16 v[92:95], a[32:35], v[128:131], v[92:95]
    s_nop 1
    s_barrier
    s_add_u32 s73, s73, 1
    s_cmp_lt_u32 s73, 16
    s_cbranch_scc1 L_k1_p2
    s_nop 7
    v_lshlrev_b32 v99, 4, v207
    v_accvgpr_read_b32 v96, a0
    v_accvgpr_read_b32 v97, a4
    v_accvgpr_read_b32 v98, a8
    v_rcp_f32 v96, v96
    v_rcp_f32 v97, v97
    v_rcp_f32 v98, v98
    v_mul_f32 v0, v96, v0
    v_mul_f32 v1, v96, v1
    v_mul_f32 v2, v96, v2
    v_mul_f32 v3, v96, v3
    v_mul_f32 v4, v96, v4
    v_mul_f32 v5, v96, v5
    v_mul_f32 v6, v96, v6
    v_mul_f32 v7, v96, v7
    v_cvt_pk_bf16_f32 v100, v0, v1
    v_cvt_pk_bf16_f32 v101, v2, v3
    v_cvt_pk_bf16_f32 v102, v4, v5
    v_cvt_pk_bf16_f32 v103, v6, v7
    s_mov_b32 s66, 0
    buffer_store_dwordx4 v[100:103], v99, s[52:55], s66 offen sc1
    v_mul_f32 v8, v96, v8
    v_mul_f32 v9, v96, v9
    v_mul_f32 v10, v96, v10
    v_mul_f32 v11, v96, v11
    v_mul_f32 v12, v96, v12
    v_mul_f32 v13, v96, v13
    v_mul_f32 v14, v96, v14
    v_mul_f32 v15, v96, v15
    v_cvt_pk_bf16_f32 v104, v8, v9
    v_cvt_pk_bf16_f32 v105, v10, v11
    v_cvt_pk_bf16_f32 v106, v12, v13
    v_cvt_pk_bf16_f32 v107, v14, v15
    s_mov_b32 s66, 98304
    buffer_store_dwordx4 v[104:107], v99, s[52:55], s66 offen sc1
    v_mul_f32 v16, v96, v16
    v_mul_f32 v17, v96, v17
    v_mul_f32 v18, v96, v18
    v_mul_f32 v19, v96, v19
    v_mul_f32 v20, v96, v20
    v_mul_f32 v21, v96, v21
    v_mul_f32 v22, v96, v22
    v_mul_f32 v23, v96, v23
    v_cvt_pk_bf16_f32 v108, v16, v17
    v_cvt_pk_bf16_f32 v109, v18, v19
    v_cvt_pk_bf16_f32 v110, v20, v21
    v_cvt_pk_bf16_f32 v111, v22, v23
    s_mov_b32 s66, 196608
    buffer_store_dwordx4 v[108:111], v99, s[52:55], s66 offen sc1
    v_mul_f32 v24, v96, v24
    v_mul_f32 v25, v96, v25
    v_mul_f32 v26, v96, v26
    v_mul_f32 v27, v96, v27
    v_mul_f32 v28, v96, v28
    v_mul_f32 v29, v96, v29
    v_mul_f32 v30, v96, v30
    v_mul_f32 v31, v96, v31
    v_cvt_pk_bf16_f32 v112, v24, v25
    v_cvt_pk_bf16_f32 v113, v26, v27
    v_cvt_pk_bf16_f32 v114, v28, v29
    v_cvt_pk_bf16_f32 v115, v30, v31
    s_mov_b32 s66, 294912
    buffer_store_dwordx4 v[112:115], v99, s[52:55], s66 offen sc1
    v_mul_f32 v32, v97, v32
    v_mul_f32 v33, v97, v33
    v_mul_f32 v34, v97, v34
    v_mul_f32 v35, v97, v35
    v_mul_f32 v36, v97, v36
    v_mul_f32 v37, v97, v37
    v_mul_f32 v38, v97, v38
    v_mul_f32 v39, v97, v39
    v_cvt_pk_bf16_f32 v116, v32, v33
    v_cvt_pk_bf16_f32 v117, v34, v35
    v_cvt_pk_bf16_f32 v118, v36, v37
    v_cvt_pk_bf16_f32 v119, v38, v39
    s_mov_b32 s66, 0
    buffer_store_dwordx4 v[116:119], v99, s[52:55], s66 offen offset:1024 sc1
    v_mul_f32 v40, v97, v40
    v_mul_f32 v41, v97, v41
    v_mul_f32 v42, v97, v42
    v_mul_f32 v43, v97, v43
    v_mul_f32 v44, v97, v44
    v_mul_f32 v45, v97, v45
    v_mul_f32 v46, v97, v46
    v_mul_f32 v47, v97, v47
    v_cvt_pk_bf16_f32 v120, v40, v41
    v_cvt_pk_bf16_f32 v121, v42, v43
    v_cvt_pk_bf16_f32 v122, v44, v45
    v_cvt_pk_bf16_f32 v123, v46, v47
    s_mov_b32 s66, 98304
    buffer_store_dwordx4 v[120:123], v99, s[52:55], s66 offen offset:1024 sc1
    v_mul_f32 v48, v97, v48
    v_mul_f32 v49, v97, v49
    v_mul_f32 v50, v97, v50
    v_mul_f32 v51, v97, v51
    v_mul_f32 v52, v97, v52
    v_mul_f32 v53, v97, v53
    v_mul_f32 v54, v97, v54
    v_mul_f32 v55, v97, v55
    v_cvt_pk_bf16_f32 v100, v48, v49
    v_cvt_pk_bf16_f32 v101, v50, v51
    v_cvt_pk_bf16_f32 v102, v52, v53
    v_cvt_pk_bf16_f32 v103, v54, v55
    s_mov_b32 s66, 196608
    buffer_store_dwordx4 v[100:103], v99, s[52:55], s66 offen offset:1024 sc1
    v_mul_f32 v56, v97, v56
    v_mul_f32 v57, v97, v57
    v_mul_f32 v58, v97, v58
    v_mul_f32 v59, v97, v59
    v_mul_f32 v60, v97, v60
    v_mul_f32 v61, v97, v61
    v_mul_f32 v62, v97, v62
    v_mul_f32 v63, v97, v63
    v_cvt_pk_bf16_f32 v104, v56, v57
    v_cvt_pk_bf16_f32 v105, v58, v59
    v_cvt_pk_bf16_f32 v106, v60, v61
    v_cvt_pk_bf16_f32 v107, v62, v63
    s_mov_b32 s66, 294912
    buffer_store_dwordx4 v[104:107], v99, s[52:55], s66 offen offset:1024 sc1
    v_mul_f32 v64, v98, v64
    v_mul_f32 v65, v98, v65
    v_mul_f32 v66, v98, v66
    v_mul_f32 v67, v98, v67
    v_mul_f32 v68, v98, v68
    v_mul_f32 v69, v98, v69
    v_mul_f32 v70, v98, v70
    v_mul_f32 v71, v98, v71
    v_cvt_pk_bf16_f32 v108, v64, v65
    v_cvt_pk_bf16_f32 v109, v66, v67
    v_cvt_pk_bf16_f32 v110, v68, v69
    v_cvt_pk_bf16_f32 v111, v70, v71
    s_mov_b32 s66, 0
    buffer_store_dwordx4 v[108:111], v99, s[52:55], s66 offen offset:2048 sc1
    v_mul_f32 v72, v98, v72
    v_mul_f32 v73, v98, v73
    v_mul_f32 v74, v98, v74
    v_mul_f32 v75, v98, v75
    v_mul_f32 v76, v98, v76
    v_mul_f32 v77, v98, v77
    v_mul_f32 v78, v98, v78
    v_mul_f32 v79, v98, v79
    v_cvt_pk_bf16_f32 v112, v72, v73
    v_cvt_pk_bf16_f32 v113, v74, v75
    v_cvt_pk_bf16_f32 v114, v76, v77
    v_cvt_pk_bf16_f32 v115, v78, v79
    s_mov_b32 s66, 98304
    buffer_store_dwordx4 v[112:115], v99, s[52:55], s66 offen offset:2048 sc1
    v_mul_f32 v80, v98, v80
    v_mul_f32 v81, v98, v81
    v_mul_f32 v82, v98, v82
    v_mul_f32 v83, v98, v83
    v_mul_f32 v84, v98, v84
    v_mul_f32 v85, v98, v85
    v_mul_f32 v86, v98, v86
    v_mul_f32 v87, v98, v87
    v_cvt_pk_bf16_f32 v116, v80, v81
    v_cvt_pk_bf16_f32 v117, v82, v83
    v_cvt_pk_bf16_f32 v118, v84, v85
    v_cvt_pk_bf16_f32 v119, v86, v87
    s_mov_b32 s66, 196608
    buffer_store_dwordx4 v[116:119], v99, s[52:55], s66 offen offset:2048 sc1
    v_mul_f32 v88, v98, v88
    v_mul_f32 v89, v98, v89
    v_mul_f32 v90, v98, v90
    v_mul_f32 v91, v98, v91
    v_mul_f32 v92, v98, v92
    v_mul_f32 v93, v98, v93
    v_mul_f32 v94, v98, v94
    v_mul_f32 v95, v98, v95
    v_cvt_pk_bf16_f32 v120, v88, v89
    v_cvt_pk_bf16_f32 v121, v90, v91
    v_cvt_pk_bf16_f32 v122, v92, v93
    v_cvt_pk_bf16_f32 v123, v94, v95
    s_mov_b32 s66, 294912
    buffer_store_dwordx4 v[120:123], v99, s[52:55], s66 offen offset:2048 sc1
    s_waitcnt vmcnt(0)
    s_endpgm
.globl oproj_kernel
.p2align 8
.type oproj_kernel,@function
oproj_kernel:
    s_cmp_ge_u32 s2, 256
    s_cbranch_scc1 L_k2_done
    s_and_b32 s7, s2, 7
    s_lshr_b32 s4, s7, 2
    s_and_b32 s7, s7, 3
    s_lshl_b32 s7, s7, 5
    s_lshr_b32 s28, s2, 3
    s_add_u32 s7, s7, s28
    s_cmp_ge_u32 s7, 126
    s_cbranch_scc1 L_k2_done
    s_load_dwordx2 s[20:21], s[0:1], 32
    s_load_dwordx2 s[22:23], s[0:1], 72
    s_load_dwordx2 s[32:33], s[0:1], 80
    s_load_dwordx2 s[30:31], s[0:1], 96
    s_mul_i32 s5, s7, 7282
    s_lshr_b32 s5, s5, 16
    s_mul_i32 s28, s5, 9
    s_sub_u32 s6, s7, s28
    v_lshrrev_b32 v1, 6, v0
    v_and_b32 v151, 63, v0
    v_readfirstlane_b32 s3, v1
    v_lshrrev_b32 v2, 3, v151
    v_mul_u32_u24 v2, 1152, v2
    v_lshrrev_b32 v3, 4, v151
    v_lshlrev_b32 v3, 1, v3
    v_and_b32 v4, 7, v151
    v_xor_b32 v4, v4, v3
    v_lshl_add_u32 v148, v4, 4, v2
    s_mul_i32 s29, s3, 24576
    v_lshrrev_b32 v2, 2, v151
    v_lshrrev_b32 v3, 1, v2
    v_and_b32 v3, 3, v3
    v_lshlrev_b32 v3, 5, v3
    v_and_b32 v4, 3, v151
    v_lshlrev_b32 v4, 3, v4
    v_lshlrev_b32 v2, 7, v2
    v_add3_u32 v2, v2, v3, v4
    v_add_u32 v2, s29, v2
    v_mov_b32 v144, v2
    v_xor_b32 v145, 32, v2
    v_xor_b32 v146, 64, v2
    v_xor_b32 v147, 96, v2
    v_lshlrev_b32 v149, 4, v151
    v_and_b32 v2, 15, v151
    v_mul_u32_u24 v2, 2304, v2
    v_lshrrev_b32 v3, 4, v151
    v_lshl_add_u32 v150, v3, 3, v2
    s_waitcnt lgkmcnt(0)
    s_cmp_eq_u32 s4, 0
    s_cselect_b32 s20, s20, s22
    s_cselect_b32 s21, s21, s23
    s_lshl_b32 s7, s6, 7
    s_add_u32 s12, s20, s7
    s_addc_u32 s13, s21, 0
    s_sub_u32 s14, 4718592, s7
    s_mov_b32 s15, 0x20000
    s_mul_i32 s7, s4, 12288
    s_mul_i32 s28, s5, 7
    s_add_u32 s7, s7, s28
    s_lshl_b32 s7, s7, 10
    s_add_u32 s8, s30, s7
    s_addc_u32 s9, s31, 0
    s_sub_u32 s10, 25165824, s7
    s_mov_b32 s11, 0x20000
    s_mul_i32 s7, s5, 258048
    s_mul_i32 s28, s4, 1152
    s_add_u32 s7, s7, s28
    s_lshl_b32 s28, s6, 7
    s_add_u32 s7, s7, s28
    s_add_u32 s16, s32, s7
    s_addc_u32 s17, s33, 0
    s_sub_u32 s18, 3538944, s7
    s_mov_b32 s19, 0x20000
    s_mul_i32 s46, s3, 98304
    s_mul_i32 s47, s3, 36864
    s_add_u32 m0, s29, 0
    s_add_u32 s42, s47, 0
    s_add_u32 s43, s47, 8192
    s_add_u32 s44, s47, 16384
    s_add_u32 s45, s47, 24576
    buffer_load_dwordx4 v148, s[12:15], s42 offen lds
    buffer_load_dwordx4 v148, s[12:15], s43 offen offset:1024 lds
    buffer_load_dwordx4 v148, s[12:15], s44 offen offset:2048 lds
    buffer_load_dwordx4 v148, s[12:15], s45 offen offset:3072 lds
    s_add_u32 s40, s46, 0
    s_add_u32 s41, s46, 4096
    buffer_load_dwordx4 a[0:3], v149, s[8:11], s40 offen
    buffer_load_dwordx4 a[4:7], v149, s[8:11], s40 offen offset:1024
    buffer_load_dwordx4 a[8:11], v149, s[8:11], s40 offen offset:2048
    buffer_load_dwordx4 a[12:15], v149, s[8:11], s40 offen offset:3072
    buffer_load_dwordx4 a[16:19], v149, s[8:11], s41 offen
    buffer_load_dwordx4 a[20:23], v149, s[8:11], s41 offen offset:1024
    buffer_load_dwordx4 a[24:27], v149, s[8:11], s41 offen offset:2048
    s_add_u32 m0, s29, 4096
    s_add_u32 s42, s47, 147456
    s_add_u32 s43, s47, 155648
    s_add_u32 s44, s47, 163840
    s_add_u32 s45, s47, 172032
    buffer_load_dwordx4 v148, s[12:15], s42 offen lds
    buffer_load_dwordx4 v148, s[12:15], s43 offen offset:1024 lds
    buffer_load_dwordx4 v148, s[12:15], s44 offen offset:2048 lds
    buffer_load_dwordx4 v148, s[12:15], s45 offen offset:3072 lds
    s_add_u32 s40, s46, 393216
    s_add_u32 s41, s46, 397312
    buffer_load_dwordx4 a[28:31], v149, s[8:11], s40 offen
    buffer_load_dwordx4 a[32:35], v149, s[8:11], s40 offen offset:1024
    buffer_load_dwordx4 a[36:39], v149, s[8:11], s40 offen offset:2048
    buffer_load_dwordx4 a[40:43], v149, s[8:11], s40 offen offset:3072
    buffer_load_dwordx4 a[44:47], v149, s[8:11], s41 offen
    buffer_load_dwordx4 a[48:51], v149, s[8:11], s41 offen offset:1024
    buffer_load_dwordx4 a[52:55], v149, s[8:11], s41 offen offset:2048
    s_add_u32 m0, s29, 8192
    s_add_u32 s42, s47, 294912
    s_add_u32 s43, s47, 303104
    s_add_u32 s44, s47, 311296
    s_add_u32 s45, s47, 319488
    buffer_load_dwordx4 v148, s[12:15], s42 offen lds
    buffer_load_dwordx4 v148, s[12:15], s43 offen offset:1024 lds
    buffer_load_dwordx4 v148, s[12:15], s44 offen offset:2048 lds
    buffer_load_dwordx4 v148, s[12:15], s45 offen offset:3072 lds
    s_add_u32 s40, s46, 786432
    s_add_u32 s41, s46, 790528
    buffer_load_dwordx4 a[56:59], v149, s[8:11], s40 offen
    buffer_load_dwordx4 a[60:63], v149, s[8:11], s40 offen offset:1024
    buffer_load_dwordx4 a[64:67], v149, s[8:11], s40 offen offset:2048
    buffer_load_dwordx4 a[68:71], v149, s[8:11], s40 offen offset:3072
    buffer_load_dwordx4 a[72:75], v149, s[8:11], s41 offen
    buffer_load_dwordx4 a[76:79], v149, s[8:11], s41 offen offset:1024
    buffer_load_dwordx4 a[80:83], v149, s[8:11], s41 offen offset:2048
    s_add_u32 m0, s29, 12288
    s_add_u32 s42, s47, 442368
    s_add_u32 s43, s47, 450560
    s_add_u32 s44, s47, 458752
    s_add_u32 s45, s47, 466944
    buffer_load_dwordx4 v148, s[12:15], s42 offen lds
    buffer_load_dwordx4 v148, s[12:15], s43 offen offset:1024 lds
    buffer_load_dwordx4 v148, s[12:15], s44 offen offset:2048 lds
    buffer_load_dwordx4 v148, s[12:15], s45 offen offset:3072 lds
    s_add_u32 m0, s29, 16384
    s_add_u32 s42, s47, 589824
    s_add_u32 s43, s47, 598016
    s_add_u32 s44, s47, 606208
    s_add_u32 s45, s47, 614400
    buffer_load_dwordx4 v148, s[12:15], s42 offen lds
    buffer_load_dwordx4 v148, s[12:15], s43 offen offset:1024 lds
    buffer_load_dwordx4 v148, s[12:15], s44 offen offset:2048 lds
    buffer_load_dwordx4 v148, s[12:15], s45 offen offset:3072 lds
    s_waitcnt vmcnt(37)
    ds_read_b64_tr_b16 v[112:113], v144
    ds_read_b64_tr_b16 v[114:115], v144 offset:2048
    ds_read_b64_tr_b16 v[116:117], v145
    ds_read_b64_tr_b16 v[118:119], v145 offset:2048
    ds_read_b64_tr_b16 v[120:121], v146
    ds_read_b64_tr_b16 v[122:123], v146 offset:2048
    ds_read_b64_tr_b16 v[124:125], v147
    ds_read_b64_tr_b16 v[126:127], v147 offset:2048
    s_waitcnt vmcnt(30)
    s_waitcnt lgkmcnt(6)
    v_mfma_f32_16x16x32_bf16 v[0:3], v[112:115], a[0:3], 0
    s_add_u32 s40, s46, 1179648
    s_add_u32 s41, s46, 1183744
    s_waitcnt lgkmcnt(4)
    v_mfma_f32_16x16x32_bf16 v[4:7], v[116:119], a[0:3], 0
    buffer_load_dwordx4 a[84:87], v149, s[8:11], s40 offen
    s_waitcnt lgkmcnt(2)
    v_mfma_f32_16x16x32_bf16 v[8:11], v[120:123], a[0:3], 0
    buffer_load_dwordx4 a[88:91], v149, s[8:11], s40 offen offset:1024
    s_waitcnt lgkmcnt(0)
    v_mfma_f32_16x16x32_bf16 v[12:15], v[124:127], a[0:3], 0
    buffer_load_dwordx4 a[92:95], v149, s[8:11], s40 offen offset:2048
    v_mfma_f32_16x16x32_bf16 v[16:19], v[112:115], a[4:7], 0
    s_waitcnt vmcnt(29)
    buffer_load_dwordx4 a[96:99], v149, s[8:11], s40 offen offset:3072
    v_mfma_f32_16x16x32_bf16 v[20:23], v[116:119], a[4:7], 0
    ds_read_b64_tr_b16 v[128:129], v144 offset:4096
    v_mfma_f32_16x16x32_bf16 v[24:27], v[120:123], a[4:7], 0
    ds_read_b64_tr_b16 v[130:131], v144 offset:6144
    v_mfma_f32_16x16x32_bf16 v[28:31], v[124:127], a[4:7], 0
    ds_read_b64_tr_b16 v[132:133], v145 offset:4096
    v_mfma_f32_16x16x32_bf16 v[32:35], v[112:115], a[8:11], 0
    ds_read_b64_tr_b16 v[134:135], v145 offset:6144
    v_mfma_f32_16x16x32_bf16 v[36:39], v[116:119], a[8:11], 0
    ds_read_b64_tr_b16 v[136:137], v146 offset:4096
    v_mfma_f32_16x16x32_bf16 v[40:43], v[120:123], a[8:11], 0
    buffer_load_dwordx4 a[100:103], v149, s[8:11], s41 offen
    v_mfma_f32_16x16x32_bf16 v[44:47], v[124:127], a[8:11], 0
    ds_read_b64_tr_b16 v[138:139], v146 offset:6144
    v_mfma_f32_16x16x32_bf16 v[48:51], v[112:115], a[12:15], 0
    ds_read_b64_tr_b16 v[140:141], v147 offset:4096
    v_mfma_f32_16x16x32_bf16 v[52:55], v[116:119], a[12:15], 0
    ds_read_b64_tr_b16 v[142:143], v147 offset:6144
    v_mfma_f32_16x16x32_bf16 v[56:59], v[120:123], a[12:15], 0
    buffer_load_dwordx4 a[104:107], v149, s[8:11], s41 offen offset:1024
    v_mfma_f32_16x16x32_bf16 v[60:63], v[124:127], a[12:15], 0
    buffer_load_dwordx4 a[108:111], v149, s[8:11], s41 offen offset:2048
    s_add_u32 m0, s29, 20480
    s_add_u32 s42, s47, 737280
    s_add_u32 s43, s47, 745472
    s_add_u32 s44, s47, 753664
    s_add_u32 s45, s47, 761856
    v_mfma_f32_16x16x32_bf16 v[64:67], v[112:115], a[16:19], 0
    buffer_load_dwordx4 v148, s[12:15], s42 offen lds
    v_mfma_f32_16x16x32_bf16 v[68:71], v[116:119], a[16:19], 0
    buffer_load_dwordx4 v148, s[12:15], s43 offen offset:1024 lds
    v_mfma_f32_16x16x32_bf16 v[72:75], v[120:123], a[16:19], 0
    buffer_load_dwordx4 v148, s[12:15], s44 offen offset:2048 lds
    v_mfma_f32_16x16x32_bf16 v[76:79], v[124:127], a[16:19], 0
    buffer_load_dwordx4 v148, s[12:15], s45 offen offset:3072 lds
    v_mfma_f32_16x16x32_bf16 v[80:83], v[112:115], a[20:23], 0
    v_mfma_f32_16x16x32_bf16 v[84:87], v[116:119], a[20:23], 0
    v_mfma_f32_16x16x32_bf16 v[88:91], v[120:123], a[20:23], 0
    v_mfma_f32_16x16x32_bf16 v[92:95], v[124:127], a[20:23], 0
    v_mfma_f32_16x16x32_bf16 v[96:99], v[112:115], a[24:27], 0
    v_mfma_f32_16x16x32_bf16 v[100:103], v[116:119], a[24:27], 0
    v_mfma_f32_16x16x32_bf16 v[104:107], v[120:123], a[24:27], 0
    s_waitcnt lgkmcnt(0)
    s_waitcnt vmcnt(30)
    s_add_u32 s40, s46, 1572864
    v_mfma_f32_16x16x32_bf16 v[108:111], v[124:127], a[24:27], 0
    s_add_u32 s41, s46, 1576960
    v_mfma_f32_16x16x32_bf16 v[0:3], v[128:131], a[28:31], v[0:3]
    v_mfma_f32_16x16x32_bf16 v[4:7], v[132:135], a[28:31], v[4:7]
    buffer_load_dwordx4 a[0:3], v149, s[8:11], s40 offen
    v_mfma_f32_16x16x32_bf16 v[8:11], v[136:139], a[28:31], v[8:11]
    buffer_load_dwordx4 a[4:7], v149, s[8:11], s40 offen offset:1024
    v_mfma_f32_16x16x32_bf16 v[12:15], v[140:143], a[28:31], v[12:15]
    buffer_load_dwordx4 a[8:11], v149, s[8:11], s40 offen offset:2048
    v_mfma_f32_16x16x32_bf16 v[16:19], v[128:131], a[32:35], v[16:19]
    s_waitcnt vmcnt(29)
    buffer_load_dwordx4 a[12:15], v149, s[8:11], s40 offen offset:3072
    v_mfma_f32_16x16x32_bf16 v[20:23], v[132:135], a[32:35], v[20:23]
    ds_read_b64_tr_b16 v[112:113], v144 offset:8192
    v_mfma_f32_16x16x32_bf16 v[24:27], v[136:139], a[32:35], v[24:27]
    ds_read_b64_tr_b16 v[114:115], v144 offset:10240
    v_mfma_f32_16x16x32_bf16 v[28:31], v[140:143], a[32:35], v[28:31]
    ds_read_b64_tr_b16 v[116:117], v145 offset:8192
    v_mfma_f32_16x16x32_bf16 v[32:35], v[128:131], a[36:39], v[32:35]
    ds_read_b64_tr_b16 v[118:119], v145 offset:10240
    v_mfma_f32_16x16x32_bf16 v[36:39], v[132:135], a[36:39], v[36:39]
    ds_read_b64_tr_b16 v[120:121], v146 offset:8192
    v_mfma_f32_16x16x32_bf16 v[40:43], v[136:139], a[36:39], v[40:43]
    buffer_load_dwordx4 a[16:19], v149, s[8:11], s41 offen
    v_mfma_f32_16x16x32_bf16 v[44:47], v[140:143], a[36:39], v[44:47]
    ds_read_b64_tr_b16 v[122:123], v146 offset:10240
    v_mfma_f32_16x16x32_bf16 v[48:51], v[128:131], a[40:43], v[48:51]
    ds_read_b64_tr_b16 v[124:125], v147 offset:8192
    v_mfma_f32_16x16x32_bf16 v[52:55], v[132:135], a[40:43], v[52:55]
    ds_read_b64_tr_b16 v[126:127], v147 offset:10240
    v_mfma_f32_16x16x32_bf16 v[56:59], v[136:139], a[40:43], v[56:59]
    buffer_load_dwordx4 a[20:23], v149, s[8:11], s41 offen offset:1024
    v_mfma_f32_16x16x32_bf16 v[60:63], v[140:143], a[40:43], v[60:63]
    buffer_load_dwordx4 a[24:27], v149, s[8:11], s41 offen offset:2048
    s_add_u32 m0, s29, 0
    s_add_u32 s42, s47, 884736
    s_add_u32 s43, s47, 892928
    s_add_u32 s44, s47, 901120
    s_add_u32 s45, s47, 909312
    v_mfma_f32_16x16x32_bf16 v[64:67], v[128:131], a[44:47], v[64:67]
    buffer_load_dwordx4 v148, s[12:15], s42 offen lds
    v_mfma_f32_16x16x32_bf16 v[68:71], v[132:135], a[44:47], v[68:71]
    buffer_load_dwordx4 v148, s[12:15], s43 offen offset:1024 lds
    v_mfma_f32_16x16x32_bf16 v[72:75], v[136:139], a[44:47], v[72:75]
    buffer_load_dwordx4 v148, s[12:15], s44 offen offset:2048 lds
    v_mfma_f32_16x16x32_bf16 v[76:79], v[140:143], a[44:47], v[76:79]
    buffer_load_dwordx4 v148, s[12:15], s45 offen offset:3072 lds
    v_mfma_f32_16x16x32_bf16 v[80:83], v[128:131], a[48:51], v[80:83]
    v_mfma_f32_16x16x32_bf16 v[84:87], v[132:135], a[48:51], v[84:87]
    v_mfma_f32_16x16x32_bf16 v[88:91], v[136:139], a[48:51], v[88:91]
    v_mfma_f32_16x16x32_bf16 v[92:95], v[140:143], a[48:51], v[92:95]
    v_mfma_f32_16x16x32_bf16 v[96:99], v[128:131], a[52:55], v[96:99]
    v_mfma_f32_16x16x32_bf16 v[100:103], v[132:135], a[52:55], v[100:103]
    v_mfma_f32_16x16x32_bf16 v[104:107], v[136:139], a[52:55], v[104:107]
    s_waitcnt lgkmcnt(0)
    s_waitcnt vmcnt(30)
    s_add_u32 s40, s46, 1966080
    v_mfma_f32_16x16x32_bf16 v[108:111], v[140:143], a[52:55], v[108:111]
    s_add_u32 s41, s46, 1970176
    v_mfma_f32_16x16x32_bf16 v[0:3], v[112:115], a[56:59], v[0:3]
    v_mfma_f32_16x16x32_bf16 v[4:7], v[116:119], a[56:59], v[4:7]
    buffer_load_dwordx4 a[28:31], v149, s[8:11], s40 offen
    v_mfma_f32_16x16x32_bf16 v[8:11], v[120:123], a[56:59], v[8:11]
    buffer_load_dwordx4 a[32:35], v149, s[8:11], s40 offen offset:1024
    v_mfma_f32_16x16x32_bf16 v[12:15], v[124:127], a[56:59], v[12:15]
    buffer_load_dwordx4 a[36:39], v149, s[8:11], s40 offen offset:2048
    v_mfma_f32_16x16x32_bf16 v[16:19], v[112:115], a[60:63], v[16:19]
    s_waitcnt vmcnt(29)
    buffer_load_dwordx4 a[40:43], v149, s[8:11], s40 offen offset:3072
    v_mfma_f32_16x16x32_bf16 v[20:23], v[116:119], a[60:63], v[20:23]
    ds_read_b64_tr_b16 v[128:129], v144 offset:12288
    v_mfma_f32_16x16x32_bf16 v[24:27], v[120:123], a[60:63], v[24:27]
    ds_read_b64_tr_b16 v[130:131], v144 offset:14336
    v_mfma_f32_16x16x32_bf16 v[28:31], v[124:127], a[60:63], v[28:31]
    ds_read_b64_tr_b16 v[132:133], v145 offset:12288
    v_mfma_f32_16x16x32_bf16 v[32:35], v[112:115], a[64:67], v[32:35]
    ds_read_b64_tr_b16 v[134:135], v145 offset:14336
    v_mfma_f32_16x16x32_bf16 v[36:39], v[116:119], a[64:67], v[36:39]
    ds_read_b64_tr_b16 v[136:137], v146 offset:12288
    v_mfma_f32_16x16x32_bf16 v[40:43], v[120:123], a[64:67], v[40:43]
    buffer_load_dwordx4 a[44:47], v149, s[8:11], s41 offen
    v_mfma_f32_16x16x32_bf16 v[44:47], v[124:127], a[64:67], v[44:47]
    ds_read_b64_tr_b16 v[138:139], v146 offset:14336
    v_mfma_f32_16x16x32_bf16 v[48:51], v[112:115], a[68:71], v[48:51]
    ds_read_b64_tr_b16 v[140:141], v147 offset:12288
    v_mfma_f32_16x16x32_bf16 v[52:55], v[116:119], a[68:71], v[52:55]
    ds_read_b64_tr_b16 v[142:143], v147 offset:14336
    v_mfma_f32_16x16x32_bf16 v[56:59], v[120:123], a[68:71], v[56:59]
    buffer_load_dwordx4 a[48:51], v149, s[8:11], s41 offen offset:1024
    v_mfma_f32_16x16x32_bf16 v[60:63], v[124:127], a[68:71], v[60:63]
    buffer_load_dwordx4 a[52:55], v149, s[8:11], s41 offen offset:2048
    s_add_u32 m0, s29, 4096
    s_add_u32 s42, s47, 1032192
    s_add_u32 s43, s47, 1040384
    s_add_u32 s44, s47, 1048576
    s_add_u32 s45, s47, 1056768
    v_mfma_f32_16x16x32_bf16 v[64:67], v[112:115], a[72:75], v[64:67]
    buffer_load_dwordx4 v148, s[12:15], s42 offen lds
    v_mfma_f32_16x16x32_bf16 v[68:71], v[116:119], a[72:75], v[68:71]
    buffer_load_dwordx4 v148, s[12:15], s43 offen offset:1024 lds
    v_mfma_f32_16x16x32_bf16 v[72:75], v[120:123], a[72:75], v[72:75]
    buffer_load_dwordx4 v148, s[12:15], s44 offen offset:2048 lds
    v_mfma_f32_16x16x32_bf16 v[76:79], v[124:127], a[72:75], v[76:79]
    buffer_load_dwordx4 v148, s[12:15], s45 offen offset:3072 lds
    v_mfma_f32_16x16x32_bf16 v[80:83], v[112:115], a[76:79], v[80:83]
    v_mfma_f32_16x16x32_bf16 v[84:87], v[116:119], a[76:79], v[84:87]
    v_mfma_f32_16x16x32_bf16 v[88:91], v[120:123], a[76:79], v[88:91]
    v_mfma_f32_16x16x32_bf16 v[92:95], v[124:127], a[76:79], v[92:95]
    v_mfma_f32_16x16x32_bf16 v[96:99], v[112:115], a[80:83], v[96:99]
    v_mfma_f32_16x16x32_bf16 v[100:103], v[116:119], a[80:83], v[100:103]
    v_mfma_f32_16x16x32_bf16 v[104:107], v[120:123], a[80:83], v[104:107]
    s_waitcnt lgkmcnt(0)
    s_waitcnt vmcnt(26)
    s_add_u32 s40, s46, 2359296
    v_mfma_f32_16x16x32_bf16 v[108:111], v[124:127], a[80:83], v[108:111]
    s_add_u32 s41, s46, 2363392
    v_mfma_f32_16x16x32_bf16 v[0:3], v[128:131], a[84:87], v[0:3]
    v_mfma_f32_16x16x32_bf16 v[4:7], v[132:135], a[84:87], v[4:7]
    buffer_load_dwordx4 a[56:59], v149, s[8:11], s40 offen
    v_mfma_f32_16x16x32_bf16 v[8:11], v[136:139], a[84:87], v[8:11]
    buffer_load_dwordx4 a[60:63], v149, s[8:11], s40 offen offset:1024
    v_mfma_f32_16x16x32_bf16 v[12:15], v[140:143], a[84:87], v[12:15]
    buffer_load_dwordx4 a[64:67], v149, s[8:11], s40 offen offset:2048
    v_mfma_f32_16x16x32_bf16 v[16:19], v[128:131], a[88:91], v[16:19]
    buffer_load_dwordx4 a[68:71], v149, s[8:11], s40 offen offset:3072
    v_mfma_f32_16x16x32_bf16 v[20:23], v[132:135], a[88:91], v[20:23]
    ds_read_b64_tr_b16 v[112:113], v144 offset:16384
    v_mfma_f32_16x16x32_bf16 v[24:27], v[136:139], a[88:91], v[24:27]
    ds_read_b64_tr_b16 v[114:115], v144 offset:18432
    v_mfma_f32_16x16x32_bf16 v[28:31], v[140:143], a[88:91], v[28:31]
    ds_read_b64_tr_b16 v[116:117], v145 offset:16384
    v_mfma_f32_16x16x32_bf16 v[32:35], v[128:131], a[92:95], v[32:35]
    ds_read_b64_tr_b16 v[118:119], v145 offset:18432
    v_mfma_f32_16x16x32_bf16 v[36:39], v[132:135], a[92:95], v[36:39]
    ds_read_b64_tr_b16 v[120:121], v146 offset:16384
    v_mfma_f32_16x16x32_bf16 v[40:43], v[136:139], a[92:95], v[40:43]
    buffer_load_dwordx4 a[72:75], v149, s[8:11], s41 offen
    v_mfma_f32_16x16x32_bf16 v[44:47], v[140:143], a[92:95], v[44:47]
    ds_read_b64_tr_b16 v[122:123], v146 offset:18432
    v_mfma_f32_16x16x32_bf16 v[48:51], v[128:131], a[96:99], v[48:51]
    ds_read_b64_tr_b16 v[124:125], v147 offset:16384
    v_mfma_f32_16x16x32_bf16 v[52:55], v[132:135], a[96:99], v[52:55]
    ds_read_b64_tr_b16 v[126:127], v147 offset:18432
    v_mfma_f32_16x16x32_bf16 v[56:59], v[136:139], a[96:99], v[56:59]
    buffer_load_dwordx4 a[76:79], v149, s[8:11], s41 offen offset:1024
    v_mfma_f32_16x16x32_bf16 v[60:63], v[140:143], a[96:99], v[60:63]
    buffer_load_dwordx4 a[80:83], v149, s[8:11], s41 offen offset:2048
    s_add_u32 m0, s29, 8192
    s_add_u32 s42, s47, 1179648
    s_add_u32 s43, s47, 1187840
    s_add_u32 s44, s47, 1196032
    s_add_u32 s45, s47, 1204224
    v_mfma_f32_16x16x32_bf16 v[64:67], v[128:131], a[100:103], v[64:67]
    buffer_load_dwordx4 v148, s[12:15], s42 offen lds
    v_mfma_f32_16x16x32_bf16 v[68:71], v[132:135], a[100:103], v[68:71]
    buffer_load_dwordx4 v148, s[12:15], s43 offen offset:1024 lds
    v_mfma_f32_16x16x32_bf16 v[72:75], v[136:139], a[100:103], v[72:75]
    buffer_load_dwordx4 v148, s[12:15], s44 offen offset:2048 lds
    v_mfma_f32_16x16x32_bf16 v[76:79], v[140:143], a[100:103], v[76:79]
    buffer_load_dwordx4 v148, s[12:15], s45 offen offset:3072 lds
    v_mfma_f32_16x16x32_bf16 v[80:83], v[128:131], a[104:107], v[80:83]
    v_mfma_f32_16x16x32_bf16 v[84:87], v[132:135], a[104:107], v[84:87]
    v_mfma_f32_16x16x32_bf16 v[88:91], v[136:139], a[104:107], v[88:91]
    v_mfma_f32_16x16x32_bf16 v[92:95], v[140:143], a[104:107], v[92:95]
    v_mfma_f32_16x16x32_bf16 v[96:99], v[128:131], a[108:111], v[96:99]
    v_mfma_f32_16x16x32_bf16 v[100:103], v[132:135], a[108:111], v[100:103]
    v_mfma_f32_16x16x32_bf16 v[104:107], v[136:139], a[108:111], v[104:107]
    s_waitcnt lgkmcnt(0)
    s_waitcnt vmcnt(26)
    s_add_u32 s40, s46, 2752512
    v_mfma_f32_16x16x32_bf16 v[108:111], v[140:143], a[108:111], v[108:111]
    s_add_u32 s41, s46, 2756608
    v_mfma_f32_16x16x32_bf16 v[0:3], v[112:115], a[0:3], v[0:3]
    v_mfma_f32_16x16x32_bf16 v[4:7], v[116:119], a[0:3], v[4:7]
    buffer_load_dwordx4 a[84:87], v149, s[8:11], s40 offen
    v_mfma_f32_16x16x32_bf16 v[8:11], v[120:123], a[0:3], v[8:11]
    buffer_load_dwordx4 a[88:91], v149, s[8:11], s40 offen offset:1024
    v_mfma_f32_16x16x32_bf16 v[12:15], v[124:127], a[0:3], v[12:15]
    buffer_load_dwordx4 a[92:95], v149, s[8:11], s40 offen offset:2048
    v_mfma_f32_16x16x32_bf16 v[16:19], v[112:115], a[4:7], v[16:19]
    buffer_load_dwordx4 a[96:99], v149, s[8:11], s40 offen offset:3072
    v_mfma_f32_16x16x32_bf16 v[20:23], v[116:119], a[4:7], v[20:23]
    ds_read_b64_tr_b16 v[128:129], v144 offset:20480
    v_mfma_f32_16x16x32_bf16 v[24:27], v[120:123], a[4:7], v[24:27]
    ds_read_b64_tr_b16 v[130:131], v144 offset:22528
    v_mfma_f32_16x16x32_bf16 v[28:31], v[124:127], a[4:7], v[28:31]
    ds_read_b64_tr_b16 v[132:133], v145 offset:20480
    v_mfma_f32_16x16x32_bf16 v[32:35], v[112:115], a[8:11], v[32:35]
    ds_read_b64_tr_b16 v[134:135], v145 offset:22528
    v_mfma_f32_16x16x32_bf16 v[36:39], v[116:119], a[8:11], v[36:39]
    ds_read_b64_tr_b16 v[136:137], v146 offset:20480
    v_mfma_f32_16x16x32_bf16 v[40:43], v[120:123], a[8:11], v[40:43]
    buffer_load_dwordx4 a[100:103], v149, s[8:11], s41 offen
    v_mfma_f32_16x16x32_bf16 v[44:47], v[124:127], a[8:11], v[44:47]
    ds_read_b64_tr_b16 v[138:139], v146 offset:22528
    v_mfma_f32_16x16x32_bf16 v[48:51], v[112:115], a[12:15], v[48:51]
    ds_read_b64_tr_b16 v[140:141], v147 offset:20480
    v_mfma_f32_16x16x32_bf16 v[52:55], v[116:119], a[12:15], v[52:55]
    ds_read_b64_tr_b16 v[142:143], v147 offset:22528
    v_mfma_f32_16x16x32_bf16 v[56:59], v[120:123], a[12:15], v[56:59]
    buffer_load_dwordx4 a[104:107], v149, s[8:11], s41 offen offset:1024
    v_mfma_f32_16x16x32_bf16 v[60:63], v[124:127], a[12:15], v[60:63]
    buffer_load_dwordx4 a[108:111], v149, s[8:11], s41 offen offset:2048
    s_add_u32 m0, s29, 12288
    s_add_u32 s42, s47, 1327104
    s_add_u32 s43, s47, 1335296
    s_add_u32 s44, s47, 1343488
    s_add_u32 s45, s47, 1351680
    v_mfma_f32_16x16x32_bf16 v[64:67], v[112:115], a[16:19], v[64:67]
    buffer_load_dwordx4 v148, s[12:15], s42 offen lds
    v_mfma_f32_16x16x32_bf16 v[68:71], v[116:119], a[16:19], v[68:71]
    buffer_load_dwordx4 v148, s[12:15], s43 offen offset:1024 lds
    v_mfma_f32_16x16x32_bf16 v[72:75], v[120:123], a[16:19], v[72:75]
    buffer_load_dwordx4 v148, s[12:15], s44 offen offset:2048 lds
    v_mfma_f32_16x16x32_bf16 v[76:79], v[124:127], a[16:19], v[76:79]
    buffer_load_dwordx4 v148, s[12:15], s45 offen offset:3072 lds
    v_mfma_f32_16x16x32_bf16 v[80:83], v[112:115], a[20:23], v[80:83]
    v_mfma_f32_16x16x32_bf16 v[84:87], v[116:119], a[20:23], v[84:87]
    v_mfma_f32_16x16x32_bf16 v[88:91], v[120:123], a[20:23], v[88:91]
    v_mfma_f32_16x16x32_bf16 v[92:95], v[124:127], a[20:23], v[92:95]
    v_mfma_f32_16x16x32_bf16 v[96:99], v[112:115], a[24:27], v[96:99]
    v_mfma_f32_16x16x32_bf16 v[100:103], v[116:119], a[24:27], v[100:103]
    v_mfma_f32_16x16x32_bf16 v[104:107], v[120:123], a[24:27], v[104:107]
    s_waitcnt lgkmcnt(0)
    s_waitcnt vmcnt(26)
    s_add_u32 s40, s46, 3145728
    v_mfma_f32_16x16x32_bf16 v[108:111], v[124:127], a[24:27], v[108:111]
    s_add_u32 s41, s46, 3149824
    v_mfma_f32_16x16x32_bf16 v[0:3], v[128:131], a[28:31], v[0:3]
    v_mfma_f32_16x16x32_bf16 v[4:7], v[132:135], a[28:31], v[4:7]
    buffer_load_dwordx4 a[0:3], v149, s[8:11], s40 offen
    v_mfma_f32_16x16x32_bf16 v[8:11], v[136:139], a[28:31], v[8:11]
    buffer_load_dwordx4 a[4:7], v149, s[8:11], s40 offen offset:1024
    v_mfma_f32_16x16x32_bf16 v[12:15], v[140:143], a[28:31], v[12:15]
    buffer_load_dwordx4 a[8:11], v149, s[8:11], s40 offen offset:2048
    v_mfma_f32_16x16x32_bf16 v[16:19], v[128:131], a[32:35], v[16:19]
    buffer_load_dwordx4 a[12:15], v149, s[8:11], s40 offen offset:3072
    v_mfma_f32_16x16x32_bf16 v[20:23], v[132:135], a[32:35], v[20:23]
    ds_read_b64_tr_b16 v[112:113], v144
    v_mfma_f32_16x16x32_bf16 v[24:27], v[136:139], a[32:35], v[24:27]
    ds_read_b64_tr_b16 v[114:115], v144 offset:2048
    v_mfma_f32_16x16x32_bf16 v[28:31], v[140:143], a[32:35], v[28:31]
    ds_read_b64_tr_b16 v[116:117], v145
    v_mfma_f32_16x16x32_bf16 v[32:35], v[128:131], a[36:39], v[32:35]
    ds_read_b64_tr_b16 v[118:119], v145 offset:2048
    v_mfma_f32_16x16x32_bf16 v[36:39], v[132:135], a[36:39], v[36:39]
    ds_read_b64_tr_b16 v[120:121], v146
    v_mfma_f32_16x16x32_bf16 v[40:43], v[136:139], a[36:39], v[40:43]
    buffer_load_dwordx4 a[16:19], v149, s[8:11], s41 offen
    v_mfma_f32_16x16x32_bf16 v[44:47], v[140:143], a[36:39], v[44:47]
    ds_read_b64_tr_b16 v[122:123], v146 offset:2048
    v_mfma_f32_16x16x32_bf16 v[48:51], v[128:131], a[40:43], v[48:51]
    ds_read_b64_tr_b16 v[124:125], v147
    v_mfma_f32_16x16x32_bf16 v[52:55], v[132:135], a[40:43], v[52:55]
    ds_read_b64_tr_b16 v[126:127], v147 offset:2048
    v_mfma_f32_16x16x32_bf16 v[56:59], v[136:139], a[40:43], v[56:59]
    buffer_load_dwordx4 a[20:23], v149, s[8:11], s41 offen offset:1024
    v_mfma_f32_16x16x32_bf16 v[60:63], v[140:143], a[40:43], v[60:63]
    buffer_load_dwordx4 a[24:27], v149, s[8:11], s41 offen offset:2048
    s_add_u32 m0, s29, 16384
    s_add_u32 s42, s47, 1474560
    s_add_u32 s43, s47, 1482752
    s_add_u32 s44, s47, 1490944
    s_add_u32 s45, s47, 1499136
    v_mfma_f32_16x16x32_bf16 v[64:67], v[128:131], a[44:47], v[64:67]
    buffer_load_dwordx4 v148, s[12:15], s42 offen lds
    v_mfma_f32_16x16x32_bf16 v[68:71], v[132:135], a[44:47], v[68:71]
    buffer_load_dwordx4 v148, s[12:15], s43 offen offset:1024 lds
    v_mfma_f32_16x16x32_bf16 v[72:75], v[136:139], a[44:47], v[72:75]
    buffer_load_dwordx4 v148, s[12:15], s44 offen offset:2048 lds
    v_mfma_f32_16x16x32_bf16 v[76:79], v[140:143], a[44:47], v[76:79]
    buffer_load_dwordx4 v148, s[12:15], s45 offen offset:3072 lds
    v_mfma_f32_16x16x32_bf16 v[80:83], v[128:131], a[48:51], v[80:83]
    v_mfma_f32_16x16x32_bf16 v[84:87], v[132:135], a[48:51], v[84:87]
    v_mfma_f32_16x16x32_bf16 v[88:91], v[136:139], a[48:51], v[88:91]
    v_mfma_f32_16x16x32_bf16 v[92:95], v[140:143], a[48:51], v[92:95]
    v_mfma_f32_16x16x32_bf16 v[96:99], v[128:131], a[52:55], v[96:99]
    v_mfma_f32_16x16x32_bf16 v[100:103], v[132:135], a[52:55], v[100:103]
    v_mfma_f32_16x16x32_bf16 v[104:107], v[136:139], a[52:55], v[104:107]
    s_waitcnt lgkmcnt(0)
    s_waitcnt vmcnt(26)
    s_add_u32 s40, s46, 3538944
    v_mfma_f32_16x16x32_bf16 v[108:111], v[140:143], a[52:55], v[108:111]
    s_add_u32 s41, s46, 3543040
    v_mfma_f32_16x16x32_bf16 v[0:3], v[112:115], a[56:59], v[0:3]
    v_mfma_f32_16x16x32_bf16 v[4:7], v[116:119], a[56:59], v[4:7]
    buffer_load_dwordx4 a[28:31], v149, s[8:11], s40 offen
    v_mfma_f32_16x16x32_bf16 v[8:11], v[120:123], a[56:59], v[8:11]
    buffer_load_dwordx4 a[32:35], v149, s[8:11], s40 offen offset:1024
    v_mfma_f32_16x16x32_bf16 v[12:15], v[124:127], a[56:59], v[12:15]
    buffer_load_dwordx4 a[36:39], v149, s[8:11], s40 offen offset:2048
    v_mfma_f32_16x16x32_bf16 v[16:19], v[112:115], a[60:63], v[16:19]
    buffer_load_dwordx4 a[40:43], v149, s[8:11], s40 offen offset:3072
    v_mfma_f32_16x16x32_bf16 v[20:23], v[116:119], a[60:63], v[20:23]
    ds_read_b64_tr_b16 v[128:129], v144 offset:4096
    v_mfma_f32_16x16x32_bf16 v[24:27], v[120:123], a[60:63], v[24:27]
    ds_read_b64_tr_b16 v[130:131], v144 offset:6144
    v_mfma_f32_16x16x32_bf16 v[28:31], v[124:127], a[60:63], v[28:31]
    ds_read_b64_tr_b16 v[132:133], v145 offset:4096
    v_mfma_f32_16x16x32_bf16 v[32:35], v[112:115], a[64:67], v[32:35]
    ds_read_b64_tr_b16 v[134:135], v145 offset:6144
    v_mfma_f32_16x16x32_bf16 v[36:39], v[116:119], a[64:67], v[36:39]
    ds_read_b64_tr_b16 v[136:137], v146 offset:4096
    v_mfma_f32_16x16x32_bf16 v[40:43], v[120:123], a[64:67], v[40:43]
    buffer_load_dwordx4 a[44:47], v149, s[8:11], s41 offen
    v_mfma_f32_16x16x32_bf16 v[44:47], v[124:127], a[64:67], v[44:47]
    ds_read_b64_tr_b16 v[138:139], v146 offset:6144
    v_mfma_f32_16x16x32_bf16 v[48:51], v[112:115], a[68:71], v[48:51]
    ds_read_b64_tr_b16 v[140:141], v147 offset:4096
    v_mfma_f32_16x16x32_bf16 v[52:55], v[116:119], a[68:71], v[52:55]
    ds_read_b64_tr_b16 v[142:143], v147 offset:6144
    v_mfma_f32_16x16x32_bf16 v[56:59], v[120:123], a[68:71], v[56:59]
    buffer_load_dwordx4 a[48:51], v149, s[8:11], s41 offen offset:1024
    v_mfma_f32_16x16x32_bf16 v[60:63], v[124:127], a[68:71], v[60:63]
    buffer_load_dwordx4 a[52:55], v149, s[8:11], s41 offen offset:2048
    s_add_u32 m0, s29, 20480
    s_add_u32 s42, s47, 1622016
    s_add_u32 s43, s47, 1630208
    s_add_u32 s44, s47, 1638400
    s_add_u32 s45, s47, 1646592
    v_mfma_f32_16x16x32_bf16 v[64:67], v[112:115], a[72:75], v[64:67]
    buffer_load_dwordx4 v148, s[12:15], s42 offen lds
    v_mfma_f32_16x16x32_bf16 v[68:71], v[116:119], a[72:75], v[68:71]
    buffer_load_dwordx4 v148, s[12:15], s43 offen offset:1024 lds
    v_mfma_f32_16x16x32_bf16 v[72:75], v[120:123], a[72:75], v[72:75]
    buffer_load_dwordx4 v148, s[12:15], s44 offen offset:2048 lds
    v_mfma_f32_16x16x32_bf16 v[76:79], v[124:127], a[72:75], v[76:79]
    buffer_load_dwordx4 v148, s[12:15], s45 offen offset:3072 lds
    v_mfma_f32_16x16x32_bf16 v[80:83], v[112:115], a[76:79], v[80:83]
    v_mfma_f32_16x16x32_bf16 v[84:87], v[116:119], a[76:79], v[84:87]
    v_mfma_f32_16x16x32_bf16 v[88:91], v[120:123], a[76:79], v[88:91]
    v_mfma_f32_16x16x32_bf16 v[92:95], v[124:127], a[76:79], v[92:95]
    v_mfma_f32_16x16x32_bf16 v[96:99], v[112:115], a[80:83], v[96:99]
    v_mfma_f32_16x16x32_bf16 v[100:103], v[116:119], a[80:83], v[100:103]
    v_mfma_f32_16x16x32_bf16 v[104:107], v[120:123], a[80:83], v[104:107]
    s_waitcnt lgkmcnt(0)
    s_waitcnt vmcnt(26)
    s_add_u32 s40, s46, 3932160
    v_mfma_f32_16x16x32_bf16 v[108:111], v[124:127], a[80:83], v[108:111]
    s_add_u32 s41, s46, 3936256
    v_mfma_f32_16x16x32_bf16 v[0:3], v[128:131], a[84:87], v[0:3]
    v_mfma_f32_16x16x32_bf16 v[4:7], v[132:135], a[84:87], v[4:7]
    buffer_load_dwordx4 a[56:59], v149, s[8:11], s40 offen
    v_mfma_f32_16x16x32_bf16 v[8:11], v[136:139], a[84:87], v[8:11]
    buffer_load_dwordx4 a[60:63], v149, s[8:11], s40 offen offset:1024
    v_mfma_f32_16x16x32_bf16 v[12:15], v[140:143], a[84:87], v[12:15]
    buffer_load_dwordx4 a[64:67], v149, s[8:11], s40 offen offset:2048
    v_mfma_f32_16x16x32_bf16 v[16:19], v[128:131], a[88:91], v[16:19]
    buffer_load_dwordx4 a[68:71], v149, s[8:11], s40 offen offset:3072
    v_mfma_f32_16x16x32_bf16 v[20:23], v[132:135], a[88:91], v[20:23]
    ds_read_b64_tr_b16 v[112:113], v144 offset:8192
    v_mfma_f32_16x16x32_bf16 v[24:27], v[136:139], a[88:91], v[24:27]
    ds_read_b64_tr_b16 v[114:115], v144 offset:10240
    v_mfma_f32_16x16x32_bf16 v[28:31], v[140:143], a[88:91], v[28:31]
    ds_read_b64_tr_b16 v[116:117], v145 offset:8192
    v_mfma_f32_16x16x32_bf16 v[32:35], v[128:131], a[92:95], v[32:35]
    ds_read_b64_tr_b16 v[118:119], v145 offset:10240
    v_mfma_f32_16x16x32_bf16 v[36:39], v[132:135], a[92:95], v[36:39]
    ds_read_b64_tr_b16 v[120:121], v146 offset:8192
    v_mfma_f32_16x16x32_bf16 v[40:43], v[136:139], a[92:95], v[40:43]
    buffer_load_dwordx4 a[72:75], v149, s[8:11], s41 offen
    v_mfma_f32_16x16x32_bf16 v[44:47], v[140:143], a[92:95], v[44:47]
    ds_read_b64_tr_b16 v[122:123], v146 offset:10240
    v_mfma_f32_16x16x32_bf16 v[48:51], v[128:131], a[96:99], v[48:51]
    ds_read_b64_tr_b16 v[124:125], v147 offset:8192
    v_mfma_f32_16x16x32_bf16 v[52:55], v[132:135], a[96:99], v[52:55]
    ds_read_b64_tr_b16 v[126:127], v147 offset:10240
    v_mfma_f32_16x16x32_bf16 v[56:59], v[136:139], a[96:99], v[56:59]
    buffer_load_dwordx4 a[76:79], v149, s[8:11], s41 offen offset:1024
    v_mfma_f32_16x16x32_bf16 v[60:63], v[140:143], a[96:99], v[60:63]
    buffer_load_dwordx4 a[80:83], v149, s[8:11], s41 offen offset:2048
    s_add_u32 m0, s29, 0
    s_add_u32 s42, s47, 1769472
    s_add_u32 s43, s47, 1777664
    s_add_u32 s44, s47, 1785856
    s_add_u32 s45, s47, 1794048
    v_mfma_f32_16x16x32_bf16 v[64:67], v[128:131], a[100:103], v[64:67]
    buffer_load_dwordx4 v148, s[12:15], s42 offen lds
    v_mfma_f32_16x16x32_bf16 v[68:71], v[132:135], a[100:103], v[68:71]
    buffer_load_dwordx4 v148, s[12:15], s43 offen offset:1024 lds
    v_mfma_f32_16x16x32_bf16 v[72:75], v[136:139], a[100:103], v[72:75]
    buffer_load_dwordx4 v148, s[12:15], s44 offen offset:2048 lds
    v_mfma_f32_16x16x32_bf16 v[76:79], v[140:143], a[100:103], v[76:79]
    buffer_load_dwordx4 v148, s[12:15], s45 offen offset:3072 lds
    v_mfma_f32_16x16x32_bf16 v[80:83], v[128:131], a[104:107], v[80:83]
    v_mfma_f32_16x16x32_bf16 v[84:87], v[132:135], a[104:107], v[84:87]
    v_mfma_f32_16x16x32_bf16 v[88:91], v[136:139], a[104:107], v[88:91]
    v_mfma_f32_16x16x32_bf16 v[92:95], v[140:143], a[104:107], v[92:95]
    v_mfma_f32_16x16x32_bf16 v[96:99], v[128:131], a[108:111], v[96:99]
    v_mfma_f32_16x16x32_bf16 v[100:103], v[132:135], a[108:111], v[100:103]
    v_mfma_f32_16x16x32_bf16 v[104:107], v[136:139], a[108:111], v[104:107]
    s_waitcnt lgkmcnt(0)
    s_waitcnt vmcnt(26)
    s_add_u32 s40, s46, 4325376
    v_mfma_f32_16x16x32_bf16 v[108:111], v[140:143], a[108:111], v[108:111]
    s_add_u32 s41, s46, 4329472
    v_mfma_f32_16x16x32_bf16 v[0:3], v[112:115], a[0:3], v[0:3]
    v_mfma_f32_16x16x32_bf16 v[4:7], v[116:119], a[0:3], v[4:7]
    buffer_load_dwordx4 a[84:87], v149, s[8:11], s40 offen
    v_mfma_f32_16x16x32_bf16 v[8:11], v[120:123], a[0:3], v[8:11]
    buffer_load_dwordx4 a[88:91], v149, s[8:11], s40 offen offset:1024
    v_mfma_f32_16x16x32_bf16 v[12:15], v[124:127], a[0:3], v[12:15]
    buffer_load_dwordx4 a[92:95], v149, s[8:11], s40 offen offset:2048
    v_mfma_f32_16x16x32_bf16 v[16:19], v[112:115], a[4:7], v[16:19]
    buffer_load_dwordx4 a[96:99], v149, s[8:11], s40 offen offset:3072
    v_mfma_f32_16x16x32_bf16 v[20:23], v[116:119], a[4:7], v[20:23]
    ds_read_b64_tr_b16 v[128:129], v144 offset:12288
    v_mfma_f32_16x16x32_bf16 v[24:27], v[120:123], a[4:7], v[24:27]
    ds_read_b64_tr_b16 v[130:131], v144 offset:14336
    v_mfma_f32_16x16x32_bf16 v[28:31], v[124:127], a[4:7], v[28:31]
    ds_read_b64_tr_b16 v[132:133], v145 offset:12288
    v_mfma_f32_16x16x32_bf16 v[32:35], v[112:115], a[8:11], v[32:35]
    ds_read_b64_tr_b16 v[134:135], v145 offset:14336
    v_mfma_f32_16x16x32_bf16 v[36:39], v[116:119], a[8:11], v[36:39]
    ds_read_b64_tr_b16 v[136:137], v146 offset:12288
    v_mfma_f32_16x16x32_bf16 v[40:43], v[120:123], a[8:11], v[40:43]
    buffer_load_dwordx4 a[100:103], v149, s[8:11], s41 offen
    v_mfma_f32_16x16x32_bf16 v[44:47], v[124:127], a[8:11], v[44:47]
    ds_read_b64_tr_b16 v[138:139], v146 offset:14336
    v_mfma_f32_16x16x32_bf16 v[48:51], v[112:115], a[12:15], v[48:51]
    ds_read_b64_tr_b16 v[140:141], v147 offset:12288
    v_mfma_f32_16x16x32_bf16 v[52:55], v[116:119], a[12:15], v[52:55]
    ds_read_b64_tr_b16 v[142:143], v147 offset:14336
    v_mfma_f32_16x16x32_bf16 v[56:59], v[120:123], a[12:15], v[56:59]
    buffer_load_dwordx4 a[104:107], v149, s[8:11], s41 offen offset:1024
    v_mfma_f32_16x16x32_bf16 v[60:63], v[124:127], a[12:15], v[60:63]
    buffer_load_dwordx4 a[108:111], v149, s[8:11], s41 offen offset:2048
    s_add_u32 m0, s29, 4096
    s_add_u32 s42, s47, 1916928
    s_add_u32 s43, s47, 1925120
    s_add_u32 s44, s47, 1933312
    s_add_u32 s45, s47, 1941504
    v_mfma_f32_16x16x32_bf16 v[64:67], v[112:115], a[16:19], v[64:67]
    buffer_load_dwordx4 v148, s[12:15], s42 offen lds
    v_mfma_f32_16x16x32_bf16 v[68:71], v[116:119], a[16:19], v[68:71]
    buffer_load_dwordx4 v148, s[12:15], s43 offen offset:1024 lds
    v_mfma_f32_16x16x32_bf16 v[72:75], v[120:123], a[16:19], v[72:75]
    buffer_load_dwordx4 v148, s[12:15], s44 offen offset:2048 lds
    v_mfma_f32_16x16x32_bf16 v[76:79], v[124:127], a[16:19], v[76:79]
    buffer_load_dwordx4 v148, s[12:15], s45 offen offset:3072 lds
    v_mfma_f32_16x16x32_bf16 v[80:83], v[112:115], a[20:23], v[80:83]
    v_mfma_f32_16x16x32_bf16 v[84:87], v[116:119], a[20:23], v[84:87]
    v_mfma_f32_16x16x32_bf16 v[88:91], v[120:123], a[20:23], v[88:91]
    v_mfma_f32_16x16x32_bf16 v[92:95], v[124:127], a[20:23], v[92:95]
    v_mfma_f32_16x16x32_bf16 v[96:99], v[112:115], a[24:27], v[96:99]
    v_mfma_f32_16x16x32_bf16 v[100:103], v[116:119], a[24:27], v[100:103]
    v_mfma_f32_16x16x32_bf16 v[104:107], v[120:123], a[24:27], v[104:107]
    s_waitcnt lgkmcnt(0)
    s_waitcnt vmcnt(26)
    s_add_u32 s40, s46, 4718592
    v_mfma_f32_16x16x32_bf16 v[108:111], v[124:127], a[24:27], v[108:111]
    s_add_u32 s41, s46, 4722688
    v_mfma_f32_16x16x32_bf16 v[0:3], v[128:131], a[28:31], v[0:3]
    v_mfma_f32_16x16x32_bf16 v[4:7], v[132:135], a[28:31], v[4:7]
    buffer_load_dwordx4 a[0:3], v149, s[8:11], s40 offen
    v_mfma_f32_16x16x32_bf16 v[8:11], v[136:139], a[28:31], v[8:11]
    buffer_load_dwordx4 a[4:7], v149, s[8:11], s40 offen offset:1024
    v_mfma_f32_16x16x32_bf16 v[12:15], v[140:143], a[28:31], v[12:15]
    buffer_load_dwordx4 a[8:11], v149, s[8:11], s40 offen offset:2048
    v_mfma_f32_16x16x32_bf16 v[16:19], v[128:131], a[32:35], v[16:19]
    buffer_load_dwordx4 a[12:15], v149, s[8:11], s40 offen offset:3072
    v_mfma_f32_16x16x32_bf16 v[20:23], v[132:135], a[32:35], v[20:23]
    ds_read_b64_tr_b16 v[112:113], v144 offset:16384
    v_mfma_f32_16x16x32_bf16 v[24:27], v[136:139], a[32:35], v[24:27]
    ds_read_b64_tr_b16 v[114:115], v144 offset:18432
    v_mfma_f32_16x16x32_bf16 v[28:31], v[140:143], a[32:35], v[28:31]
    ds_read_b64_tr_b16 v[116:117], v145 offset:16384
    v_mfma_f32_16x16x32_bf16 v[32:35], v[128:131], a[36:39], v[32:35]
    ds_read_b64_tr_b16 v[118:119], v145 offset:18432
    v_mfma_f32_16x16x32_bf16 v[36:39], v[132:135], a[36:39], v[36:39]
    ds_read_b64_tr_b16 v[120:121], v146 offset:16384
    v_mfma_f32_16x16x32_bf16 v[40:43], v[136:139], a[36:39], v[40:43]
    buffer_load_dwordx4 a[16:19], v149, s[8:11], s41 offen
    v_mfma_f32_16x16x32_bf16 v[44:47], v[140:143], a[36:39], v[44:47]
    ds_read_b64_tr_b16 v[122:123], v146 offset:18432
    v_mfma_f32_16x16x32_bf16 v[48:51], v[128:131], a[40:43], v[48:51]
    ds_read_b64_tr_b16 v[124:125], v147 offset:16384
    v_mfma_f32_16x16x32_bf16 v[52:55], v[132:135], a[40:43], v[52:55]
    ds_read_b64_tr_b16 v[126:127], v147 offset:18432
    v_mfma_f32_16x16x32_bf16 v[56:59], v[136:139], a[40:43], v[56:59]
    buffer_load_dwordx4 a[20:23], v149, s[8:11], s41 offen offset:1024
    v_mfma_f32_16x16x32_bf16 v[60:63], v[140:143], a[40:43], v[60:63]
    buffer_load_dwordx4 a[24:27], v149, s[8:11], s41 offen offset:2048
    s_add_u32 m0, s29, 8192
    s_add_u32 s42, s47, 2064384
    s_add_u32 s43, s47, 2072576
    s_add_u32 s44, s47, 2080768
    s_add_u32 s45, s47, 2088960
    v_mfma_f32_16x16x32_bf16 v[64:67], v[128:131], a[44:47], v[64:67]
    buffer_load_dwordx4 v148, s[12:15], s42 offen lds
    v_mfma_f32_16x16x32_bf16 v[68:71], v[132:135], a[44:47], v[68:71]
    buffer_load_dwordx4 v148, s[12:15], s43 offen offset:1024 lds
    v_mfma_f32_16x16x32_bf16 v[72:75], v[136:139], a[44:47], v[72:75]
    buffer_load_dwordx4 v148, s[12:15], s44 offen offset:2048 lds
    v_mfma_f32_16x16x32_bf16 v[76:79], v[140:143], a[44:47], v[76:79]
    buffer_load_dwordx4 v148, s[12:15], s45 offen offset:3072 lds
    v_mfma_f32_16x16x32_bf16 v[80:83], v[128:131], a[48:51], v[80:83]
    v_mfma_f32_16x16x32_bf16 v[84:87], v[132:135], a[48:51], v[84:87]
    v_mfma_f32_16x16x32_bf16 v[88:91], v[136:139], a[48:51], v[88:91]
    v_mfma_f32_16x16x32_bf16 v[92:95], v[140:143], a[48:51], v[92:95]
    v_mfma_f32_16x16x32_bf16 v[96:99], v[128:131], a[52:55], v[96:99]
    v_mfma_f32_16x16x32_bf16 v[100:103], v[132:135], a[52:55], v[100:103]
    v_mfma_f32_16x16x32_bf16 v[104:107], v[136:139], a[52:55], v[104:107]
    s_waitcnt lgkmcnt(0)
    s_waitcnt vmcnt(26)
    s_add_u32 s40, s46, 5111808
    v_mfma_f32_16x16x32_bf16 v[108:111], v[140:143], a[52:55], v[108:111]
    s_add_u32 s41, s46, 5115904
    v_mfma_f32_16x16x32_bf16 v[0:3], v[112:115], a[56:59], v[0:3]
    v_mfma_f32_16x16x32_bf16 v[4:7], v[116:119], a[56:59], v[4:7]
    buffer_load_dwordx4 a[28:31], v149, s[8:11], s40 offen
    v_mfma_f32_16x16x32_bf16 v[8:11], v[120:123], a[56:59], v[8:11]
    buffer_load_dwordx4 a[32:35], v149, s[8:11], s40 offen offset:1024
    v_mfma_f32_16x16x32_bf16 v[12:15], v[124:127], a[56:59], v[12:15]
    buffer_load_dwordx4 a[36:39], v149, s[8:11], s40 offen offset:2048
    v_mfma_f32_16x16x32_bf16 v[16:19], v[112:115], a[60:63], v[16:19]
    buffer_load_dwordx4 a[40:43], v149, s[8:11], s40 offen offset:3072
    v_mfma_f32_16x16x32_bf16 v[20:23], v[116:119], a[60:63], v[20:23]
    ds_read_b64_tr_b16 v[128:129], v144 offset:20480
    v_mfma_f32_16x16x32_bf16 v[24:27], v[120:123], a[60:63], v[24:27]
    ds_read_b64_tr_b16 v[130:131], v144 offset:22528
    v_mfma_f32_16x16x32_bf16 v[28:31], v[124:127], a[60:63], v[28:31]
    ds_read_b64_tr_b16 v[132:133], v145 offset:20480
    v_mfma_f32_16x16x32_bf16 v[32:35], v[112:115], a[64:67], v[32:35]
    ds_read_b64_tr_b16 v[134:135], v145 offset:22528
    v_mfma_f32_16x16x32_bf16 v[36:39], v[116:119], a[64:67], v[36:39]
    ds_read_b64_tr_b16 v[136:137], v146 offset:20480
    v_mfma_f32_16x16x32_bf16 v[40:43], v[120:123], a[64:67], v[40:43]
    buffer_load_dwordx4 a[44:47], v149, s[8:11], s41 offen
    v_mfma_f32_16x16x32_bf16 v[44:47], v[124:127], a[64:67], v[44:47]
    ds_read_b64_tr_b16 v[138:139], v146 offset:22528
    v_mfma_f32_16x16x32_bf16 v[48:51], v[112:115], a[68:71], v[48:51]
    ds_read_b64_tr_b16 v[140:141], v147 offset:20480
    v_mfma_f32_16x16x32_bf16 v[52:55], v[116:119], a[68:71], v[52:55]
    ds_read_b64_tr_b16 v[142:143], v147 offset:22528
    v_mfma_f32_16x16x32_bf16 v[56:59], v[120:123], a[68:71], v[56:59]
    buffer_load_dwordx4 a[48:51], v149, s[8:11], s41 offen offset:1024
    v_mfma_f32_16x16x32_bf16 v[60:63], v[124:127], a[68:71], v[60:63]
    buffer_load_dwordx4 a[52:55], v149, s[8:11], s41 offen offset:2048
    s_add_u32 m0, s29, 12288
    s_add_u32 s42, s47, 2211840
    s_add_u32 s43, s47, 2220032
    s_add_u32 s44, s47, 2228224
    s_add_u32 s45, s47, 2236416
    v_mfma_f32_16x16x32_bf16 v[64:67], v[112:115], a[72:75], v[64:67]
    buffer_load_dwordx4 v148, s[12:15], s42 offen lds
    v_mfma_f32_16x16x32_bf16 v[68:71], v[116:119], a[72:75], v[68:71]
    buffer_load_dwordx4 v148, s[12:15], s43 offen offset:1024 lds
    v_mfma_f32_16x16x32_bf16 v[72:75], v[120:123], a[72:75], v[72:75]
    buffer_load_dwordx4 v148, s[12:15], s44 offen offset:2048 lds
    v_mfma_f32_16x16x32_bf16 v[76:79], v[124:127], a[72:75], v[76:79]
    buffer_load_dwordx4 v148, s[12:15], s45 offen offset:3072 lds
    v_mfma_f32_16x16x32_bf16 v[80:83], v[112:115], a[76:79], v[80:83]
    v_mfma_f32_16x16x32_bf16 v[84:87], v[116:119], a[76:79], v[84:87]
    v_mfma_f32_16x16x32_bf16 v[88:91], v[120:123], a[76:79], v[88:91]
    v_mfma_f32_16x16x32_bf16 v[92:95], v[124:127], a[76:79], v[92:95]
    v_mfma_f32_16x16x32_bf16 v[96:99], v[112:115], a[80:83], v[96:99]
    v_mfma_f32_16x16x32_bf16 v[100:103], v[116:119], a[80:83], v[100:103]
    v_mfma_f32_16x16x32_bf16 v[104:107], v[120:123], a[80:83], v[104:107]
    s_waitcnt lgkmcnt(0)
    s_waitcnt vmcnt(26)
    s_add_u32 s40, s46, 5505024
    v_mfma_f32_16x16x32_bf16 v[108:111], v[124:127], a[80:83], v[108:111]
    s_add_u32 s41, s46, 5509120
    v_mfma_f32_16x16x32_bf16 v[0:3], v[128:131], a[84:87], v[0:3]
    v_mfma_f32_16x16x32_bf16 v[4:7], v[132:135], a[84:87], v[4:7]
    buffer_load_dwordx4 a[56:59], v149, s[8:11], s40 offen
    v_mfma_f32_16x16x32_bf16 v[8:11], v[136:139], a[84:87], v[8:11]
    buffer_load_dwordx4 a[60:63], v149, s[8:11], s40 offen offset:1024
    v_mfma_f32_16x16x32_bf16 v[12:15], v[140:143], a[84:87], v[12:15]
    buffer_load_dwordx4 a[64:67], v149, s[8:11], s40 offen offset:2048
    v_mfma_f32_16x16x32_bf16 v[16:19], v[128:131], a[88:91], v[16:19]
    buffer_load_dwordx4 a[68:71], v149, s[8:11], s40 offen offset:3072
    v_mfma_f32_16x16x32_bf16 v[20:23], v[132:135], a[88:91], v[20:23]
    ds_read_b64_tr_b16 v[112:113], v144
    v_mfma_f32_16x16x32_bf16 v[24:27], v[136:139], a[88:91], v[24:27]
    ds_read_b64_tr_b16 v[114:115], v144 offset:2048
    v_mfma_f32_16x16x32_bf16 v[28:31], v[140:143], a[88:91], v[28:31]
    ds_read_b64_tr_b16 v[116:117], v145
    v_mfma_f32_16x16x32_bf16 v[32:35], v[128:131], a[92:95], v[32:35]
    ds_read_b64_tr_b16 v[118:119], v145 offset:2048
    v_mfma_f32_16x16x32_bf16 v[36:39], v[132:135], a[92:95], v[36:39]
    ds_read_b64_tr_b16 v[120:121], v146
    v_mfma_f32_16x16x32_bf16 v[40:43], v[136:139], a[92:95], v[40:43]
    buffer_load_dwordx4 a[72:75], v149, s[8:11], s41 offen
    v_mfma_f32_16x16x32_bf16 v[44:47], v[140:143], a[92:95], v[44:47]
    ds_read_b64_tr_b16 v[122:123], v146 offset:2048
    v_mfma_f32_16x16x32_bf16 v[48:51], v[128:131], a[96:99], v[48:51]
    ds_read_b64_tr_b16 v[124:125], v147
    v_mfma_f32_16x16x32_bf16 v[52:55], v[132:135], a[96:99], v[52:55]
    ds_read_b64_tr_b16 v[126:127], v147 offset:2048
    v_mfma_f32_16x16x32_bf16 v[56:59], v[136:139], a[96:99], v[56:59]
    buffer_load_dwordx4 a[76:79], v149, s[8:11], s41 offen offset:1024
    v_mfma_f32_16x16x32_bf16 v[60:63], v[140:143], a[96:99], v[60:63]
    buffer_load_dwordx4 a[80:83], v149, s[8:11], s41 offen offset:2048
    s_add_u32 m0, s29, 16384
    s_add_u32 s42, s47, 2359296
    s_add_u32 s43, s47, 2367488
    s_add_u32 s44, s47, 2375680
    s_add_u32 s45, s47, 2383872
    v_mfma_f32_16x16x32_bf16 v[64:67], v[128:131], a[100:103], v[64:67]
    buffer_load_dwordx4 v148, s[12:15], s42 offen lds
    v_mfma_f32_16x16x32_bf16 v[68:71], v[132:135], a[100:103], v[68:71]
    buffer_load_dwordx4 v148, s[12:15], s43 offen offset:1024 lds
    v_mfma_f32_16x16x32_bf16 v[72:75], v[136:139], a[100:103], v[72:75]
    buffer_load_dwordx4 v148, s[12:15], s44 offen offset:2048 lds
    v_mfma_f32_16x16x32_bf16 v[76:79], v[140:143], a[100:103], v[76:79]
    buffer_load_dwordx4 v148, s[12:15], s45 offen offset:3072 lds
    v_mfma_f32_16x16x32_bf16 v[80:83], v[128:131], a[104:107], v[80:83]
    v_mfma_f32_16x16x32_bf16 v[84:87], v[132:135], a[104:107], v[84:87]
    v_mfma_f32_16x16x32_bf16 v[88:91], v[136:139], a[104:107], v[88:91]
    v_mfma_f32_16x16x32_bf16 v[92:95], v[140:143], a[104:107], v[92:95]
    v_mfma_f32_16x16x32_bf16 v[96:99], v[128:131], a[108:111], v[96:99]
    v_mfma_f32_16x16x32_bf16 v[100:103], v[132:135], a[108:111], v[100:103]
    v_mfma_f32_16x16x32_bf16 v[104:107], v[136:139], a[108:111], v[104:107]
    s_waitcnt lgkmcnt(0)
    s_waitcnt vmcnt(26)
    s_add_u32 s40, s46, 5898240
    v_mfma_f32_16x16x32_bf16 v[108:111], v[140:143], a[108:111], v[108:111]
    s_add_u32 s41, s46, 5902336
    v_mfma_f32_16x16x32_bf16 v[0:3], v[112:115], a[0:3], v[0:3]
    v_mfma_f32_16x16x32_bf16 v[4:7], v[116:119], a[0:3], v[4:7]
    buffer_load_dwordx4 a[84:87], v149, s[8:11], s40 offen
    v_mfma_f32_16x16x32_bf16 v[8:11], v[120:123], a[0:3], v[8:11]
    buffer_load_dwordx4 a[88:91], v149, s[8:11], s40 offen offset:1024
    v_mfma_f32_16x16x32_bf16 v[12:15], v[124:127], a[0:3], v[12:15]
    buffer_load_dwordx4 a[92:95], v149, s[8:11], s40 offen offset:2048
    v_mfma_f32_16x16x32_bf16 v[16:19], v[112:115], a[4:7], v[16:19]
    buffer_load_dwordx4 a[96:99], v149, s[8:11], s40 offen offset:3072
    v_mfma_f32_16x16x32_bf16 v[20:23], v[116:119], a[4:7], v[20:23]
    ds_read_b64_tr_b16 v[128:129], v144 offset:4096
    v_mfma_f32_16x16x32_bf16 v[24:27], v[120:123], a[4:7], v[24:27]
    ds_read_b64_tr_b16 v[130:131], v144 offset:6144
    v_mfma_f32_16x16x32_bf16 v[28:31], v[124:127], a[4:7], v[28:31]
    ds_read_b64_tr_b16 v[132:133], v145 offset:4096
    v_mfma_f32_16x16x32_bf16 v[32:35], v[112:115], a[8:11], v[32:35]
    ds_read_b64_tr_b16 v[134:135], v145 offset:6144
    v_mfma_f32_16x16x32_bf16 v[36:39], v[116:119], a[8:11], v[36:39]
    ds_read_b64_tr_b16 v[136:137], v146 offset:4096
    v_mfma_f32_16x16x32_bf16 v[40:43], v[120:123], a[8:11], v[40:43]
    buffer_load_dwordx4 a[100:103], v149, s[8:11], s41 offen
    v_mfma_f32_16x16x32_bf16 v[44:47], v[124:127], a[8:11], v[44:47]
    ds_read_b64_tr_b16 v[138:139], v146 offset:6144
    v_mfma_f32_16x16x32_bf16 v[48:51], v[112:115], a[12:15], v[48:51]
    ds_read_b64_tr_b16 v[140:141], v147 offset:4096
    v_mfma_f32_16x16x32_bf16 v[52:55], v[116:119], a[12:15], v[52:55]
    ds_read_b64_tr_b16 v[142:143], v147 offset:6144
    v_mfma_f32_16x16x32_bf16 v[56:59], v[120:123], a[12:15], v[56:59]
    buffer_load_dwordx4 a[104:107], v149, s[8:11], s41 offen offset:1024
    v_mfma_f32_16x16x32_bf16 v[60:63], v[124:127], a[12:15], v[60:63]
    buffer_load_dwordx4 a[108:111], v149, s[8:11], s41 offen offset:2048
    s_add_u32 m0, s29, 20480
    s_add_u32 s42, s47, 2506752
    s_add_u32 s43, s47, 2514944
    s_add_u32 s44, s47, 2523136
    s_add_u32 s45, s47, 2531328
    v_mfma_f32_16x16x32_bf16 v[64:67], v[112:115], a[16:19], v[64:67]
    buffer_load_dwordx4 v148, s[12:15], s42 offen lds
    v_mfma_f32_16x16x32_bf16 v[68:71], v[116:119], a[16:19], v[68:71]
    buffer_load_dwordx4 v148, s[12:15], s43 offen offset:1024 lds
    v_mfma_f32_16x16x32_bf16 v[72:75], v[120:123], a[16:19], v[72:75]
    buffer_load_dwordx4 v148, s[12:15], s44 offen offset:2048 lds
    v_mfma_f32_16x16x32_bf16 v[76:79], v[124:127], a[16:19], v[76:79]
    buffer_load_dwordx4 v148, s[12:15], s45 offen offset:3072 lds
    v_mfma_f32_16x16x32_bf16 v[80:83], v[112:115], a[20:23], v[80:83]
    v_mfma_f32_16x16x32_bf16 v[84:87], v[116:119], a[20:23], v[84:87]
    v_mfma_f32_16x16x32_bf16 v[88:91], v[120:123], a[20:23], v[88:91]
    v_mfma_f32_16x16x32_bf16 v[92:95], v[124:127], a[20:23], v[92:95]
    v_mfma_f32_16x16x32_bf16 v[96:99], v[112:115], a[24:27], v[96:99]
    v_mfma_f32_16x16x32_bf16 v[100:103], v[116:119], a[24:27], v[100:103]
    v_mfma_f32_16x16x32_bf16 v[104:107], v[120:123], a[24:27], v[104:107]
    s_waitcnt lgkmcnt(0)
    s_waitcnt vmcnt(26)
    s_add_u32 s40, s46, 6291456
    v_mfma_f32_16x16x32_bf16 v[108:111], v[124:127], a[24:27], v[108:111]
    s_add_u32 s41, s46, 6295552
    v_mfma_f32_16x16x32_bf16 v[0:3], v[128:131], a[28:31], v[0:3]
    v_mfma_f32_16x16x32_bf16 v[4:7], v[132:135], a[28:31], v[4:7]
    buffer_load_dwordx4 a[0:3], v149, s[8:11], s40 offen
    v_mfma_f32_16x16x32_bf16 v[8:11], v[136:139], a[28:31], v[8:11]
    buffer_load_dwordx4 a[4:7], v149, s[8:11], s40 offen offset:1024
    v_mfma_f32_16x16x32_bf16 v[12:15], v[140:143], a[28:31], v[12:15]
    buffer_load_dwordx4 a[8:11], v149, s[8:11], s40 offen offset:2048
    v_mfma_f32_16x16x32_bf16 v[16:19], v[128:131], a[32:35], v[16:19]
    buffer_load_dwordx4 a[12:15], v149, s[8:11], s40 offen offset:3072
    v_mfma_f32_16x16x32_bf16 v[20:23], v[132:135], a[32:35], v[20:23]
    ds_read_b64_tr_b16 v[112:113], v144 offset:8192
    v_mfma_f32_16x16x32_bf16 v[24:27], v[136:139], a[32:35], v[24:27]
    ds_read_b64_tr_b16 v[114:115], v144 offset:10240
    v_mfma_f32_16x16x32_bf16 v[28:31], v[140:143], a[32:35], v[28:31]
    ds_read_b64_tr_b16 v[116:117], v145 offset:8192
    v_mfma_f32_16x16x32_bf16 v[32:35], v[128:131], a[36:39], v[32:35]
    ds_read_b64_tr_b16 v[118:119], v145 offset:10240
    v_mfma_f32_16x16x32_bf16 v[36:39], v[132:135], a[36:39], v[36:39]
    ds_read_b64_tr_b16 v[120:121], v146 offset:8192
    v_mfma_f32_16x16x32_bf16 v[40:43], v[136:139], a[36:39], v[40:43]
    buffer_load_dwordx4 a[16:19], v149, s[8:11], s41 offen
    v_mfma_f32_16x16x32_bf16 v[44:47], v[140:143], a[36:39], v[44:47]
    ds_read_b64_tr_b16 v[122:123], v146 offset:10240
    v_mfma_f32_16x16x32_bf16 v[48:51], v[128:131], a[40:43], v[48:51]
    ds_read_b64_tr_b16 v[124:125], v147 offset:8192
    v_mfma_f32_16x16x32_bf16 v[52:55], v[132:135], a[40:43], v[52:55]
    ds_read_b64_tr_b16 v[126:127], v147 offset:10240
    v_mfma_f32_16x16x32_bf16 v[56:59], v[136:139], a[40:43], v[56:59]
    buffer_load_dwordx4 a[20:23], v149, s[8:11], s41 offen offset:1024
    v_mfma_f32_16x16x32_bf16 v[60:63], v[140:143], a[40:43], v[60:63]
    buffer_load_dwordx4 a[24:27], v149, s[8:11], s41 offen offset:2048
    s_add_u32 m0, s29, 0
    s_add_u32 s42, s47, 2654208
    s_add_u32 s43, s47, 2662400
    s_add_u32 s44, s47, 2670592
    s_add_u32 s45, s47, 2678784
    v_mfma_f32_16x16x32_bf16 v[64:67], v[128:131], a[44:47], v[64:67]
    buffer_load_dwordx4 v148, s[12:15], s42 offen lds
    v_mfma_f32_16x16x32_bf16 v[68:71], v[132:135], a[44:47], v[68:71]
    buffer_load_dwordx4 v148, s[12:15], s43 offen offset:1024 lds
    v_mfma_f32_16x16x32_bf16 v[72:75], v[136:139], a[44:47], v[72:75]
    buffer_load_dwordx4 v148, s[12:15], s44 offen offset:2048 lds
    v_mfma_f32_16x16x32_bf16 v[76:79], v[140:143], a[44:47], v[76:79]
    buffer_load_dwordx4 v148, s[12:15], s45 offen offset:3072 lds
    v_mfma_f32_16x16x32_bf16 v[80:83], v[128:131], a[48:51], v[80:83]
    v_mfma_f32_16x16x32_bf16 v[84:87], v[132:135], a[48:51], v[84:87]
    v_mfma_f32_16x16x32_bf16 v[88:91], v[136:139], a[48:51], v[88:91]
    v_mfma_f32_16x16x32_bf16 v[92:95], v[140:143], a[48:51], v[92:95]
    v_mfma_f32_16x16x32_bf16 v[96:99], v[128:131], a[52:55], v[96:99]
    v_mfma_f32_16x16x32_bf16 v[100:103], v[132:135], a[52:55], v[100:103]
    v_mfma_f32_16x16x32_bf16 v[104:107], v[136:139], a[52:55], v[104:107]
    s_waitcnt lgkmcnt(0)
    s_waitcnt vmcnt(26)
    s_add_u32 s40, s46, 6684672
    v_mfma_f32_16x16x32_bf16 v[108:111], v[140:143], a[52:55], v[108:111]
    s_add_u32 s41, s46, 6688768
    v_mfma_f32_16x16x32_bf16 v[0:3], v[112:115], a[56:59], v[0:3]
    v_mfma_f32_16x16x32_bf16 v[4:7], v[116:119], a[56:59], v[4:7]
    buffer_load_dwordx4 a[28:31], v149, s[8:11], s40 offen
    v_mfma_f32_16x16x32_bf16 v[8:11], v[120:123], a[56:59], v[8:11]
    buffer_load_dwordx4 a[32:35], v149, s[8:11], s40 offen offset:1024
    v_mfma_f32_16x16x32_bf16 v[12:15], v[124:127], a[56:59], v[12:15]
    buffer_load_dwordx4 a[36:39], v149, s[8:11], s40 offen offset:2048
    v_mfma_f32_16x16x32_bf16 v[16:19], v[112:115], a[60:63], v[16:19]
    buffer_load_dwordx4 a[40:43], v149, s[8:11], s40 offen offset:3072
    v_mfma_f32_16x16x32_bf16 v[20:23], v[116:119], a[60:63], v[20:23]
    ds_read_b64_tr_b16 v[128:129], v144 offset:12288
    v_mfma_f32_16x16x32_bf16 v[24:27], v[120:123], a[60:63], v[24:27]
    ds_read_b64_tr_b16 v[130:131], v144 offset:14336
    v_mfma_f32_16x16x32_bf16 v[28:31], v[124:127], a[60:63], v[28:31]
    ds_read_b64_tr_b16 v[132:133], v145 offset:12288
    v_mfma_f32_16x16x32_bf16 v[32:35], v[112:115], a[64:67], v[32:35]
    ds_read_b64_tr_b16 v[134:135], v145 offset:14336
    v_mfma_f32_16x16x32_bf16 v[36:39], v[116:119], a[64:67], v[36:39]
    ds_read_b64_tr_b16 v[136:137], v146 offset:12288
    v_mfma_f32_16x16x32_bf16 v[40:43], v[120:123], a[64:67], v[40:43]
    buffer_load_dwordx4 a[44:47], v149, s[8:11], s41 offen
    v_mfma_f32_16x16x32_bf16 v[44:47], v[124:127], a[64:67], v[44:47]
    ds_read_b64_tr_b16 v[138:139], v146 offset:14336
    v_mfma_f32_16x16x32_bf16 v[48:51], v[112:115], a[68:71], v[48:51]
    ds_read_b64_tr_b16 v[140:141], v147 offset:12288
    v_mfma_f32_16x16x32_bf16 v[52:55], v[116:119], a[68:71], v[52:55]
    ds_read_b64_tr_b16 v[142:143], v147 offset:14336
    v_mfma_f32_16x16x32_bf16 v[56:59], v[120:123], a[68:71], v[56:59]
    buffer_load_dwordx4 a[48:51], v149, s[8:11], s41 offen offset:1024
    v_mfma_f32_16x16x32_bf16 v[60:63], v[124:127], a[68:71], v[60:63]
    buffer_load_dwordx4 a[52:55], v149, s[8:11], s41 offen offset:2048
    s_add_u32 m0, s29, 4096
    s_add_u32 s42, s47, 2801664
    s_add_u32 s43, s47, 2809856
    s_add_u32 s44, s47, 2818048
    s_add_u32 s45, s47, 2826240
    v_mfma_f32_16x16x32_bf16 v[64:67], v[112:115], a[72:75], v[64:67]
    buffer_load_dwordx4 v148, s[12:15], s42 offen lds
    v_mfma_f32_16x16x32_bf16 v[68:71], v[116:119], a[72:75], v[68:71]
    buffer_load_dwordx4 v148, s[12:15], s43 offen offset:1024 lds
    v_mfma_f32_16x16x32_bf16 v[72:75], v[120:123], a[72:75], v[72:75]
    buffer_load_dwordx4 v148, s[12:15], s44 offen offset:2048 lds
    v_mfma_f32_16x16x32_bf16 v[76:79], v[124:127], a[72:75], v[76:79]
    buffer_load_dwordx4 v148, s[12:15], s45 offen offset:3072 lds
    v_mfma_f32_16x16x32_bf16 v[80:83], v[112:115], a[76:79], v[80:83]
    v_mfma_f32_16x16x32_bf16 v[84:87], v[116:119], a[76:79], v[84:87]
    v_mfma_f32_16x16x32_bf16 v[88:91], v[120:123], a[76:79], v[88:91]
    v_mfma_f32_16x16x32_bf16 v[92:95], v[124:127], a[76:79], v[92:95]
    v_mfma_f32_16x16x32_bf16 v[96:99], v[112:115], a[80:83], v[96:99]
    v_mfma_f32_16x16x32_bf16 v[100:103], v[116:119], a[80:83], v[100:103]
    v_mfma_f32_16x16x32_bf16 v[104:107], v[120:123], a[80:83], v[104:107]
    s_waitcnt lgkmcnt(0)
    s_waitcnt vmcnt(26)
    s_add_u32 s40, s46, 7077888
    v_mfma_f32_16x16x32_bf16 v[108:111], v[124:127], a[80:83], v[108:111]
    s_add_u32 s41, s46, 7081984
    v_mfma_f32_16x16x32_bf16 v[0:3], v[128:131], a[84:87], v[0:3]
    v_mfma_f32_16x16x32_bf16 v[4:7], v[132:135], a[84:87], v[4:7]
    buffer_load_dwordx4 a[56:59], v149, s[8:11], s40 offen
    v_mfma_f32_16x16x32_bf16 v[8:11], v[136:139], a[84:87], v[8:11]
    buffer_load_dwordx4 a[60:63], v149, s[8:11], s40 offen offset:1024
    v_mfma_f32_16x16x32_bf16 v[12:15], v[140:143], a[84:87], v[12:15]
    buffer_load_dwordx4 a[64:67], v149, s[8:11], s40 offen offset:2048
    v_mfma_f32_16x16x32_bf16 v[16:19], v[128:131], a[88:91], v[16:19]
    buffer_load_dwordx4 a[68:71], v149, s[8:11], s40 offen offset:3072
    v_mfma_f32_16x16x32_bf16 v[20:23], v[132:135], a[88:91], v[20:23]
    ds_read_b64_tr_b16 v[112:113], v144 offset:16384
    v_mfma_f32_16x16x32_bf16 v[24:27], v[136:139], a[88:91], v[24:27]
    ds_read_b64_tr_b16 v[114:115], v144 offset:18432
    v_mfma_f32_16x16x32_bf16 v[28:31], v[140:143], a[88:91], v[28:31]
    ds_read_b64_tr_b16 v[116:117], v145 offset:16384
    v_mfma_f32_16x16x32_bf16 v[32:35], v[128:131], a[92:95], v[32:35]
    ds_read_b64_tr_b16 v[118:119], v145 offset:18432
    v_mfma_f32_16x16x32_bf16 v[36:39], v[132:135], a[92:95], v[36:39]
    ds_read_b64_tr_b16 v[120:121], v146 offset:16384
    v_mfma_f32_16x16x32_bf16 v[40:43], v[136:139], a[92:95], v[40:43]
    buffer_load_dwordx4 a[72:75], v149, s[8:11], s41 offen
    v_mfma_f32_16x16x32_bf16 v[44:47], v[140:143], a[92:95], v[44:47]
    ds_read_b64_tr_b16 v[122:123], v146 offset:18432
    v_mfma_f32_16x16x32_bf16 v[48:51], v[128:131], a[96:99], v[48:51]
    ds_read_b64_tr_b16 v[124:125], v147 offset:16384
    v_mfma_f32_16x16x32_bf16 v[52:55], v[132:135], a[96:99], v[52:55]
    ds_read_b64_tr_b16 v[126:127], v147 offset:18432
    v_mfma_f32_16x16x32_bf16 v[56:59], v[136:139], a[96:99], v[56:59]
    buffer_load_dwordx4 a[76:79], v149, s[8:11], s41 offen offset:1024
    v_mfma_f32_16x16x32_bf16 v[60:63], v[140:143], a[96:99], v[60:63]
    buffer_load_dwordx4 a[80:83], v149, s[8:11], s41 offen offset:2048
    s_add_u32 m0, s29, 8192
    s_add_u32 s42, s47, 2949120
    s_add_u32 s43, s47, 2957312
    s_add_u32 s44, s47, 2965504
    s_add_u32 s45, s47, 2973696
    v_mfma_f32_16x16x32_bf16 v[64:67], v[128:131], a[100:103], v[64:67]
    buffer_load_dwordx4 v148, s[12:15], s42 offen lds
    v_mfma_f32_16x16x32_bf16 v[68:71], v[132:135], a[100:103], v[68:71]
    buffer_load_dwordx4 v148, s[12:15], s43 offen offset:1024 lds
    v_mfma_f32_16x16x32_bf16 v[72:75], v[136:139], a[100:103], v[72:75]
    buffer_load_dwordx4 v148, s[12:15], s44 offen offset:2048 lds
    v_mfma_f32_16x16x32_bf16 v[76:79], v[140:143], a[100:103], v[76:79]
    buffer_load_dwordx4 v148, s[12:15], s45 offen offset:3072 lds
    v_mfma_f32_16x16x32_bf16 v[80:83], v[128:131], a[104:107], v[80:83]
    v_mfma_f32_16x16x32_bf16 v[84:87], v[132:135], a[104:107], v[84:87]
    v_mfma_f32_16x16x32_bf16 v[88:91], v[136:139], a[104:107], v[88:91]
    v_mfma_f32_16x16x32_bf16 v[92:95], v[140:143], a[104:107], v[92:95]
    v_mfma_f32_16x16x32_bf16 v[96:99], v[128:131], a[108:111], v[96:99]
    v_mfma_f32_16x16x32_bf16 v[100:103], v[132:135], a[108:111], v[100:103]
    v_mfma_f32_16x16x32_bf16 v[104:107], v[136:139], a[108:111], v[104:107]
    s_waitcnt lgkmcnt(0)
    s_waitcnt vmcnt(26)
    s_add_u32 s40, s46, 7471104
    v_mfma_f32_16x16x32_bf16 v[108:111], v[140:143], a[108:111], v[108:111]
    s_add_u32 s41, s46, 7475200
    v_mfma_f32_16x16x32_bf16 v[0:3], v[112:115], a[0:3], v[0:3]
    v_mfma_f32_16x16x32_bf16 v[4:7], v[116:119], a[0:3], v[4:7]
    buffer_load_dwordx4 a[84:87], v149, s[8:11], s40 offen
    v_mfma_f32_16x16x32_bf16 v[8:11], v[120:123], a[0:3], v[8:11]
    buffer_load_dwordx4 a[88:91], v149, s[8:11], s40 offen offset:1024
    v_mfma_f32_16x16x32_bf16 v[12:15], v[124:127], a[0:3], v[12:15]
    buffer_load_dwordx4 a[92:95], v149, s[8:11], s40 offen offset:2048
    v_mfma_f32_16x16x32_bf16 v[16:19], v[112:115], a[4:7], v[16:19]
    buffer_load_dwordx4 a[96:99], v149, s[8:11], s40 offen offset:3072
    v_mfma_f32_16x16x32_bf16 v[20:23], v[116:119], a[4:7], v[20:23]
    ds_read_b64_tr_b16 v[128:129], v144 offset:20480
    v_mfma_f32_16x16x32_bf16 v[24:27], v[120:123], a[4:7], v[24:27]
    ds_read_b64_tr_b16 v[130:131], v144 offset:22528
    v_mfma_f32_16x16x32_bf16 v[28:31], v[124:127], a[4:7], v[28:31]
    ds_read_b64_tr_b16 v[132:133], v145 offset:20480
    v_mfma_f32_16x16x32_bf16 v[32:35], v[112:115], a[8:11], v[32:35]
    ds_read_b64_tr_b16 v[134:135], v145 offset:22528
    v_mfma_f32_16x16x32_bf16 v[36:39], v[116:119], a[8:11], v[36:39]
    ds_read_b64_tr_b16 v[136:137], v146 offset:20480
    v_mfma_f32_16x16x32_bf16 v[40:43], v[120:123], a[8:11], v[40:43]
    buffer_load_dwordx4 a[100:103], v149, s[8:11], s41 offen
    v_mfma_f32_16x16x32_bf16 v[44:47], v[124:127], a[8:11], v[44:47]
    ds_read_b64_tr_b16 v[138:139], v146 offset:22528
    v_mfma_f32_16x16x32_bf16 v[48:51], v[112:115], a[12:15], v[48:51]
    ds_read_b64_tr_b16 v[140:141], v147 offset:20480
    v_mfma_f32_16x16x32_bf16 v[52:55], v[116:119], a[12:15], v[52:55]
    ds_read_b64_tr_b16 v[142:143], v147 offset:22528
    v_mfma_f32_16x16x32_bf16 v[56:59], v[120:123], a[12:15], v[56:59]
    buffer_load_dwordx4 a[104:107], v149, s[8:11], s41 offen offset:1024
    v_mfma_f32_16x16x32_bf16 v[60:63], v[124:127], a[12:15], v[60:63]
    buffer_load_dwordx4 a[108:111], v149, s[8:11], s41 offen offset:2048
    s_add_u32 m0, s29, 12288
    s_add_u32 s42, s47, 3096576
    s_add_u32 s43, s47, 3104768
    s_add_u32 s44, s47, 3112960
    s_add_u32 s45, s47, 3121152
    v_mfma_f32_16x16x32_bf16 v[64:67], v[112:115], a[16:19], v[64:67]
    buffer_load_dwordx4 v148, s[12:15], s42 offen lds
    v_mfma_f32_16x16x32_bf16 v[68:71], v[116:119], a[16:19], v[68:71]
    buffer_load_dwordx4 v148, s[12:15], s43 offen offset:1024 lds
    v_mfma_f32_16x16x32_bf16 v[72:75], v[120:123], a[16:19], v[72:75]
    buffer_load_dwordx4 v148, s[12:15], s44 offen offset:2048 lds
    v_mfma_f32_16x16x32_bf16 v[76:79], v[124:127], a[16:19], v[76:79]
    buffer_load_dwordx4 v148, s[12:15], s45 offen offset:3072 lds
    v_mfma_f32_16x16x32_bf16 v[80:83], v[112:115], a[20:23], v[80:83]
    v_mfma_f32_16x16x32_bf16 v[84:87], v[116:119], a[20:23], v[84:87]
    v_mfma_f32_16x16x32_bf16 v[88:91], v[120:123], a[20:23], v[88:91]
    v_mfma_f32_16x16x32_bf16 v[92:95], v[124:127], a[20:23], v[92:95]
    v_mfma_f32_16x16x32_bf16 v[96:99], v[112:115], a[24:27], v[96:99]
    v_mfma_f32_16x16x32_bf16 v[100:103], v[116:119], a[24:27], v[100:103]
    v_mfma_f32_16x16x32_bf16 v[104:107], v[120:123], a[24:27], v[104:107]
    s_waitcnt lgkmcnt(0)
    s_waitcnt vmcnt(26)
    s_add_u32 s40, s46, 7864320
    v_mfma_f32_16x16x32_bf16 v[108:111], v[124:127], a[24:27], v[108:111]
    s_add_u32 s41, s46, 7868416
    v_mfma_f32_16x16x32_bf16 v[0:3], v[128:131], a[28:31], v[0:3]
    v_mfma_f32_16x16x32_bf16 v[4:7], v[132:135], a[28:31], v[4:7]
    buffer_load_dwordx4 a[0:3], v149, s[8:11], s40 offen
    v_mfma_f32_16x16x32_bf16 v[8:11], v[136:139], a[28:31], v[8:11]
    buffer_load_dwordx4 a[4:7], v149, s[8:11], s40 offen offset:1024
    v_mfma_f32_16x16x32_bf16 v[12:15], v[140:143], a[28:31], v[12:15]
    buffer_load_dwordx4 a[8:11], v149, s[8:11], s40 offen offset:2048
    v_mfma_f32_16x16x32_bf16 v[16:19], v[128:131], a[32:35], v[16:19]
    buffer_load_dwordx4 a[12:15], v149, s[8:11], s40 offen offset:3072
    v_mfma_f32_16x16x32_bf16 v[20:23], v[132:135], a[32:35], v[20:23]
    ds_read_b64_tr_b16 v[112:113], v144
    v_mfma_f32_16x16x32_bf16 v[24:27], v[136:139], a[32:35], v[24:27]
    ds_read_b64_tr_b16 v[114:115], v144 offset:2048
    v_mfma_f32_16x16x32_bf16 v[28:31], v[140:143], a[32:35], v[28:31]
    ds_read_b64_tr_b16 v[116:117], v145
    v_mfma_f32_16x16x32_bf16 v[32:35], v[128:131], a[36:39], v[32:35]
    ds_read_b64_tr_b16 v[118:119], v145 offset:2048
    v_mfma_f32_16x16x32_bf16 v[36:39], v[132:135], a[36:39], v[36:39]
    ds_read_b64_tr_b16 v[120:121], v146
    v_mfma_f32_16x16x32_bf16 v[40:43], v[136:139], a[36:39], v[40:43]
    buffer_load_dwordx4 a[16:19], v149, s[8:11], s41 offen
    v_mfma_f32_16x16x32_bf16 v[44:47], v[140:143], a[36:39], v[44:47]
    ds_read_b64_tr_b16 v[122:123], v146 offset:2048
    v_mfma_f32_16x16x32_bf16 v[48:51], v[128:131], a[40:43], v[48:51]
    ds_read_b64_tr_b16 v[124:125], v147
    v_mfma_f32_16x16x32_bf16 v[52:55], v[132:135], a[40:43], v[52:55]
    ds_read_b64_tr_b16 v[126:127], v147 offset:2048
    v_mfma_f32_16x16x32_bf16 v[56:59], v[136:139], a[40:43], v[56:59]
    buffer_load_dwordx4 a[20:23], v149, s[8:11], s41 offen offset:1024
    v_mfma_f32_16x16x32_bf16 v[60:63], v[140:143], a[40:43], v[60:63]
    buffer_load_dwordx4 a[24:27], v149, s[8:11], s41 offen offset:2048
    s_add_u32 m0, s29, 16384
    s_add_u32 s42, s47, 3244032
    s_add_u32 s43, s47, 3252224
    s_add_u32 s44, s47, 3260416
    s_add_u32 s45, s47, 3268608
    v_mfma_f32_16x16x32_bf16 v[64:67], v[128:131], a[44:47], v[64:67]
    buffer_load_dwordx4 v148, s[12:15], s42 offen lds
    v_mfma_f32_16x16x32_bf16 v[68:71], v[132:135], a[44:47], v[68:71]
    buffer_load_dwordx4 v148, s[12:15], s43 offen offset:1024 lds
    v_mfma_f32_16x16x32_bf16 v[72:75], v[136:139], a[44:47], v[72:75]
    buffer_load_dwordx4 v148, s[12:15], s44 offen offset:2048 lds
    v_mfma_f32_16x16x32_bf16 v[76:79], v[140:143], a[44:47], v[76:79]
    buffer_load_dwordx4 v148, s[12:15], s45 offen offset:3072 lds
    v_mfma_f32_16x16x32_bf16 v[80:83], v[128:131], a[48:51], v[80:83]
    v_mfma_f32_16x16x32_bf16 v[84:87], v[132:135], a[48:51], v[84:87]
    v_mfma_f32_16x16x32_bf16 v[88:91], v[136:139], a[48:51], v[88:91]
    v_mfma_f32_16x16x32_bf16 v[92:95], v[140:143], a[48:51], v[92:95]
    v_mfma_f32_16x16x32_bf16 v[96:99], v[128:131], a[52:55], v[96:99]
    v_mfma_f32_16x16x32_bf16 v[100:103], v[132:135], a[52:55], v[100:103]
    v_mfma_f32_16x16x32_bf16 v[104:107], v[136:139], a[52:55], v[104:107]
    s_waitcnt lgkmcnt(0)
    s_waitcnt vmcnt(26)
    s_add_u32 s40, s46, 8257536
    v_mfma_f32_16x16x32_bf16 v[108:111], v[140:143], a[52:55], v[108:111]
    s_add_u32 s41, s46, 8261632
    v_mfma_f32_16x16x32_bf16 v[0:3], v[112:115], a[56:59], v[0:3]
    v_mfma_f32_16x16x32_bf16 v[4:7], v[116:119], a[56:59], v[4:7]
    buffer_load_dwordx4 a[28:31], v149, s[8:11], s40 offen
    v_mfma_f32_16x16x32_bf16 v[8:11], v[120:123], a[56:59], v[8:11]
    buffer_load_dwordx4 a[32:35], v149, s[8:11], s40 offen offset:1024
    v_mfma_f32_16x16x32_bf16 v[12:15], v[124:127], a[56:59], v[12:15]
    buffer_load_dwordx4 a[36:39], v149, s[8:11], s40 offen offset:2048
    v_mfma_f32_16x16x32_bf16 v[16:19], v[112:115], a[60:63], v[16:19]
    buffer_load_dwordx4 a[40:43], v149, s[8:11], s40 offen offset:3072
    v_mfma_f32_16x16x32_bf16 v[20:23], v[116:119], a[60:63], v[20:23]
    ds_read_b64_tr_b16 v[128:129], v144 offset:4096
    v_mfma_f32_16x16x32_bf16 v[24:27], v[120:123], a[60:63], v[24:27]
    ds_read_b64_tr_b16 v[130:131], v144 offset:6144
    v_mfma_f32_16x16x32_bf16 v[28:31], v[124:127], a[60:63], v[28:31]
    ds_read_b64_tr_b16 v[132:133], v145 offset:4096
    v_mfma_f32_16x16x32_bf16 v[32:35], v[112:115], a[64:67], v[32:35]
    ds_read_b64_tr_b16 v[134:135], v145 offset:6144
    v_mfma_f32_16x16x32_bf16 v[36:39], v[116:119], a[64:67], v[36:39]
    ds_read_b64_tr_b16 v[136:137], v146 offset:4096
    v_mfma_f32_16x16x32_bf16 v[40:43], v[120:123], a[64:67], v[40:43]
    buffer_load_dwordx4 a[44:47], v149, s[8:11], s41 offen
    v_mfma_f32_16x16x32_bf16 v[44:47], v[124:127], a[64:67], v[44:47]
    ds_read_b64_tr_b16 v[138:139], v146 offset:6144
    v_mfma_f32_16x16x32_bf16 v[48:51], v[112:115], a[68:71], v[48:51]
    ds_read_b64_tr_b16 v[140:141], v147 offset:4096
    v_mfma_f32_16x16x32_bf16 v[52:55], v[116:119], a[68:71], v[52:55]
    ds_read_b64_tr_b16 v[142:143], v147 offset:6144
    v_mfma_f32_16x16x32_bf16 v[56:59], v[120:123], a[68:71], v[56:59]
    buffer_load_dwordx4 a[48:51], v149, s[8:11], s41 offen offset:1024
    v_mfma_f32_16x16x32_bf16 v[60:63], v[124:127], a[68:71], v[60:63]
    buffer_load_dwordx4 a[52:55], v149, s[8:11], s41 offen offset:2048
    s_add_u32 m0, s29, 20480
    s_add_u32 s42, s47, 3391488
    s_add_u32 s43, s47, 3399680
    s_add_u32 s44, s47, 3407872
    s_add_u32 s45, s47, 3416064
    v_mfma_f32_16x16x32_bf16 v[64:67], v[112:115], a[72:75], v[64:67]
    buffer_load_dwordx4 v148, s[12:15], s42 offen lds
    v_mfma_f32_16x16x32_bf16 v[68:71], v[116:119], a[72:75], v[68:71]
    buffer_load_dwordx4 v148, s[12:15], s43 offen offset:1024 lds
    v_mfma_f32_16x16x32_bf16 v[72:75], v[120:123], a[72:75], v[72:75]
    buffer_load_dwordx4 v148, s[12:15], s44 offen offset:2048 lds
    v_mfma_f32_16x16x32_bf16 v[76:79], v[124:127], a[72:75], v[76:79]
    buffer_load_dwordx4 v148, s[12:15], s45 offen offset:3072 lds
    v_mfma_f32_16x16x32_bf16 v[80:83], v[112:115], a[76:79], v[80:83]
    v_mfma_f32_16x16x32_bf16 v[84:87], v[116:119], a[76:79], v[84:87]
    v_mfma_f32_16x16x32_bf16 v[88:91], v[120:123], a[76:79], v[88:91]
    v_mfma_f32_16x16x32_bf16 v[92:95], v[124:127], a[76:79], v[92:95]
    v_mfma_f32_16x16x32_bf16 v[96:99], v[112:115], a[80:83], v[96:99]
    v_mfma_f32_16x16x32_bf16 v[100:103], v[116:119], a[80:83], v[100:103]
    v_mfma_f32_16x16x32_bf16 v[104:107], v[120:123], a[80:83], v[104:107]
    s_waitcnt lgkmcnt(0)
    s_waitcnt vmcnt(26)
    s_add_u32 s40, s46, 8650752
    v_mfma_f32_16x16x32_bf16 v[108:111], v[124:127], a[80:83], v[108:111]
    s_add_u32 s41, s46, 8654848
    v_mfma_f32_16x16x32_bf16 v[0:3], v[128:131], a[84:87], v[0:3]
    v_mfma_f32_16x16x32_bf16 v[4:7], v[132:135], a[84:87], v[4:7]
    buffer_load_dwordx4 a[56:59], v149, s[8:11], s40 offen
    v_mfma_f32_16x16x32_bf16 v[8:11], v[136:139], a[84:87], v[8:11]
    buffer_load_dwordx4 a[60:63], v149, s[8:11], s40 offen offset:1024
    v_mfma_f32_16x16x32_bf16 v[12:15], v[140:143], a[84:87], v[12:15]
    buffer_load_dwordx4 a[64:67], v149, s[8:11], s40 offen offset:2048
    v_mfma_f32_16x16x32_bf16 v[16:19], v[128:131], a[88:91], v[16:19]
    buffer_load_dwordx4 a[68:71], v149, s[8:11], s40 offen offset:3072
    v_mfma_f32_16x16x32_bf16 v[20:23], v[132:135], a[88:91], v[20:23]
    ds_read_b64_tr_b16 v[112:113], v144 offset:8192
    v_mfma_f32_16x16x32_bf16 v[24:27], v[136:139], a[88:91], v[24:27]
    ds_read_b64_tr_b16 v[114:115], v144 offset:10240
    v_mfma_f32_16x16x32_bf16 v[28:31], v[140:143], a[88:91], v[28:31]
    ds_read_b64_tr_b16 v[116:117], v145 offset:8192
    v_mfma_f32_16x16x32_bf16 v[32:35], v[128:131], a[92:95], v[32:35]
    ds_read_b64_tr_b16 v[118:119], v145 offset:10240
    v_mfma_f32_16x16x32_bf16 v[36:39], v[132:135], a[92:95], v[36:39]
    ds_read_b64_tr_b16 v[120:121], v146 offset:8192
    v_mfma_f32_16x16x32_bf16 v[40:43], v[136:139], a[92:95], v[40:43]
    buffer_load_dwordx4 a[72:75], v149, s[8:11], s41 offen
    v_mfma_f32_16x16x32_bf16 v[44:47], v[140:143], a[92:95], v[44:47]
    ds_read_b64_tr_b16 v[122:123], v146 offset:10240
    v_mfma_f32_16x16x32_bf16 v[48:51], v[128:131], a[96:99], v[48:51]
    ds_read_b64_tr_b16 v[124:125], v147 offset:8192
    v_mfma_f32_16x16x32_bf16 v[52:55], v[132:135], a[96:99], v[52:55]
    ds_read_b64_tr_b16 v[126:127], v147 offset:10240
    v_mfma_f32_16x16x32_bf16 v[56:59], v[136:139], a[96:99], v[56:59]
    buffer_load_dwordx4 a[76:79], v149, s[8:11], s41 offen offset:1024
    v_mfma_f32_16x16x32_bf16 v[60:63], v[140:143], a[96:99], v[60:63]
    buffer_load_dwordx4 a[80:83], v149, s[8:11], s41 offen offset:2048
    s_add_u32 m0, s29, 0
    s_add_u32 s42, s47, 3538944
    s_add_u32 s43, s47, 3547136
    s_add_u32 s44, s47, 3555328
    s_add_u32 s45, s47, 3563520
    v_mfma_f32_16x16x32_bf16 v[64:67], v[128:131], a[100:103], v[64:67]
    buffer_load_dwordx4 v148, s[12:15], s42 offen lds
    v_mfma_f32_16x16x32_bf16 v[68:71], v[132:135], a[100:103], v[68:71]
    buffer_load_dwordx4 v148, s[12:15], s43 offen offset:1024 lds
    v_mfma_f32_16x16x32_bf16 v[72:75], v[136:139], a[100:103], v[72:75]
    buffer_load_dwordx4 v148, s[12:15], s44 offen offset:2048 lds
    v_mfma_f32_16x16x32_bf16 v[76:79], v[140:143], a[100:103], v[76:79]
    buffer_load_dwordx4 v148, s[12:15], s45 offen offset:3072 lds
    v_mfma_f32_16x16x32_bf16 v[80:83], v[128:131], a[104:107], v[80:83]
    v_mfma_f32_16x16x32_bf16 v[84:87], v[132:135], a[104:107], v[84:87]
    v_mfma_f32_16x16x32_bf16 v[88:91], v[136:139], a[104:107], v[88:91]
    v_mfma_f32_16x16x32_bf16 v[92:95], v[140:143], a[104:107], v[92:95]
    v_mfma_f32_16x16x32_bf16 v[96:99], v[128:131], a[108:111], v[96:99]
    v_mfma_f32_16x16x32_bf16 v[100:103], v[132:135], a[108:111], v[100:103]
    v_mfma_f32_16x16x32_bf16 v[104:107], v[136:139], a[108:111], v[104:107]
    s_waitcnt lgkmcnt(0)
    s_waitcnt vmcnt(26)
    s_add_u32 s40, s46, 9043968
    v_mfma_f32_16x16x32_bf16 v[108:111], v[140:143], a[108:111], v[108:111]
    s_add_u32 s41, s46, 9048064
    v_mfma_f32_16x16x32_bf16 v[0:3], v[112:115], a[0:3], v[0:3]
    v_mfma_f32_16x16x32_bf16 v[4:7], v[116:119], a[0:3], v[4:7]
    buffer_load_dwordx4 a[84:87], v149, s[8:11], s40 offen
    v_mfma_f32_16x16x32_bf16 v[8:11], v[120:123], a[0:3], v[8:11]
    buffer_load_dwordx4 a[88:91], v149, s[8:11], s40 offen offset:1024
    v_mfma_f32_16x16x32_bf16 v[12:15], v[124:127], a[0:3], v[12:15]
    buffer_load_dwordx4 a[92:95], v149, s[8:11], s40 offen offset:2048
    v_mfma_f32_16x16x32_bf16 v[16:19], v[112:115], a[4:7], v[16:19]
    buffer_load_dwordx4 a[96:99], v149, s[8:11], s40 offen offset:3072
    v_mfma_f32_16x16x32_bf16 v[20:23], v[116:119], a[4:7], v[20:23]
    ds_read_b64_tr_b16 v[128:129], v144 offset:12288
    v_mfma_f32_16x16x32_bf16 v[24:27], v[120:123], a[4:7], v[24:27]
    ds_read_b64_tr_b16 v[130:131], v144 offset:14336
    v_mfma_f32_16x16x32_bf16 v[28:31], v[124:127], a[4:7], v[28:31]
    ds_read_b64_tr_b16 v[132:133], v145 offset:12288
    v_mfma_f32_16x16x32_bf16 v[32:35], v[112:115], a[8:11], v[32:35]
    ds_read_b64_tr_b16 v[134:135], v145 offset:14336
    v_mfma_f32_16x16x32_bf16 v[36:39], v[116:119], a[8:11], v[36:39]
    ds_read_b64_tr_b16 v[136:137], v146 offset:12288
    v_mfma_f32_16x16x32_bf16 v[40:43], v[120:123], a[8:11], v[40:43]
    buffer_load_dwordx4 a[100:103], v149, s[8:11], s41 offen
    v_mfma_f32_16x16x32_bf16 v[44:47], v[124:127], a[8:11], v[44:47]
    ds_read_b64_tr_b16 v[138:139], v146 offset:14336
    v_mfma_f32_16x16x32_bf16 v[48:51], v[112:115], a[12:15], v[48:51]
    ds_read_b64_tr_b16 v[140:141], v147 offset:12288
    v_mfma_f32_16x16x32_bf16 v[52:55], v[116:119], a[12:15], v[52:55]
    ds_read_b64_tr_b16 v[142:143], v147 offset:14336
    v_mfma_f32_16x16x32_bf16 v[56:59], v[120:123], a[12:15], v[56:59]
    buffer_load_dwordx4 a[104:107], v149, s[8:11], s41 offen offset:1024
    v_mfma_f32_16x16x32_bf16 v[60:63], v[124:127], a[12:15], v[60:63]
    buffer_load_dwordx4 a[108:111], v149, s[8:11], s41 offen offset:2048
    s_add_u32 m0, s29, 4096
    s_add_u32 s42, s47, 3686400
    s_add_u32 s43, s47, 3694592
    s_add_u32 s44, s47, 3702784
    s_add_u32 s45, s47, 3710976
    v_mfma_f32_16x16x32_bf16 v[64:67], v[112:115], a[16:19], v[64:67]
    buffer_load_dwordx4 v148, s[12:15], s42 offen lds
    v_mfma_f32_16x16x32_bf16 v[68:71], v[116:119], a[16:19], v[68:71]
    buffer_load_dwordx4 v148, s[12:15], s43 offen offset:1024 lds
    v_mfma_f32_16x16x32_bf16 v[72:75], v[120:123], a[16:19], v[72:75]
    buffer_load_dwordx4 v148, s[12:15], s44 offen offset:2048 lds
    v_mfma_f32_16x16x32_bf16 v[76:79], v[124:127], a[16:19], v[76:79]
    buffer_load_dwordx4 v148, s[12:15], s45 offen offset:3072 lds
    v_mfma_f32_16x16x32_bf16 v[80:83], v[112:115], a[20:23], v[80:83]
    v_mfma_f32_16x16x32_bf16 v[84:87], v[116:119], a[20:23], v[84:87]
    v_mfma_f32_16x16x32_bf16 v[88:91], v[120:123], a[20:23], v[88:91]
    v_mfma_f32_16x16x32_bf16 v[92:95], v[124:127], a[20:23], v[92:95]
    v_mfma_f32_16x16x32_bf16 v[96:99], v[112:115], a[24:27], v[96:99]
    v_mfma_f32_16x16x32_bf16 v[100:103], v[116:119], a[24:27], v[100:103]
    v_mfma_f32_16x16x32_bf16 v[104:107], v[120:123], a[24:27], v[104:107]
    s_waitcnt lgkmcnt(0)
    s_waitcnt vmcnt(26)
    s_add_u32 s40, s46, 9437184
    v_mfma_f32_16x16x32_bf16 v[108:111], v[124:127], a[24:27], v[108:111]
    s_add_u32 s41, s46, 9441280
    v_mfma_f32_16x16x32_bf16 v[0:3], v[128:131], a[28:31], v[0:3]
    v_mfma_f32_16x16x32_bf16 v[4:7], v[132:135], a[28:31], v[4:7]
    buffer_load_dwordx4 a[0:3], v149, s[8:11], s40 offen
    v_mfma_f32_16x16x32_bf16 v[8:11], v[136:139], a[28:31], v[8:11]
    buffer_load_dwordx4 a[4:7], v149, s[8:11], s40 offen offset:1024
    v_mfma_f32_16x16x32_bf16 v[12:15], v[140:143], a[28:31], v[12:15]
    buffer_load_dwordx4 a[8:11], v149, s[8:11], s40 offen offset:2048
    v_mfma_f32_16x16x32_bf16 v[16:19], v[128:131], a[32:35], v[16:19]
    buffer_load_dwordx4 a[12:15], v149, s[8:11], s40 offen offset:3072
    v_mfma_f32_16x16x32_bf16 v[20:23], v[132:135], a[32:35], v[20:23]
    ds_read_b64_tr_b16 v[112:113], v144 offset:16384
    v_mfma_f32_16x16x32_bf16 v[24:27], v[136:139], a[32:35], v[24:27]
    ds_read_b64_tr_b16 v[114:115], v144 offset:18432
    v_mfma_f32_16x16x32_bf16 v[28:31], v[140:143], a[32:35], v[28:31]
    ds_read_b64_tr_b16 v[116:117], v145 offset:16384
    v_mfma_f32_16x16x32_bf16 v[32:35], v[128:131], a[36:39], v[32:35]
    ds_read_b64_tr_b16 v[118:119], v145 offset:18432
    v_mfma_f32_16x16x32_bf16 v[36:39], v[132:135], a[36:39], v[36:39]
    ds_read_b64_tr_b16 v[120:121], v146 offset:16384
    v_mfma_f32_16x16x32_bf16 v[40:43], v[136:139], a[36:39], v[40:43]
    buffer_load_dwordx4 a[16:19], v149, s[8:11], s41 offen
    v_mfma_f32_16x16x32_bf16 v[44:47], v[140:143], a[36:39], v[44:47]
    ds_read_b64_tr_b16 v[122:123], v146 offset:18432
    v_mfma_f32_16x16x32_bf16 v[48:51], v[128:131], a[40:43], v[48:51]
    ds_read_b64_tr_b16 v[124:125], v147 offset:16384
    v_mfma_f32_16x16x32_bf16 v[52:55], v[132:135], a[40:43], v[52:55]
    ds_read_b64_tr_b16 v[126:127], v147 offset:18432
    v_mfma_f32_16x16x32_bf16 v[56:59], v[136:139], a[40:43], v[56:59]
    buffer_load_dwordx4 a[20:23], v149, s[8:11], s41 offen offset:1024
    v_mfma_f32_16x16x32_bf16 v[60:63], v[140:143], a[40:43], v[60:63]
    buffer_load_dwordx4 a[24:27], v149, s[8:11], s41 offen offset:2048
    s_add_u32 m0, s29, 8192
    s_add_u32 s42, s47, 3833856
    s_add_u32 s43, s47, 3842048
    s_add_u32 s44, s47, 3850240
    s_add_u32 s45, s47, 3858432
    v_mfma_f32_16x16x32_bf16 v[64:67], v[128:131], a[44:47], v[64:67]
    buffer_load_dwordx4 v148, s[12:15], s42 offen lds
    v_mfma_f32_16x16x32_bf16 v[68:71], v[132:135], a[44:47], v[68:71]
    buffer_load_dwordx4 v148, s[12:15], s43 offen offset:1024 lds
    v_mfma_f32_16x16x32_bf16 v[72:75], v[136:139], a[44:47], v[72:75]
    buffer_load_dwordx4 v148, s[12:15], s44 offen offset:2048 lds
    v_mfma_f32_16x16x32_bf16 v[76:79], v[140:143], a[44:47], v[76:79]
    buffer_load_dwordx4 v148, s[12:15], s45 offen offset:3072 lds
    v_mfma_f32_16x16x32_bf16 v[80:83], v[128:131], a[48:51], v[80:83]
    v_mfma_f32_16x16x32_bf16 v[84:87], v[132:135], a[48:51], v[84:87]
    v_mfma_f32_16x16x32_bf16 v[88:91], v[136:139], a[48:51], v[88:91]
    v_mfma_f32_16x16x32_bf16 v[92:95], v[140:143], a[48:51], v[92:95]
    v_mfma_f32_16x16x32_bf16 v[96:99], v[128:131], a[52:55], v[96:99]
    v_mfma_f32_16x16x32_bf16 v[100:103], v[132:135], a[52:55], v[100:103]
    v_mfma_f32_16x16x32_bf16 v[104:107], v[136:139], a[52:55], v[104:107]
    s_waitcnt lgkmcnt(0)
    s_waitcnt vmcnt(26)
    s_add_u32 s40, s46, 9830400
    v_mfma_f32_16x16x32_bf16 v[108:111], v[140:143], a[52:55], v[108:111]
    s_add_u32 s41, s46, 9834496
    v_mfma_f32_16x16x32_bf16 v[0:3], v[112:115], a[56:59], v[0:3]
    v_mfma_f32_16x16x32_bf16 v[4:7], v[116:119], a[56:59], v[4:7]
    buffer_load_dwordx4 a[28:31], v149, s[8:11], s40 offen
    v_mfma_f32_16x16x32_bf16 v[8:11], v[120:123], a[56:59], v[8:11]
    buffer_load_dwordx4 a[32:35], v149, s[8:11], s40 offen offset:1024
    v_mfma_f32_16x16x32_bf16 v[12:15], v[124:127], a[56:59], v[12:15]
    buffer_load_dwordx4 a[36:39], v149, s[8:11], s40 offen offset:2048
    v_mfma_f32_16x16x32_bf16 v[16:19], v[112:115], a[60:63], v[16:19]
    buffer_load_dwordx4 a[40:43], v149, s[8:11], s40 offen offset:3072
    v_mfma_f32_16x16x32_bf16 v[20:23], v[116:119], a[60:63], v[20:23]
    ds_read_b64_tr_b16 v[128:129], v144 offset:20480
    v_mfma_f32_16x16x32_bf16 v[24:27], v[120:123], a[60:63], v[24:27]
    ds_read_b64_tr_b16 v[130:131], v144 offset:22528
    v_mfma_f32_16x16x32_bf16 v[28:31], v[124:127], a[60:63], v[28:31]
    ds_read_b64_tr_b16 v[132:133], v145 offset:20480
    v_mfma_f32_16x16x32_bf16 v[32:35], v[112:115], a[64:67], v[32:35]
    ds_read_b64_tr_b16 v[134:135], v145 offset:22528
    v_mfma_f32_16x16x32_bf16 v[36:39], v[116:119], a[64:67], v[36:39]
    ds_read_b64_tr_b16 v[136:137], v146 offset:20480
    v_mfma_f32_16x16x32_bf16 v[40:43], v[120:123], a[64:67], v[40:43]
    buffer_load_dwordx4 a[44:47], v149, s[8:11], s41 offen
    v_mfma_f32_16x16x32_bf16 v[44:47], v[124:127], a[64:67], v[44:47]
    ds_read_b64_tr_b16 v[138:139], v146 offset:22528
    v_mfma_f32_16x16x32_bf16 v[48:51], v[112:115], a[68:71], v[48:51]
    ds_read_b64_tr_b16 v[140:141], v147 offset:20480
    v_mfma_f32_16x16x32_bf16 v[52:55], v[116:119], a[68:71], v[52:55]
    ds_read_b64_tr_b16 v[142:143], v147 offset:22528
    v_mfma_f32_16x16x32_bf16 v[56:59], v[120:123], a[68:71], v[56:59]
    buffer_load_dwordx4 a[48:51], v149, s[8:11], s41 offen offset:1024
    v_mfma_f32_16x16x32_bf16 v[60:63], v[124:127], a[68:71], v[60:63]
    buffer_load_dwordx4 a[52:55], v149, s[8:11], s41 offen offset:2048
    s_add_u32 m0, s29, 12288
    s_add_u32 s42, s47, 3981312
    s_add_u32 s43, s47, 3989504
    s_add_u32 s44, s47, 3997696
    s_add_u32 s45, s47, 4005888
    v_mfma_f32_16x16x32_bf16 v[64:67], v[112:115], a[72:75], v[64:67]
    buffer_load_dwordx4 v148, s[12:15], s42 offen lds
    v_mfma_f32_16x16x32_bf16 v[68:71], v[116:119], a[72:75], v[68:71]
    buffer_load_dwordx4 v148, s[12:15], s43 offen offset:1024 lds
    v_mfma_f32_16x16x32_bf16 v[72:75], v[120:123], a[72:75], v[72:75]
    buffer_load_dwordx4 v148, s[12:15], s44 offen offset:2048 lds
    v_mfma_f32_16x16x32_bf16 v[76:79], v[124:127], a[72:75], v[76:79]
    buffer_load_dwordx4 v148, s[12:15], s45 offen offset:3072 lds
    v_mfma_f32_16x16x32_bf16 v[80:83], v[112:115], a[76:79], v[80:83]
    v_mfma_f32_16x16x32_bf16 v[84:87], v[116:119], a[76:79], v[84:87]
    v_mfma_f32_16x16x32_bf16 v[88:91], v[120:123], a[76:79], v[88:91]
    v_mfma_f32_16x16x32_bf16 v[92:95], v[124:127], a[76:79], v[92:95]
    v_mfma_f32_16x16x32_bf16 v[96:99], v[112:115], a[80:83], v[96:99]
    v_mfma_f32_16x16x32_bf16 v[100:103], v[116:119], a[80:83], v[100:103]
    v_mfma_f32_16x16x32_bf16 v[104:107], v[120:123], a[80:83], v[104:107]
    s_waitcnt lgkmcnt(0)
    s_waitcnt vmcnt(26)
    s_add_u32 s40, s46, 10223616
    v_mfma_f32_16x16x32_bf16 v[108:111], v[124:127], a[80:83], v[108:111]
    s_add_u32 s41, s46, 10227712
    v_mfma_f32_16x16x32_bf16 v[0:3], v[128:131], a[84:87], v[0:3]
    v_mfma_f32_16x16x32_bf16 v[4:7], v[132:135], a[84:87], v[4:7]
    buffer_load_dwordx4 a[56:59], v149, s[8:11], s40 offen
    v_mfma_f32_16x16x32_bf16 v[8:11], v[136:139], a[84:87], v[8:11]
    buffer_load_dwordx4 a[60:63], v149, s[8:11], s40 offen offset:1024
    v_mfma_f32_16x16x32_bf16 v[12:15], v[140:143], a[84:87], v[12:15]
    buffer_load_dwordx4 a[64:67], v149, s[8:11], s40 offen offset:2048
    v_mfma_f32_16x16x32_bf16 v[16:19], v[128:131], a[88:91], v[16:19]
    buffer_load_dwordx4 a[68:71], v149, s[8:11], s40 offen offset:3072
    v_mfma_f32_16x16x32_bf16 v[20:23], v[132:135], a[88:91], v[20:23]
    ds_read_b64_tr_b16 v[112:113], v144
    v_mfma_f32_16x16x32_bf16 v[24:27], v[136:139], a[88:91], v[24:27]
    ds_read_b64_tr_b16 v[114:115], v144 offset:2048
    v_mfma_f32_16x16x32_bf16 v[28:31], v[140:143], a[88:91], v[28:31]
    ds_read_b64_tr_b16 v[116:117], v145
    v_mfma_f32_16x16x32_bf16 v[32:35], v[128:131], a[92:95], v[32:35]
    ds_read_b64_tr_b16 v[118:119], v145 offset:2048
    v_mfma_f32_16x16x32_bf16 v[36:39], v[132:135], a[92:95], v[36:39]
    ds_read_b64_tr_b16 v[120:121], v146
    v_mfma_f32_16x16x32_bf16 v[40:43], v[136:139], a[92:95], v[40:43]
    buffer_load_dwordx4 a[72:75], v149, s[8:11], s41 offen
    v_mfma_f32_16x16x32_bf16 v[44:47], v[140:143], a[92:95], v[44:47]
    ds_read_b64_tr_b16 v[122:123], v146 offset:2048
    v_mfma_f32_16x16x32_bf16 v[48:51], v[128:131], a[96:99], v[48:51]
    ds_read_b64_tr_b16 v[124:125], v147
    v_mfma_f32_16x16x32_bf16 v[52:55], v[132:135], a[96:99], v[52:55]
    ds_read_b64_tr_b16 v[126:127], v147 offset:2048
    v_mfma_f32_16x16x32_bf16 v[56:59], v[136:139], a[96:99], v[56:59]
    buffer_load_dwordx4 a[76:79], v149, s[8:11], s41 offen offset:1024
    v_mfma_f32_16x16x32_bf16 v[60:63], v[140:143], a[96:99], v[60:63]
    buffer_load_dwordx4 a[80:83], v149, s[8:11], s41 offen offset:2048
    s_add_u32 m0, s29, 16384
    s_add_u32 s42, s47, 4128768
    s_add_u32 s43, s47, 4136960
    s_add_u32 s44, s47, 4145152
    s_add_u32 s45, s47, 4153344
    v_mfma_f32_16x16x32_bf16 v[64:67], v[128:131], a[100:103], v[64:67]
    buffer_load_dwordx4 v148, s[12:15], s42 offen lds
    v_mfma_f32_16x16x32_bf16 v[68:71], v[132:135], a[100:103], v[68:71]
    buffer_load_dwordx4 v148, s[12:15], s43 offen offset:1024 lds
    v_mfma_f32_16x16x32_bf16 v[72:75], v[136:139], a[100:103], v[72:75]
    buffer_load_dwordx4 v148, s[12:15], s44 offen offset:2048 lds
    v_mfma_f32_16x16x32_bf16 v[76:79], v[140:143], a[100:103], v[76:79]
    buffer_load_dwordx4 v148, s[12:15], s45 offen offset:3072 lds
    v_mfma_f32_16x16x32_bf16 v[80:83], v[128:131], a[104:107], v[80:83]
    v_mfma_f32_16x16x32_bf16 v[84:87], v[132:135], a[104:107], v[84:87]
    v_mfma_f32_16x16x32_bf16 v[88:91], v[136:139], a[104:107], v[88:91]
    v_mfma_f32_16x16x32_bf16 v[92:95], v[140:143], a[104:107], v[92:95]
    v_mfma_f32_16x16x32_bf16 v[96:99], v[128:131], a[108:111], v[96:99]
    v_mfma_f32_16x16x32_bf16 v[100:103], v[132:135], a[108:111], v[100:103]
    v_mfma_f32_16x16x32_bf16 v[104:107], v[136:139], a[108:111], v[104:107]
    s_waitcnt lgkmcnt(0)
    s_waitcnt vmcnt(26)
    s_add_u32 s40, s46, 10616832
    v_mfma_f32_16x16x32_bf16 v[108:111], v[140:143], a[108:111], v[108:111]
    s_add_u32 s41, s46, 10620928
    v_mfma_f32_16x16x32_bf16 v[0:3], v[112:115], a[0:3], v[0:3]
    v_mfma_f32_16x16x32_bf16 v[4:7], v[116:119], a[0:3], v[4:7]
    buffer_load_dwordx4 a[84:87], v149, s[8:11], s40 offen
    v_mfma_f32_16x16x32_bf16 v[8:11], v[120:123], a[0:3], v[8:11]
    buffer_load_dwordx4 a[88:91], v149, s[8:11], s40 offen offset:1024
    v_mfma_f32_16x16x32_bf16 v[12:15], v[124:127], a[0:3], v[12:15]
    buffer_load_dwordx4 a[92:95], v149, s[8:11], s40 offen offset:2048
    v_mfma_f32_16x16x32_bf16 v[16:19], v[112:115], a[4:7], v[16:19]
    buffer_load_dwordx4 a[96:99], v149, s[8:11], s40 offen offset:3072
    v_mfma_f32_16x16x32_bf16 v[20:23], v[116:119], a[4:7], v[20:23]
    ds_read_b64_tr_b16 v[128:129], v144 offset:4096
    v_mfma_f32_16x16x32_bf16 v[24:27], v[120:123], a[4:7], v[24:27]
    ds_read_b64_tr_b16 v[130:131], v144 offset:6144
    v_mfma_f32_16x16x32_bf16 v[28:31], v[124:127], a[4:7], v[28:31]
    ds_read_b64_tr_b16 v[132:133], v145 offset:4096
    v_mfma_f32_16x16x32_bf16 v[32:35], v[112:115], a[8:11], v[32:35]
    ds_read_b64_tr_b16 v[134:135], v145 offset:6144
    v_mfma_f32_16x16x32_bf16 v[36:39], v[116:119], a[8:11], v[36:39]
    ds_read_b64_tr_b16 v[136:137], v146 offset:4096
    v_mfma_f32_16x16x32_bf16 v[40:43], v[120:123], a[8:11], v[40:43]
    buffer_load_dwordx4 a[100:103], v149, s[8:11], s41 offen
    v_mfma_f32_16x16x32_bf16 v[44:47], v[124:127], a[8:11], v[44:47]
    ds_read_b64_tr_b16 v[138:139], v146 offset:6144
    v_mfma_f32_16x16x32_bf16 v[48:51], v[112:115], a[12:15], v[48:51]
    ds_read_b64_tr_b16 v[140:141], v147 offset:4096
    v_mfma_f32_16x16x32_bf16 v[52:55], v[116:119], a[12:15], v[52:55]
    ds_read_b64_tr_b16 v[142:143], v147 offset:6144
    v_mfma_f32_16x16x32_bf16 v[56:59], v[120:123], a[12:15], v[56:59]
    buffer_load_dwordx4 a[104:107], v149, s[8:11], s41 offen offset:1024
    v_mfma_f32_16x16x32_bf16 v[60:63], v[124:127], a[12:15], v[60:63]
    buffer_load_dwordx4 a[108:111], v149, s[8:11], s41 offen offset:2048
    s_add_u32 m0, s29, 20480
    s_add_u32 s42, s47, 4276224
    s_add_u32 s43, s47, 4284416
    s_add_u32 s44, s47, 4292608
    s_add_u32 s45, s47, 4300800
    v_mfma_f32_16x16x32_bf16 v[64:67], v[112:115], a[16:19], v[64:67]
    buffer_load_dwordx4 v148, s[12:15], s42 offen lds
    v_mfma_f32_16x16x32_bf16 v[68:71], v[116:119], a[16:19], v[68:71]
    buffer_load_dwordx4 v148, s[12:15], s43 offen offset:1024 lds
    v_mfma_f32_16x16x32_bf16 v[72:75], v[120:123], a[16:19], v[72:75]
    buffer_load_dwordx4 v148, s[12:15], s44 offen offset:2048 lds
    v_mfma_f32_16x16x32_bf16 v[76:79], v[124:127], a[16:19], v[76:79]
    buffer_load_dwordx4 v148, s[12:15], s45 offen offset:3072 lds
    v_mfma_f32_16x16x32_bf16 v[80:83], v[112:115], a[20:23], v[80:83]
    v_mfma_f32_16x16x32_bf16 v[84:87], v[116:119], a[20:23], v[84:87]
    v_mfma_f32_16x16x32_bf16 v[88:91], v[120:123], a[20:23], v[88:91]
    v_mfma_f32_16x16x32_bf16 v[92:95], v[124:127], a[20:23], v[92:95]
    v_mfma_f32_16x16x32_bf16 v[96:99], v[112:115], a[24:27], v[96:99]
    v_mfma_f32_16x16x32_bf16 v[100:103], v[116:119], a[24:27], v[100:103]
    v_mfma_f32_16x16x32_bf16 v[104:107], v[120:123], a[24:27], v[104:107]
    s_waitcnt lgkmcnt(0)
    s_waitcnt vmcnt(26)
    s_add_u32 s40, s46, 11010048
    v_mfma_f32_16x16x32_bf16 v[108:111], v[124:127], a[24:27], v[108:111]
    s_add_u32 s41, s46, 11014144
    v_mfma_f32_16x16x32_bf16 v[0:3], v[128:131], a[28:31], v[0:3]
    v_mfma_f32_16x16x32_bf16 v[4:7], v[132:135], a[28:31], v[4:7]
    buffer_load_dwordx4 a[0:3], v149, s[8:11], s40 offen
    v_mfma_f32_16x16x32_bf16 v[8:11], v[136:139], a[28:31], v[8:11]
    buffer_load_dwordx4 a[4:7], v149, s[8:11], s40 offen offset:1024
    v_mfma_f32_16x16x32_bf16 v[12:15], v[140:143], a[28:31], v[12:15]
    buffer_load_dwordx4 a[8:11], v149, s[8:11], s40 offen offset:2048
    v_mfma_f32_16x16x32_bf16 v[16:19], v[128:131], a[32:35], v[16:19]
    buffer_load_dwordx4 a[12:15], v149, s[8:11], s40 offen offset:3072
    v_mfma_f32_16x16x32_bf16 v[20:23], v[132:135], a[32:35], v[20:23]
    ds_read_b64_tr_b16 v[112:113], v144 offset:8192
    v_mfma_f32_16x16x32_bf16 v[24:27], v[136:139], a[32:35], v[24:27]
    ds_read_b64_tr_b16 v[114:115], v144 offset:10240
    v_mfma_f32_16x16x32_bf16 v[28:31], v[140:143], a[32:35], v[28:31]
    ds_read_b64_tr_b16 v[116:117], v145 offset:8192
    v_mfma_f32_16x16x32_bf16 v[32:35], v[128:131], a[36:39], v[32:35]
    ds_read_b64_tr_b16 v[118:119], v145 offset:10240
    v_mfma_f32_16x16x32_bf16 v[36:39], v[132:135], a[36:39], v[36:39]
    ds_read_b64_tr_b16 v[120:121], v146 offset:8192
    v_mfma_f32_16x16x32_bf16 v[40:43], v[136:139], a[36:39], v[40:43]
    buffer_load_dwordx4 a[16:19], v149, s[8:11], s41 offen
    v_mfma_f32_16x16x32_bf16 v[44:47], v[140:143], a[36:39], v[44:47]
    ds_read_b64_tr_b16 v[122:123], v146 offset:10240
    v_mfma_f32_16x16x32_bf16 v[48:51], v[128:131], a[40:43], v[48:51]
    ds_read_b64_tr_b16 v[124:125], v147 offset:8192
    v_mfma_f32_16x16x32_bf16 v[52:55], v[132:135], a[40:43], v[52:55]
    ds_read_b64_tr_b16 v[126:127], v147 offset:10240
    v_mfma_f32_16x16x32_bf16 v[56:59], v[136:139], a[40:43], v[56:59]
    buffer_load_dwordx4 a[20:23], v149, s[8:11], s41 offen offset:1024
    v_mfma_f32_16x16x32_bf16 v[60:63], v[140:143], a[40:43], v[60:63]
    buffer_load_dwordx4 a[24:27], v149, s[8:11], s41 offen offset:2048
    s_add_u32 m0, s29, 0
    s_add_u32 s42, s47, 4423680
    s_add_u32 s43, s47, 4431872
    s_add_u32 s44, s47, 4440064
    s_add_u32 s45, s47, 4448256
    v_mfma_f32_16x16x32_bf16 v[64:67], v[128:131], a[44:47], v[64:67]
    buffer_load_dwordx4 v148, s[12:15], s42 offen lds
    v_mfma_f32_16x16x32_bf16 v[68:71], v[132:135], a[44:47], v[68:71]
    buffer_load_dwordx4 v148, s[12:15], s43 offen offset:1024 lds
    v_mfma_f32_16x16x32_bf16 v[72:75], v[136:139], a[44:47], v[72:75]
    buffer_load_dwordx4 v148, s[12:15], s44 offen offset:2048 lds
    v_mfma_f32_16x16x32_bf16 v[76:79], v[140:143], a[44:47], v[76:79]
    buffer_load_dwordx4 v148, s[12:15], s45 offen offset:3072 lds
    v_mfma_f32_16x16x32_bf16 v[80:83], v[128:131], a[48:51], v[80:83]
    v_mfma_f32_16x16x32_bf16 v[84:87], v[132:135], a[48:51], v[84:87]
    v_mfma_f32_16x16x32_bf16 v[88:91], v[136:139], a[48:51], v[88:91]
    v_mfma_f32_16x16x32_bf16 v[92:95], v[140:143], a[48:51], v[92:95]
    v_mfma_f32_16x16x32_bf16 v[96:99], v[128:131], a[52:55], v[96:99]
    v_mfma_f32_16x16x32_bf16 v[100:103], v[132:135], a[52:55], v[100:103]
    v_mfma_f32_16x16x32_bf16 v[104:107], v[136:139], a[52:55], v[104:107]
    s_waitcnt lgkmcnt(0)
    s_waitcnt vmcnt(26)
    s_add_u32 s40, s46, 11403264
    v_mfma_f32_16x16x32_bf16 v[108:111], v[140:143], a[52:55], v[108:111]
    s_add_u32 s41, s46, 11407360
    v_mfma_f32_16x16x32_bf16 v[0:3], v[112:115], a[56:59], v[0:3]
    v_mfma_f32_16x16x32_bf16 v[4:7], v[116:119], a[56:59], v[4:7]
    buffer_load_dwordx4 a[28:31], v149, s[8:11], s40 offen
    v_mfma_f32_16x16x32_bf16 v[8:11], v[120:123], a[56:59], v[8:11]
    buffer_load_dwordx4 a[32:35], v149, s[8:11], s40 offen offset:1024
    v_mfma_f32_16x16x32_bf16 v[12:15], v[124:127], a[56:59], v[12:15]
    buffer_load_dwordx4 a[36:39], v149, s[8:11], s40 offen offset:2048
    v_mfma_f32_16x16x32_bf16 v[16:19], v[112:115], a[60:63], v[16:19]
    buffer_load_dwordx4 a[40:43], v149, s[8:11], s40 offen offset:3072
    v_mfma_f32_16x16x32_bf16 v[20:23], v[116:119], a[60:63], v[20:23]
    ds_read_b64_tr_b16 v[128:129], v144 offset:12288
    v_mfma_f32_16x16x32_bf16 v[24:27], v[120:123], a[60:63], v[24:27]
    ds_read_b64_tr_b16 v[130:131], v144 offset:14336
    v_mfma_f32_16x16x32_bf16 v[28:31], v[124:127], a[60:63], v[28:31]
    ds_read_b64_tr_b16 v[132:133], v145 offset:12288
    v_mfma_f32_16x16x32_bf16 v[32:35], v[112:115], a[64:67], v[32:35]
    ds_read_b64_tr_b16 v[134:135], v145 offset:14336
    v_mfma_f32_16x16x32_bf16 v[36:39], v[116:119], a[64:67], v[36:39]
    ds_read_b64_tr_b16 v[136:137], v146 offset:12288
    v_mfma_f32_16x16x32_bf16 v[40:43], v[120:123], a[64:67], v[40:43]
    buffer_load_dwordx4 a[44:47], v149, s[8:11], s41 offen
    v_mfma_f32_16x16x32_bf16 v[44:47], v[124:127], a[64:67], v[44:47]
    ds_read_b64_tr_b16 v[138:139], v146 offset:14336
    v_mfma_f32_16x16x32_bf16 v[48:51], v[112:115], a[68:71], v[48:51]
    ds_read_b64_tr_b16 v[140:141], v147 offset:12288
    v_mfma_f32_16x16x32_bf16 v[52:55], v[116:119], a[68:71], v[52:55]
    ds_read_b64_tr_b16 v[142:143], v147 offset:14336
    v_mfma_f32_16x16x32_bf16 v[56:59], v[120:123], a[68:71], v[56:59]
    buffer_load_dwordx4 a[48:51], v149, s[8:11], s41 offen offset:1024
    v_mfma_f32_16x16x32_bf16 v[60:63], v[124:127], a[68:71], v[60:63]
    buffer_load_dwordx4 a[52:55], v149, s[8:11], s41 offen offset:2048
    s_add_u32 m0, s29, 4096
    s_add_u32 s42, s47, 4571136
    s_add_u32 s43, s47, 4579328
    s_add_u32 s44, s47, 4587520
    s_add_u32 s45, s47, 4595712
    v_mfma_f32_16x16x32_bf16 v[64:67], v[112:115], a[72:75], v[64:67]
    buffer_load_dwordx4 v148, s[12:15], s42 offen lds
    v_mfma_f32_16x16x32_bf16 v[68:71], v[116:119], a[72:75], v[68:71]
    buffer_load_dwordx4 v148, s[12:15], s43 offen offset:1024 lds
    v_mfma_f32_16x16x32_bf16 v[72:75], v[120:123], a[72:75], v[72:75]
    buffer_load_dwordx4 v148, s[12:15], s44 offen offset:2048 lds
    v_mfma_f32_16x16x32_bf16 v[76:79], v[124:127], a[72:75], v[76:79]
    buffer_load_dwordx4 v148, s[12:15], s45 offen offset:3072 lds
    v_mfma_f32_16x16x32_bf16 v[80:83], v[112:115], a[76:79], v[80:83]
    v_mfma_f32_16x16x32_bf16 v[84:87], v[116:119], a[76:79], v[84:87]
    v_mfma_f32_16x16x32_bf16 v[88:91], v[120:123], a[76:79], v[88:91]
    v_mfma_f32_16x16x32_bf16 v[92:95], v[124:127], a[76:79], v[92:95]
    v_mfma_f32_16x16x32_bf16 v[96:99], v[112:115], a[80:83], v[96:99]
    v_mfma_f32_16x16x32_bf16 v[100:103], v[116:119], a[80:83], v[100:103]
    v_mfma_f32_16x16x32_bf16 v[104:107], v[120:123], a[80:83], v[104:107]
    s_waitcnt lgkmcnt(0)
    s_waitcnt vmcnt(26)
    s_add_u32 s40, s46, 11796480
    v_mfma_f32_16x16x32_bf16 v[108:111], v[124:127], a[80:83], v[108:111]
    s_add_u32 s41, s46, 11800576
    v_mfma_f32_16x16x32_bf16 v[0:3], v[128:131], a[84:87], v[0:3]
    v_mfma_f32_16x16x32_bf16 v[4:7], v[132:135], a[84:87], v[4:7]
    buffer_load_dwordx4 a[56:59], v149, s[8:11], s40 offen
    v_mfma_f32_16x16x32_bf16 v[8:11], v[136:139], a[84:87], v[8:11]
    buffer_load_dwordx4 a[60:63], v149, s[8:11], s40 offen offset:1024
    v_mfma_f32_16x16x32_bf16 v[12:15], v[140:143], a[84:87], v[12:15]
    buffer_load_dwordx4 a[64:67], v149, s[8:11], s40 offen offset:2048
    v_mfma_f32_16x16x32_bf16 v[16:19], v[128:131], a[88:91], v[16:19]
    buffer_load_dwordx4 a[68:71], v149, s[8:11], s40 offen offset:3072
    v_mfma_f32_16x16x32_bf16 v[20:23], v[132:135], a[88:91], v[20:23]
    ds_read_b64_tr_b16 v[112:113], v144 offset:16384
    v_mfma_f32_16x16x32_bf16 v[24:27], v[136:139], a[88:91], v[24:27]
    ds_read_b64_tr_b16 v[114:115], v144 offset:18432
    v_mfma_f32_16x16x32_bf16 v[28:31], v[140:143], a[88:91], v[28:31]
    ds_read_b64_tr_b16 v[116:117], v145 offset:16384
    v_mfma_f32_16x16x32_bf16 v[32:35], v[128:131], a[92:95], v[32:35]
    ds_read_b64_tr_b16 v[118:119], v145 offset:18432
    v_mfma_f32_16x16x32_bf16 v[36:39], v[132:135], a[92:95], v[36:39]
    ds_read_b64_tr_b16 v[120:121], v146 offset:16384
    v_mfma_f32_16x16x32_bf16 v[40:43], v[136:139], a[92:95], v[40:43]
    buffer_load_dwordx4 a[72:75], v149, s[8:11], s41 offen
    v_mfma_f32_16x16x32_bf16 v[44:47], v[140:143], a[92:95], v[44:47]
    ds_read_b64_tr_b16 v[122:123], v146 offset:18432
    v_mfma_f32_16x16x32_bf16 v[48:51], v[128:131], a[96:99], v[48:51]
    ds_read_b64_tr_b16 v[124:125], v147 offset:16384
    v_mfma_f32_16x16x32_bf16 v[52:55], v[132:135], a[96:99], v[52:55]
    ds_read_b64_tr_b16 v[126:127], v147 offset:18432
    v_mfma_f32_16x16x32_bf16 v[56:59], v[136:139], a[96:99], v[56:59]
    buffer_load_dwordx4 a[76:79], v149, s[8:11], s41 offen offset:1024
    v_mfma_f32_16x16x32_bf16 v[60:63], v[140:143], a[96:99], v[60:63]
    buffer_load_dwordx4 a[80:83], v149, s[8:11], s41 offen offset:2048
    v_mfma_f32_16x16x32_bf16 v[64:67], v[128:131], a[100:103], v[64:67]
    v_mfma_f32_16x16x32_bf16 v[68:71], v[132:135], a[100:103], v[68:71]
    v_mfma_f32_16x16x32_bf16 v[72:75], v[136:139], a[100:103], v[72:75]
    v_mfma_f32_16x16x32_bf16 v[76:79], v[140:143], a[100:103], v[76:79]
    v_mfma_f32_16x16x32_bf16 v[80:83], v[128:131], a[104:107], v[80:83]
    v_mfma_f32_16x16x32_bf16 v[84:87], v[132:135], a[104:107], v[84:87]
    v_mfma_f32_16x16x32_bf16 v[88:91], v[136:139], a[104:107], v[88:91]
    v_mfma_f32_16x16x32_bf16 v[92:95], v[140:143], a[104:107], v[92:95]
    v_mfma_f32_16x16x32_bf16 v[96:99], v[128:131], a[108:111], v[96:99]
    v_mfma_f32_16x16x32_bf16 v[100:103], v[132:135], a[108:111], v[100:103]
    v_mfma_f32_16x16x32_bf16 v[104:107], v[136:139], a[108:111], v[104:107]
    s_waitcnt lgkmcnt(0)
    s_waitcnt vmcnt(22)
    s_add_u32 s40, s46, 12189696
    v_mfma_f32_16x16x32_bf16 v[108:111], v[140:143], a[108:111], v[108:111]
    s_add_u32 s41, s46, 12193792
    v_mfma_f32_16x16x32_bf16 v[0:3], v[112:115], a[0:3], v[0:3]
    v_mfma_f32_16x16x32_bf16 v[4:7], v[116:119], a[0:3], v[4:7]
    buffer_load_dwordx4 a[84:87], v149, s[8:11], s40 offen
    v_mfma_f32_16x16x32_bf16 v[8:11], v[120:123], a[0:3], v[8:11]
    buffer_load_dwordx4 a[88:91], v149, s[8:11], s40 offen offset:1024
    v_mfma_f32_16x16x32_bf16 v[12:15], v[124:127], a[0:3], v[12:15]
    buffer_load_dwordx4 a[92:95], v149, s[8:11], s40 offen offset:2048
    v_mfma_f32_16x16x32_bf16 v[16:19], v[112:115], a[4:7], v[16:19]
    buffer_load_dwordx4 a[96:99], v149, s[8:11], s40 offen offset:3072
    v_mfma_f32_16x16x32_bf16 v[20:23], v[116:119], a[4:7], v[20:23]
    ds_read_b64_tr_b16 v[128:129], v144 offset:20480
    v_mfma_f32_16x16x32_bf16 v[24:27], v[120:123], a[4:7], v[24:27]
    ds_read_b64_tr_b16 v[130:131], v144 offset:22528
    v_mfma_f32_16x16x32_bf16 v[28:31], v[124:127], a[4:7], v[28:31]
    ds_read_b64_tr_b16 v[132:133], v145 offset:20480
    v_mfma_f32_16x16x32_bf16 v[32:35], v[112:115], a[8:11], v[32:35]
    ds_read_b64_tr_b16 v[134:135], v145 offset:22528
    v_mfma_f32_16x16x32_bf16 v[36:39], v[116:119], a[8:11], v[36:39]
    ds_read_b64_tr_b16 v[136:137], v146 offset:20480
    v_mfma_f32_16x16x32_bf16 v[40:43], v[120:123], a[8:11], v[40:43]
    buffer_load_dwordx4 a[100:103], v149, s[8:11], s41 offen
    v_mfma_f32_16x16x32_bf16 v[44:47], v[124:127], a[8:11], v[44:47]
    ds_read_b64_tr_b16 v[138:139], v146 offset:22528
    v_mfma_f32_16x16x32_bf16 v[48:51], v[112:115], a[12:15], v[48:51]
    ds_read_b64_tr_b16 v[140:141], v147 offset:20480
    v_mfma_f32_16x16x32_bf16 v[52:55], v[116:119], a[12:15], v[52:55]
    ds_read_b64_tr_b16 v[142:143], v147 offset:22528
    v_mfma_f32_16x16x32_bf16 v[56:59], v[120:123], a[12:15], v[56:59]
    buffer_load_dwordx4 a[104:107], v149, s[8:11], s41 offen offset:1024
    v_mfma_f32_16x16x32_bf16 v[60:63], v[124:127], a[12:15], v[60:63]
    buffer_load_dwordx4 a[108:111], v149, s[8:11], s41 offen offset:2048
    v_mfma_f32_16x16x32_bf16 v[64:67], v[112:115], a[16:19], v[64:67]
    v_mfma_f32_16x16x32_bf16 v[68:71], v[116:119], a[16:19], v[68:71]
    v_mfma_f32_16x16x32_bf16 v[72:75], v[120:123], a[16:19], v[72:75]
    v_mfma_f32_16x16x32_bf16 v[76:79], v[124:127], a[16:19], v[76:79]
    v_mfma_f32_16x16x32_bf16 v[80:83], v[112:115], a[20:23], v[80:83]
    v_mfma_f32_16x16x32_bf16 v[84:87], v[116:119], a[20:23], v[84:87]
    v_mfma_f32_16x16x32_bf16 v[88:91], v[120:123], a[20:23], v[88:91]
    v_mfma_f32_16x16x32_bf16 v[92:95], v[124:127], a[20:23], v[92:95]
    v_mfma_f32_16x16x32_bf16 v[96:99], v[112:115], a[24:27], v[96:99]
    v_mfma_f32_16x16x32_bf16 v[100:103], v[116:119], a[24:27], v[100:103]
    v_mfma_f32_16x16x32_bf16 v[104:107], v[120:123], a[24:27], v[104:107]
    s_waitcnt lgkmcnt(0)
    s_waitcnt vmcnt(18)
    v_mfma_f32_16x16x32_bf16 v[108:111], v[124:127], a[24:27], v[108:111]
    v_mfma_f32_16x16x32_bf16 v[0:3], v[128:131], a[28:31], v[0:3]
    v_mfma_f32_16x16x32_bf16 v[4:7], v[132:135], a[28:31], v[4:7]
    v_mfma_f32_16x16x32_bf16 v[8:11], v[136:139], a[28:31], v[8:11]
    v_mfma_f32_16x16x32_bf16 v[12:15], v[140:143], a[28:31], v[12:15]
    v_mfma_f32_16x16x32_bf16 v[16:19], v[128:131], a[32:35], v[16:19]
    v_mfma_f32_16x16x32_bf16 v[20:23], v[132:135], a[32:35], v[20:23]
    ds_read_b64_tr_b16 v[112:113], v144
    v_mfma_f32_16x16x32_bf16 v[24:27], v[136:139], a[32:35], v[24:27]
    ds_read_b64_tr_b16 v[114:115], v144 offset:2048
    v_mfma_f32_16x16x32_bf16 v[28:31], v[140:143], a[32:35], v[28:31]
    ds_read_b64_tr_b16 v[116:117], v145
    v_mfma_f32_16x16x32_bf16 v[32:35], v[128:131], a[36:39], v[32:35]
    ds_read_b64_tr_b16 v[118:119], v145 offset:2048
    v_mfma_f32_16x16x32_bf16 v[36:39], v[132:135], a[36:39], v[36:39]
    ds_read_b64_tr_b16 v[120:121], v146
    v_mfma_f32_16x16x32_bf16 v[40:43], v[136:139], a[36:39], v[40:43]
    ds_read_b64_tr_b16 v[122:123], v146 offset:2048
    v_mfma_f32_16x16x32_bf16 v[44:47], v[140:143], a[36:39], v[44:47]
    ds_read_b64_tr_b16 v[124:125], v147
    v_mfma_f32_16x16x32_bf16 v[48:51], v[128:131], a[40:43], v[48:51]
    ds_read_b64_tr_b16 v[126:127], v147 offset:2048
    v_mfma_f32_16x16x32_bf16 v[52:55], v[132:135], a[40:43], v[52:55]
    v_mfma_f32_16x16x32_bf16 v[56:59], v[136:139], a[40:43], v[56:59]
    v_mfma_f32_16x16x32_bf16 v[60:63], v[140:143], a[40:43], v[60:63]
    v_mfma_f32_16x16x32_bf16 v[64:67], v[128:131], a[44:47], v[64:67]
    v_mfma_f32_16x16x32_bf16 v[68:71], v[132:135], a[44:47], v[68:71]
    v_mfma_f32_16x16x32_bf16 v[72:75], v[136:139], a[44:47], v[72:75]
    v_mfma_f32_16x16x32_bf16 v[76:79], v[140:143], a[44:47], v[76:79]
    v_mfma_f32_16x16x32_bf16 v[80:83], v[128:131], a[48:51], v[80:83]
    v_mfma_f32_16x16x32_bf16 v[84:87], v[132:135], a[48:51], v[84:87]
    v_mfma_f32_16x16x32_bf16 v[88:91], v[136:139], a[48:51], v[88:91]
    v_mfma_f32_16x16x32_bf16 v[92:95], v[140:143], a[48:51], v[92:95]
    v_mfma_f32_16x16x32_bf16 v[96:99], v[128:131], a[52:55], v[96:99]
    v_mfma_f32_16x16x32_bf16 v[100:103], v[132:135], a[52:55], v[100:103]
    v_mfma_f32_16x16x32_bf16 v[104:107], v[136:139], a[52:55], v[104:107]
    s_waitcnt lgkmcnt(0)
    s_waitcnt vmcnt(7)
    v_mfma_f32_16x16x32_bf16 v[108:111], v[140:143], a[52:55], v[108:111]
    v_mfma_f32_16x16x32_bf16 v[0:3], v[112:115], a[56:59], v[0:3]
    v_mfma_f32_16x16x32_bf16 v[4:7], v[116:119], a[56:59], v[4:7]
    v_mfma_f32_16x16x32_bf16 v[8:11], v[120:123], a[56:59], v[8:11]
    v_mfma_f32_16x16x32_bf16 v[12:15], v[124:127], a[56:59], v[12:15]
    v_mfma_f32_16x16x32_bf16 v[16:19], v[112:115], a[60:63], v[16:19]
    v_mfma_f32_16x16x32_bf16 v[20:23], v[116:119], a[60:63], v[20:23]
    ds_read_b64_tr_b16 v[128:129], v144 offset:4096
    v_mfma_f32_16x16x32_bf16 v[24:27], v[120:123], a[60:63], v[24:27]
    ds_read_b64_tr_b16 v[130:131], v144 offset:6144
    v_mfma_f32_16x16x32_bf16 v[28:31], v[124:127], a[60:63], v[28:31]
    ds_read_b64_tr_b16 v[132:133], v145 offset:4096
    v_mfma_f32_16x16x32_bf16 v[32:35], v[112:115], a[64:67], v[32:35]
    ds_read_b64_tr_b16 v[134:135], v145 offset:6144
    v_mfma_f32_16x16x32_bf16 v[36:39], v[116:119], a[64:67], v[36:39]
    ds_read_b64_tr_b16 v[136:137], v146 offset:4096
    v_mfma_f32_16x16x32_bf16 v[40:43], v[120:123], a[64:67], v[40:43]
    ds_read_b64_tr_b16 v[138:139], v146 offset:6144
    v_mfma_f32_16x16x32_bf16 v[44:47], v[124:127], a[64:67], v[44:47]
    ds_read_b64_tr_b16 v[140:141], v147 offset:4096
    v_mfma_f32_16x16x32_bf16 v[48:51], v[112:115], a[68:71], v[48:51]
    ds_read_b64_tr_b16 v[142:143], v147 offset:6144
    v_mfma_f32_16x16x32_bf16 v[52:55], v[116:119], a[68:71], v[52:55]
    v_mfma_f32_16x16x32_bf16 v[56:59], v[120:123], a[68:71], v[56:59]
    v_mfma_f32_16x16x32_bf16 v[60:63], v[124:127], a[68:71], v[60:63]
    v_mfma_f32_16x16x32_bf16 v[64:67], v[112:115], a[72:75], v[64:67]
    v_mfma_f32_16x16x32_bf16 v[68:71], v[116:119], a[72:75], v[68:71]
    v_mfma_f32_16x16x32_bf16 v[72:75], v[120:123], a[72:75], v[72:75]
    v_mfma_f32_16x16x32_bf16 v[76:79], v[124:127], a[72:75], v[76:79]
    v_mfma_f32_16x16x32_bf16 v[80:83], v[112:115], a[76:79], v[80:83]
    v_mfma_f32_16x16x32_bf16 v[84:87], v[116:119], a[76:79], v[84:87]
    v_mfma_f32_16x16x32_bf16 v[88:91], v[120:123], a[76:79], v[88:91]
    v_mfma_f32_16x16x32_bf16 v[92:95], v[124:127], a[76:79], v[92:95]
    v_mfma_f32_16x16x32_bf16 v[96:99], v[112:115], a[80:83], v[96:99]
    v_mfma_f32_16x16x32_bf16 v[100:103], v[116:119], a[80:83], v[100:103]
    v_mfma_f32_16x16x32_bf16 v[104:107], v[120:123], a[80:83], v[104:107]
    s_waitcnt lgkmcnt(0)
    s_waitcnt vmcnt(0)
    v_mfma_f32_16x16x32_bf16 v[108:111], v[124:127], a[80:83], v[108:111]
    v_mfma_f32_16x16x32_bf16 v[0:3], v[128:131], a[84:87], v[0:3]
    v_mfma_f32_16x16x32_bf16 v[4:7], v[132:135], a[84:87], v[4:7]
    v_mfma_f32_16x16x32_bf16 v[8:11], v[136:139], a[84:87], v[8:11]
    v_mfma_f32_16x16x32_bf16 v[12:15], v[140:143], a[84:87], v[12:15]
    v_mfma_f32_16x16x32_bf16 v[16:19], v[128:131], a[88:91], v[16:19]
    v_mfma_f32_16x16x32_bf16 v[20:23], v[132:135], a[88:91], v[20:23]
    v_mfma_f32_16x16x32_bf16 v[24:27], v[136:139], a[88:91], v[24:27]
    v_mfma_f32_16x16x32_bf16 v[28:31], v[140:143], a[88:91], v[28:31]
    v_mfma_f32_16x16x32_bf16 v[32:35], v[128:131], a[92:95], v[32:35]
    v_mfma_f32_16x16x32_bf16 v[36:39], v[132:135], a[92:95], v[36:39]
    v_mfma_f32_16x16x32_bf16 v[40:43], v[136:139], a[92:95], v[40:43]
    v_mfma_f32_16x16x32_bf16 v[44:47], v[140:143], a[92:95], v[44:47]
    v_mfma_f32_16x16x32_bf16 v[48:51], v[128:131], a[96:99], v[48:51]
    v_mfma_f32_16x16x32_bf16 v[52:55], v[132:135], a[96:99], v[52:55]
    v_mfma_f32_16x16x32_bf16 v[56:59], v[136:139], a[96:99], v[56:59]
    v_mfma_f32_16x16x32_bf16 v[60:63], v[140:143], a[96:99], v[60:63]
    v_mfma_f32_16x16x32_bf16 v[64:67], v[128:131], a[100:103], v[64:67]
    v_mfma_f32_16x16x32_bf16 v[68:71], v[132:135], a[100:103], v[68:71]
    v_mfma_f32_16x16x32_bf16 v[72:75], v[136:139], a[100:103], v[72:75]
    v_mfma_f32_16x16x32_bf16 v[76:79], v[140:143], a[100:103], v[76:79]
    v_mfma_f32_16x16x32_bf16 v[80:83], v[128:131], a[104:107], v[80:83]
    v_mfma_f32_16x16x32_bf16 v[84:87], v[132:135], a[104:107], v[84:87]
    v_mfma_f32_16x16x32_bf16 v[88:91], v[136:139], a[104:107], v[88:91]
    v_mfma_f32_16x16x32_bf16 v[92:95], v[140:143], a[104:107], v[92:95]
    v_mfma_f32_16x16x32_bf16 v[96:99], v[128:131], a[108:111], v[96:99]
    v_mfma_f32_16x16x32_bf16 v[100:103], v[132:135], a[108:111], v[100:103]
    v_mfma_f32_16x16x32_bf16 v[104:107], v[136:139], a[108:111], v[104:107]
    v_mfma_f32_16x16x32_bf16 v[108:111], v[140:143], a[108:111], v[108:111]
    s_nop 7
    s_barrier
    v_add_u32 v152, 65536, v149
    s_cmp_eq_u32 s3, 0
    s_cbranch_scc0 L_k2_w0
    ds_write_b128 v149, v[4:7] offset:5120
    ds_write_b128 v149, v[8:11] offset:7168
    ds_write_b128 v149, v[12:15] offset:9216
    ds_write_b128 v149, v[20:23] offset:17408
    ds_write_b128 v149, v[24:27] offset:19456
    ds_write_b128 v149, v[28:31] offset:21504
    ds_write_b128 v149, v[36:39] offset:29696
    ds_write_b128 v149, v[40:43] offset:31744
    ds_write_b128 v149, v[44:47] offset:33792
    ds_write_b128 v149, v[52:55] offset:41984
    ds_write_b128 v149, v[56:59] offset:44032
    ds_write_b128 v149, v[60:63] offset:46080
    ds_write_b128 v149, v[68:71] offset:54272
    ds_write_b128 v149, v[72:75] offset:56320
    ds_write_b128 v149, v[76:79] offset:58368
    ds_write_b128 v152, v[84:87] offset:1024
    ds_write_b128 v152, v[88:91] offset:3072
    ds_write_b128 v152, v[92:95] offset:5120
    ds_write_b128 v152, v[100:103] offset:13312
    ds_write_b128 v152, v[104:107] offset:15360
    ds_write_b128 v152, v[108:111] offset:17408
L_k2_w0:
    s_cmp_eq_u32 s3, 1
    s_cbranch_scc0 L_k2_w1
    ds_write_b128 v149, v[0:3]
    ds_write_b128 v149, v[8:11] offset:8192
    ds_write_b128 v149, v[12:15] offset:10240
    ds_write_b128 v149, v[16:19] offset:12288
    ds_write_b128 v149, v[24:27] offset:20480
    ds_write_b128 v149, v[28:31] offset:22528
    ds_write_b128 v149, v[32:35] offset:24576
    ds_write_b128 v149, v[40:43] offset:32768
    ds_write_b128 v149, v[44:47] offset:34816
    ds_write_b128 v149, v[48:51] offset:36864
    ds_write_b128 v149, v[56:59] offset:45056
    ds_write_b128 v149, v[60:63] offset:47104
    ds_write_b128 v149, v[64:67] offset:49152
    ds_write_b128 v149, v[72:75] offset:57344
    ds_write_b128 v149, v[76:79] offset:59392
    ds_write_b128 v149, v[80:83] offset:61440
    ds_write_b128 v152, v[88:91] offset:4096
    ds_write_b128 v152, v[92:95] offset:6144
    ds_write_b128 v152, v[96:99] offset:8192
    ds_write_b128 v152, v[104:107] offset:16384
    ds_write_b128 v152, v[108:111] offset:18432
L_k2_w1:
    s_cmp_eq_u32 s3, 2
    s_cbranch_scc0 L_k2_w2
    ds_write_b128 v149, v[0:3] offset:1024
    ds_write_b128 v149, v[4:7] offset:3072
    ds_write_b128 v149, v[12:15] offset:11264
    ds_write_b128 v149, v[16:19] offset:13312
    ds_write_b128 v149, v[20:23] offset:15360
    ds_write_b128 v149, v[28:31] offset:23552
    ds_write_b128 v149, v[32:35] offset:25600
    ds_write_b128 v149, v[36:39] offset:27648
    ds_write_b128 v149, v[44:47] offset:35840
    ds_write_b128 v149, v[48:51] offset:37888
    ds_write_b128 v149, v[52:55] offset:39936
    ds_write_b128 v149, v[60:63] offset:48128
    ds_write_b128 v149, v[64:67] offset:50176
    ds_write_b128 v149, v[68:71] offset:52224
    ds_write_b128 v149, v[76:79] offset:60416
    ds_write_b128 v149, v[80:83] offset:62464
    ds_write_b128 v149, v[84:87] offset:64512
    ds_write_b128 v152, v[92:95] offset:7168
    ds_write_b128 v152, v[96:99] offset:9216
    ds_write_b128 v152, v[100:103] offset:11264
    ds_write_b128 v152, v[108:111] offset:19456
L_k2_w2:
    s_cmp_eq_u32 s3, 3
    s_cbranch_scc0 L_k2_w3
    ds_write_b128 v149, v[0:3] offset:2048
    ds_write_b128 v149, v[4:7] offset:4096
    ds_write_b128 v149, v[8:11] offset:6144
    ds_write_b128 v149, v[16:19] offset:14336
    ds_write_b128 v149, v[20:23] offset:16384
    ds_write_b128 v149, v[24:27] offset:18432
    ds_write_b128 v149, v[32:35] offset:26624
    ds_write_b128 v149, v[36:39] offset:28672
    ds_write_b128 v149, v[40:43] offset:30720
    ds_write_b128 v149, v[48:51] offset:38912
    ds_write_b128 v149, v[52:55] offset:40960
    ds_write_b128 v149, v[56:59] offset:43008
    ds_write_b128 v149, v[64:67] offset:51200
    ds_write_b128 v149, v[68:71] offset:53248
    ds_write_b128 v149, v[72:75] offset:55296
    ds_write_b128 v149, v[80:83] offset:63488
    ds_write_b128 v152, v[84:87]
    ds_write_b128 v152, v[88:91] offset:2048
    ds_write_b128 v152, v[96:99] offset:10240
    ds_write_b128 v152, v[100:103] offset:12288
    ds_write_b128 v152, v[104:107] offset:14336
L_k2_w3:
    s_waitcnt lgkmcnt(0)
    s_barrier
    s_cmp_eq_u32 s3, 0
    s_cbranch_scc0 L_k2_r0
    ds_read_b128 v[112:115], v149
    ds_read_b128 v[116:119], v149 offset:1024
    ds_read_b128 v[120:123], v149 offset:2048
    ds_read_b128 v[124:127], v149 offset:12288
    ds_read_b128 v[128:131], v149 offset:13312
    ds_read_b128 v[132:135], v149 offset:14336
    ds_read_b128 v[136:139], v149 offset:24576
    ds_read_b128 v[140:143], v149 offset:25600
    ds_read_b128 v[144:147], v149 offset:26624
    s_waitcnt lgkmcnt(6)
    v_add_f32 v0, v0, v112
    v_add_f32 v1, v1, v113
    v_add_f32 v2, v2, v114
    v_add_f32 v3, v3, v115
    v_add_f32 v0, v0, v116
    v_add_f32 v1, v1, v117
    v_add_f32 v2, v2, v118
    v_add_f32 v3, v3, v119
    v_add_f32 v0, v0, v120
    v_add_f32 v1, v1, v121
    v_add_f32 v2, v2, v122
    v_add_f32 v3, v3, v123
    v_cvt_pk_bf16_f32 v160, v0, v1
    v_cvt_pk_bf16_f32 v161, v2, v3
    s_mov_b32 s7, 0
    buffer_store_dwordx2 v[160:161], v150, s[16:19], s7 offen
    ds_read_b128 v[112:115], v149 offset:36864
    ds_read_b128 v[116:119], v149 offset:37888
    ds_read_b128 v[120:123], v149 offset:38912
    s_waitcnt lgkmcnt(6)
    v_add_f32 v16, v16, v124
    v_add_f32 v17, v17, v125
    v_add_f32 v18, v18, v126
    v_add_f32 v19, v19, v127
    v_add_f32 v16, v16, v128
    v_add_f32 v17, v17, v129
    v_add_f32 v18, v18, v130
    v_add_f32 v19, v19, v131
    v_add_f32 v16, v16, v132
    v_add_f32 v17, v17, v133
    v_add_f32 v18, v18, v134
    v_add_f32 v19, v19, v135
    v_cvt_pk_bf16_f32 v162, v16, v17
    v_cvt_pk_bf16_f32 v163, v18, v19
    s_mov_b32 s7, 36864
    buffer_store_dwordx2 v[162:163], v150, s[16:19], s7 offen
    ds_read_b128 v[124:127], v149 offset:49152
    ds_read_b128 v[128:131], v149 offset:50176
    ds_read_b128 v[132:135], v149 offset:51200
    s_waitcnt lgkmcnt(6)
    v_add_f32 v32, v32, v136
    v_add_f32 v33, v33, v137
    v_add_f32 v34, v34, v138
    v_add_f32 v35, v35, v139
    v_add_f32 v32, v32, v140
    v_add_f32 v33, v33, v141
    v_add_f32 v34, v34, v142
    v_add_f32 v35, v35, v143
    v_add_f32 v32, v32, v144
    v_add_f32 v33, v33, v145
    v_add_f32 v34, v34, v146
    v_add_f32 v35, v35, v147
    v_cvt_pk_bf16_f32 v164, v32, v33
    v_cvt_pk_bf16_f32 v165, v34, v35
    s_mov_b32 s7, 73728
    buffer_store_dwordx2 v[164:165], v150, s[16:19], s7 offen
    ds_read_b128 v[136:139], v149 offset:61440
    ds_read_b128 v[140:143], v149 offset:62464
    ds_read_b128 v[144:147], v149 offset:63488
    s_waitcnt lgkmcnt(6)
    v_add_f32 v48, v48, v112
    v_add_f32 v49, v49, v113
    v_add_f32 v50, v50, v114
    v_add_f32 v51, v51, v115
    v_add_f32 v48, v48, v116
    v_add_f32 v49, v49, v117
    v_add_f32 v50, v50, v118
    v_add_f32 v51, v51, v119
    v_add_f32 v48, v48, v120
    v_add_f32 v49, v49, v121
    v_add_f32 v50, v50, v122
    v_add_f32 v51, v51, v123
    v_cvt_pk_bf16_f32 v166, v48, v49
    v_cvt_pk_bf16_f32 v167, v50, v51
    s_mov_b32 s7, 110592
    buffer_store_dwordx2 v[166:167], v150, s[16:19], s7 offen
    ds_read_b128 v[112:115], v152 offset:8192
    ds_read_b128 v[116:119], v152 offset:9216
    ds_read_b128 v[120:123], v152 offset:10240
    s_waitcnt lgkmcnt(6)
    v_add_f32 v64, v64, v124
    v_add_f32 v65, v65, v125
    v_add_f32 v66, v66, v126
    v_add_f32 v67, v67, v127
    v_add_f32 v64, v64, v128
    v_add_f32 v65, v65, v129
    v_add_f32 v66, v66, v130
    v_add_f32 v67, v67, v131
    v_add_f32 v64, v64, v132
    v_add_f32 v65, v65, v133
    v_add_f32 v66, v66, v134
    v_add_f32 v67, v67, v135
    v_cvt_pk_bf16_f32 v160, v64, v65
    v_cvt_pk_bf16_f32 v161, v66, v67
    s_mov_b32 s7, 147456
    buffer_store_dwordx2 v[160:161], v150, s[16:19], s7 offen
    s_waitcnt lgkmcnt(3)
    v_add_f32 v80, v80, v136
    v_add_f32 v81, v81, v137
    v_add_f32 v82, v82, v138
    v_add_f32 v83, v83, v139
    v_add_f32 v80, v80, v140
    v_add_f32 v81, v81, v141
    v_add_f32 v82, v82, v142
    v_add_f32 v83, v83, v143
    v_add_f32 v80, v80, v144
    v_add_f32 v81, v81, v145
    v_add_f32 v82, v82, v146
    v_add_f32 v83, v83, v147
    v_cvt_pk_bf16_f32 v162, v80, v81
    v_cvt_pk_bf16_f32 v163, v82, v83
    s_mov_b32 s7, 184320
    buffer_store_dwordx2 v[162:163], v150, s[16:19], s7 offen
    s_waitcnt lgkmcnt(0)
    v_add_f32 v96, v96, v112
    v_add_f32 v97, v97, v113
    v_add_f32 v98, v98, v114
    v_add_f32 v99, v99, v115
    v_add_f32 v96, v96, v116
    v_add_f32 v97, v97, v117
    v_add_f32 v98, v98, v118
    v_add_f32 v99, v99, v119
    v_add_f32 v96, v96, v120
    v_add_f32 v97, v97, v121
    v_add_f32 v98, v98, v122
    v_add_f32 v99, v99, v123
    v_cvt_pk_bf16_f32 v164, v96, v97
    v_cvt_pk_bf16_f32 v165, v98, v99
    s_mov_b32 s7, 221184
    buffer_store_dwordx2 v[164:165], v150, s[16:19], s7 offen
L_k2_r0:
    s_cmp_eq_u32 s3, 1
    s_cbranch_scc0 L_k2_r1
    ds_read_b128 v[112:115], v149 offset:3072
    ds_read_b128 v[116:119], v149 offset:4096
    ds_read_b128 v[120:123], v149 offset:5120
    ds_read_b128 v[124:127], v149 offset:15360
    ds_read_b128 v[128:131], v149 offset:16384
    ds_read_b128 v[132:135], v149 offset:17408
    ds_read_b128 v[136:139], v149 offset:27648
    ds_read_b128 v[140:143], v149 offset:28672
    ds_read_b128 v[144:147], v149 offset:29696
    s_waitcnt lgkmcnt(6)
    v_add_f32 v4, v4, v112
    v_add_f32 v5, v5, v113
    v_add_f32 v6, v6, v114
    v_add_f32 v7, v7, v115
    v_add_f32 v4, v4, v116
    v_add_f32 v5, v5, v117
    v_add_f32 v6, v6, v118
    v_add_f32 v7, v7, v119
    v_add_f32 v4, v4, v120
    v_add_f32 v5, v5, v121
    v_add_f32 v6, v6, v122
    v_add_f32 v7, v7, v123
    v_cvt_pk_bf16_f32 v160, v4, v5
    v_cvt_pk_bf16_f32 v161, v6, v7
    s_mov_b32 s7, 32
    buffer_store_dwordx2 v[160:161], v150, s[16:19], s7 offen
    ds_read_b128 v[112:115], v149 offset:39936
    ds_read_b128 v[116:119], v149 offset:40960
    ds_read_b128 v[120:123], v149 offset:41984
    s_waitcnt lgkmcnt(6)
    v_add_f32 v20, v20, v124
    v_add_f32 v21, v21, v125
    v_add_f32 v22, v22, v126
    v_add_f32 v23, v23, v127
    v_add_f32 v20, v20, v128
    v_add_f32 v21, v21, v129
    v_add_f32 v22, v22, v130
    v_add_f32 v23, v23, v131
    v_add_f32 v20, v20, v132
    v_add_f32 v21, v21, v133
    v_add_f32 v22, v22, v134
    v_add_f32 v23, v23, v135
    v_cvt_pk_bf16_f32 v162, v20, v21
    v_cvt_pk_bf16_f32 v163, v22, v23
    s_mov_b32 s7, 36896
    buffer_store_dwordx2 v[162:163], v150, s[16:19], s7 offen
    ds_read_b128 v[124:127], v149 offset:52224
    ds_read_b128 v[128:131], v149 offset:53248
    ds_read_b128 v[132:135], v149 offset:54272
    s_waitcnt lgkmcnt(6)
    v_add_f32 v36, v36, v136
    v_add_f32 v37, v37, v137
    v_add_f32 v38, v38, v138
    v_add_f32 v39, v39, v139
    v_add_f32 v36, v36, v140
    v_add_f32 v37, v37, v141
    v_add_f32 v38, v38, v142
    v_add_f32 v39, v39, v143
    v_add_f32 v36, v36, v144
    v_add_f32 v37, v37, v145
    v_add_f32 v38, v38, v146
    v_add_f32 v39, v39, v147
    v_cvt_pk_bf16_f32 v164, v36, v37
    v_cvt_pk_bf16_f32 v165, v38, v39
    s_mov_b32 s7, 73760
    buffer_store_dwordx2 v[164:165], v150, s[16:19], s7 offen
    ds_read_b128 v[136:139], v149 offset:64512
    ds_read_b128 v[140:143], v152
    ds_read_b128 v[144:147], v152 offset:1024
    s_waitcnt lgkmcnt(6)
    v_add_f32 v52, v52, v112
    v_add_f32 v53, v53, v113
    v_add_f32 v54, v54, v114
    v_add_f32 v55, v55, v115
    v_add_f32 v52, v52, v116
    v_add_f32 v53, v53, v117
    v_add_f32 v54, v54, v118
    v_add_f32 v55, v55, v119
    v_add_f32 v52, v52, v120
    v_add_f32 v53, v53, v121
    v_add_f32 v54, v54, v122
    v_add_f32 v55, v55, v123
    v_cvt_pk_bf16_f32 v166, v52, v53
    v_cvt_pk_bf16_f32 v167, v54, v55
    s_mov_b32 s7, 110624
    buffer_store_dwordx2 v[166:167], v150, s[16:19], s7 offen
    ds_read_b128 v[112:115], v152 offset:11264
    ds_read_b128 v[116:119], v152 offset:12288
    ds_read_b128 v[120:123], v152 offset:13312
    s_waitcnt lgkmcnt(6)
    v_add_f32 v68, v68, v124
    v_add_f32 v69, v69, v125
    v_add_f32 v70, v70, v126
    v_add_f32 v71, v71, v127
    v_add_f32 v68, v68, v128
    v_add_f32 v69, v69, v129
    v_add_f32 v70, v70, v130
    v_add_f32 v71, v71, v131
    v_add_f32 v68, v68, v132
    v_add_f32 v69, v69, v133
    v_add_f32 v70, v70, v134
    v_add_f32 v71, v71, v135
    v_cvt_pk_bf16_f32 v160, v68, v69
    v_cvt_pk_bf16_f32 v161, v70, v71
    s_mov_b32 s7, 147488
    buffer_store_dwordx2 v[160:161], v150, s[16:19], s7 offen
    s_waitcnt lgkmcnt(3)
    v_add_f32 v84, v84, v136
    v_add_f32 v85, v85, v137
    v_add_f32 v86, v86, v138
    v_add_f32 v87, v87, v139
    v_add_f32 v84, v84, v140
    v_add_f32 v85, v85, v141
    v_add_f32 v86, v86, v142
    v_add_f32 v87, v87, v143
    v_add_f32 v84, v84, v144
    v_add_f32 v85, v85, v145
    v_add_f32 v86, v86, v146
    v_add_f32 v87, v87, v147
    v_cvt_pk_bf16_f32 v162, v84, v85
    v_cvt_pk_bf16_f32 v163, v86, v87
    s_mov_b32 s7, 184352
    buffer_store_dwordx2 v[162:163], v150, s[16:19], s7 offen
    s_waitcnt lgkmcnt(0)
    v_add_f32 v100, v100, v112
    v_add_f32 v101, v101, v113
    v_add_f32 v102, v102, v114
    v_add_f32 v103, v103, v115
    v_add_f32 v100, v100, v116
    v_add_f32 v101, v101, v117
    v_add_f32 v102, v102, v118
    v_add_f32 v103, v103, v119
    v_add_f32 v100, v100, v120
    v_add_f32 v101, v101, v121
    v_add_f32 v102, v102, v122
    v_add_f32 v103, v103, v123
    v_cvt_pk_bf16_f32 v164, v100, v101
    v_cvt_pk_bf16_f32 v165, v102, v103
    s_mov_b32 s7, 221216
    buffer_store_dwordx2 v[164:165], v150, s[16:19], s7 offen
L_k2_r1:
    s_cmp_eq_u32 s3, 2
    s_cbranch_scc0 L_k2_r2
    ds_read_b128 v[112:115], v149 offset:6144
    ds_read_b128 v[116:119], v149 offset:7168
    ds_read_b128 v[120:123], v149 offset:8192
    ds_read_b128 v[124:127], v149 offset:18432
    ds_read_b128 v[128:131], v149 offset:19456
    ds_read_b128 v[132:135], v149 offset:20480
    ds_read_b128 v[136:139], v149 offset:30720
    ds_read_b128 v[140:143], v149 offset:31744
    ds_read_b128 v[144:147], v149 offset:32768
    s_waitcnt lgkmcnt(6)
    v_add_f32 v8, v8, v112
    v_add_f32 v9, v9, v113
    v_add_f32 v10, v10, v114
    v_add_f32 v11, v11, v115
    v_add_f32 v8, v8, v116
    v_add_f32 v9, v9, v117
    v_add_f32 v10, v10, v118
    v_add_f32 v11, v11, v119
    v_add_f32 v8, v8, v120
    v_add_f32 v9, v9, v121
    v_add_f32 v10, v10, v122
    v_add_f32 v11, v11, v123
    v_cvt_pk_bf16_f32 v160, v8, v9
    v_cvt_pk_bf16_f32 v161, v10, v11
    s_mov_b32 s7, 64
    buffer_store_dwordx2 v[160:161], v150, s[16:19], s7 offen
    ds_read_b128 v[112:115], v149 offset:43008
    ds_read_b128 v[116:119], v149 offset:44032
    ds_read_b128 v[120:123], v149 offset:45056
    s_waitcnt lgkmcnt(6)
    v_add_f32 v24, v24, v124
    v_add_f32 v25, v25, v125
    v_add_f32 v26, v26, v126
    v_add_f32 v27, v27, v127
    v_add_f32 v24, v24, v128
    v_add_f32 v25, v25, v129
    v_add_f32 v26, v26, v130
    v_add_f32 v27, v27, v131
    v_add_f32 v24, v24, v132
    v_add_f32 v25, v25, v133
    v_add_f32 v26, v26, v134
    v_add_f32 v27, v27, v135
    v_cvt_pk_bf16_f32 v162, v24, v25
    v_cvt_pk_bf16_f32 v163, v26, v27
    s_mov_b32 s7, 36928
    buffer_store_dwordx2 v[162:163], v150, s[16:19], s7 offen
    ds_read_b128 v[124:127], v149 offset:55296
    ds_read_b128 v[128:131], v149 offset:56320
    ds_read_b128 v[132:135], v149 offset:57344
    s_waitcnt lgkmcnt(6)
    v_add_f32 v40, v40, v136
    v_add_f32 v41, v41, v137
    v_add_f32 v42, v42, v138
    v_add_f32 v43, v43, v139
    v_add_f32 v40, v40, v140
    v_add_f32 v41, v41, v141
    v_add_f32 v42, v42, v142
    v_add_f32 v43, v43, v143
    v_add_f32 v40, v40, v144
    v_add_f32 v41, v41, v145
    v_add_f32 v42, v42, v146
    v_add_f32 v43, v43, v147
    v_cvt_pk_bf16_f32 v164, v40, v41
    v_cvt_pk_bf16_f32 v165, v42, v43
    s_mov_b32 s7, 73792
    buffer_store_dwordx2 v[164:165], v150, s[16:19], s7 offen
    ds_read_b128 v[136:139], v152 offset:2048
    ds_read_b128 v[140:143], v152 offset:3072
    ds_read_b128 v[144:147], v152 offset:4096
    s_waitcnt lgkmcnt(6)
    v_add_f32 v56, v56, v112
    v_add_f32 v57, v57, v113
    v_add_f32 v58, v58, v114
    v_add_f32 v59, v59, v115
    v_add_f32 v56, v56, v116
    v_add_f32 v57, v57, v117
    v_add_f32 v58, v58, v118
    v_add_f32 v59, v59, v119
    v_add_f32 v56, v56, v120
    v_add_f32 v57, v57, v121
    v_add_f32 v58, v58, v122
    v_add_f32 v59, v59, v123
    v_cvt_pk_bf16_f32 v166, v56, v57
    v_cvt_pk_bf16_f32 v167, v58, v59
    s_mov_b32 s7, 110656
    buffer_store_dwordx2 v[166:167], v150, s[16:19], s7 offen
    ds_read_b128 v[112:115], v152 offset:14336
    ds_read_b128 v[116:119], v152 offset:15360
    ds_read_b128 v[120:123], v152 offset:16384
    s_waitcnt lgkmcnt(6)
    v_add_f32 v72, v72, v124
    v_add_f32 v73, v73, v125
    v_add_f32 v74, v74, v126
    v_add_f32 v75, v75, v127
    v_add_f32 v72, v72, v128
    v_add_f32 v73, v73, v129
    v_add_f32 v74, v74, v130
    v_add_f32 v75, v75, v131
    v_add_f32 v72, v72, v132
    v_add_f32 v73, v73, v133
    v_add_f32 v74, v74, v134
    v_add_f32 v75, v75, v135
    v_cvt_pk_bf16_f32 v160, v72, v73
    v_cvt_pk_bf16_f32 v161, v74, v75
    s_mov_b32 s7, 147520
    buffer_store_dwordx2 v[160:161], v150, s[16:19], s7 offen
    s_waitcnt lgkmcnt(3)
    v_add_f32 v88, v88, v136
    v_add_f32 v89, v89, v137
    v_add_f32 v90, v90, v138
    v_add_f32 v91, v91, v139
    v_add_f32 v88, v88, v140
    v_add_f32 v89, v89, v141
    v_add_f32 v90, v90, v142
    v_add_f32 v91, v91, v143
    v_add_f32 v88, v88, v144
    v_add_f32 v89, v89, v145
    v_add_f32 v90, v90, v146
    v_add_f32 v91, v91, v147
    v_cvt_pk_bf16_f32 v162, v88, v89
    v_cvt_pk_bf16_f32 v163, v90, v91
    s_mov_b32 s7, 184384
    buffer_store_dwordx2 v[162:163], v150, s[16:19], s7 offen
    s_waitcnt lgkmcnt(0)
    v_add_f32 v104, v104, v112
    v_add_f32 v105, v105, v113
    v_add_f32 v106, v106, v114
    v_add_f32 v107, v107, v115
    v_add_f32 v104, v104, v116
    v_add_f32 v105, v105, v117
    v_add_f32 v106, v106, v118
    v_add_f32 v107, v107, v119
    v_add_f32 v104, v104, v120
    v_add_f32 v105, v105, v121
    v_add_f32 v106, v106, v122
    v_add_f32 v107, v107, v123
    v_cvt_pk_bf16_f32 v164, v104, v105
    v_cvt_pk_bf16_f32 v165, v106, v107
    s_mov_b32 s7, 221248
    buffer_store_dwordx2 v[164:165], v150, s[16:19], s7 offen
L_k2_r2:
    s_cmp_eq_u32 s3, 3
    s_cbranch_scc0 L_k2_r3
    ds_read_b128 v[112:115], v149 offset:9216
    ds_read_b128 v[116:119], v149 offset:10240
    ds_read_b128 v[120:123], v149 offset:11264
    ds_read_b128 v[124:127], v149 offset:21504
    ds_read_b128 v[128:131], v149 offset:22528
    ds_read_b128 v[132:135], v149 offset:23552
    ds_read_b128 v[136:139], v149 offset:33792
    ds_read_b128 v[140:143], v149 offset:34816
    ds_read_b128 v[144:147], v149 offset:35840
    s_waitcnt lgkmcnt(6)
    v_add_f32 v12, v12, v112
    v_add_f32 v13, v13, v113
    v_add_f32 v14, v14, v114
    v_add_f32 v15, v15, v115
    v_add_f32 v12, v12, v116
    v_add_f32 v13, v13, v117
    v_add_f32 v14, v14, v118
    v_add_f32 v15, v15, v119
    v_add_f32 v12, v12, v120
    v_add_f32 v13, v13, v121
    v_add_f32 v14, v14, v122
    v_add_f32 v15, v15, v123
    v_cvt_pk_bf16_f32 v160, v12, v13
    v_cvt_pk_bf16_f32 v161, v14, v15
    s_mov_b32 s7, 96
    buffer_store_dwordx2 v[160:161], v150, s[16:19], s7 offen
    ds_read_b128 v[112:115], v149 offset:46080
    ds_read_b128 v[116:119], v149 offset:47104
    ds_read_b128 v[120:123], v149 offset:48128
    s_waitcnt lgkmcnt(6)
    v_add_f32 v28, v28, v124
    v_add_f32 v29, v29, v125
    v_add_f32 v30, v30, v126
    v_add_f32 v31, v31, v127
    v_add_f32 v28, v28, v128
    v_add_f32 v29, v29, v129
    v_add_f32 v30, v30, v130
    v_add_f32 v31, v31, v131
    v_add_f32 v28, v28, v132
    v_add_f32 v29, v29, v133
    v_add_f32 v30, v30, v134
    v_add_f32 v31, v31, v135
    v_cvt_pk_bf16_f32 v162, v28, v29
    v_cvt_pk_bf16_f32 v163, v30, v31
    s_mov_b32 s7, 36960
    buffer_store_dwordx2 v[162:163], v150, s[16:19], s7 offen
    ds_read_b128 v[124:127], v149 offset:58368
    ds_read_b128 v[128:131], v149 offset:59392
    ds_read_b128 v[132:135], v149 offset:60416
    s_waitcnt lgkmcnt(6)
    v_add_f32 v44, v44, v136
    v_add_f32 v45, v45, v137
    v_add_f32 v46, v46, v138
    v_add_f32 v47, v47, v139
    v_add_f32 v44, v44, v140
    v_add_f32 v45, v45, v141
    v_add_f32 v46, v46, v142
    v_add_f32 v47, v47, v143
    v_add_f32 v44, v44, v144
    v_add_f32 v45, v45, v145
    v_add_f32 v46, v46, v146
    v_add_f32 v47, v47, v147
    v_cvt_pk_bf16_f32 v164, v44, v45
    v_cvt_pk_bf16_f32 v165, v46, v47
    s_mov_b32 s7, 73824
    buffer_store_dwordx2 v[164:165], v150, s[16:19], s7 offen
    ds_read_b128 v[136:139], v152 offset:5120
    ds_read_b128 v[140:143], v152 offset:6144
    ds_read_b128 v[144:147], v152 offset:7168
    s_waitcnt lgkmcnt(6)
    v_add_f32 v60, v60, v112
    v_add_f32 v61, v61, v113
    v_add_f32 v62, v62, v114
    v_add_f32 v63, v63, v115
    v_add_f32 v60, v60, v116
    v_add_f32 v61, v61, v117
    v_add_f32 v62, v62, v118
    v_add_f32 v63, v63, v119
    v_add_f32 v60, v60, v120
    v_add_f32 v61, v61, v121
    v_add_f32 v62, v62, v122
    v_add_f32 v63, v63, v123
    v_cvt_pk_bf16_f32 v166, v60, v61
    v_cvt_pk_bf16_f32 v167, v62, v63
    s_mov_b32 s7, 110688
    buffer_store_dwordx2 v[166:167], v150, s[16:19], s7 offen
    ds_read_b128 v[112:115], v152 offset:17408
    ds_read_b128 v[116:119], v152 offset:18432
    ds_read_b128 v[120:123], v152 offset:19456
    s_waitcnt lgkmcnt(6)
    v_add_f32 v76, v76, v124
    v_add_f32 v77, v77, v125
    v_add_f32 v78, v78, v126
    v_add_f32 v79, v79, v127
    v_add_f32 v76, v76, v128
    v_add_f32 v77, v77, v129
    v_add_f32 v78, v78, v130
    v_add_f32 v79, v79, v131
    v_add_f32 v76, v76, v132
    v_add_f32 v77, v77, v133
    v_add_f32 v78, v78, v134
    v_add_f32 v79, v79, v135
    v_cvt_pk_bf16_f32 v160, v76, v77
    v_cvt_pk_bf16_f32 v161, v78, v79
    s_mov_b32 s7, 147552
    buffer_store_dwordx2 v[160:161], v150, s[16:19], s7 offen
    s_waitcnt lgkmcnt(3)
    v_add_f32 v92, v92, v136
    v_add_f32 v93, v93, v137
    v_add_f32 v94, v94, v138
    v_add_f32 v95, v95, v139
    v_add_f32 v92, v92, v140
    v_add_f32 v93, v93, v141
    v_add_f32 v94, v94, v142
    v_add_f32 v95, v95, v143
    v_add_f32 v92, v92, v144
    v_add_f32 v93, v93, v145
    v_add_f32 v94, v94, v146
    v_add_f32 v95, v95, v147
    v_cvt_pk_bf16_f32 v162, v92, v93
    v_cvt_pk_bf16_f32 v163, v94, v95
    s_mov_b32 s7, 184416
    buffer_store_dwordx2 v[162:163], v150, s[16:19], s7 offen
    s_waitcnt lgkmcnt(0)
    v_add_f32 v108, v108, v112
    v_add_f32 v109, v109, v113
    v_add_f32 v110, v110, v114
    v_add_f32 v111, v111, v115
    v_add_f32 v108, v108, v116
    v_add_f32 v109, v109, v117
    v_add_f32 v110, v110, v118
    v_add_f32 v111, v111, v119
    v_add_f32 v108, v108, v120
    v_add_f32 v109, v109, v121
    v_add_f32 v110, v110, v122
    v_add_f32 v111, v111, v123
    v_cvt_pk_bf16_f32 v164, v108, v109
    v_cvt_pk_bf16_f32 v165, v110, v111
    s_mov_b32 s7, 221280
    buffer_store_dwordx2 v[164:165], v150, s[16:19], s7 offen
L_k2_r3:
L_k2_done:
    s_endpgm
.section .rodata,"a"
.p2align 6
.amdhsa_kernel attn_kernel
  .amdhsa_next_free_vgpr 256
  .amdhsa_next_free_sgpr 102
  .amdhsa_accum_offset 208
  .amdhsa_group_segment_fixed_size 0
  .amdhsa_kernarg_size 104
  .amdhsa_user_sgpr_count 2
  .amdhsa_user_sgpr_kernarg_segment_ptr 1
  .amdhsa_system_sgpr_workgroup_id_x 1
.end_amdhsa_kernel
.text
.section .rodata,"a"
.p2align 6
.amdhsa_kernel oproj_kernel
  .amdhsa_next_free_vgpr 512
  .amdhsa_next_free_sgpr 102
  .amdhsa_accum_offset 256
  .amdhsa_group_segment_fixed_size 0
  .amdhsa_kernarg_size 104
  .amdhsa_user_sgpr_count 2
  .amdhsa_user_sgpr_kernarg_segment_ptr 1
  .amdhsa_system_sgpr_workgroup_id_x 1
.end_amdhsa_kernel
```
